```python
import torch

def _softmax(x, axis=-1):
    return torch.softmax(x, dim=axis)
def _gelu(x):
    return torch.nn.functional.gelu(x, approximate="tanh")
def _silu(x):
    return torch.nn.functional.silu(x)
def _sigmoid(x):
    return torch.sigmoid(x)
def _layernorm(x, axis=-1, eps=1e-5):
    m = x.mean(dim=axis, keepdim=True)
    v = x.var(dim=axis, keepdim=True, unbiased=False)
    return (x - m) / torch.sqrt(v + eps)
def _scatter_add(tgt, idx, src, axis=0):
    return tgt.clone().index_add_(axis, idx, src)
def _segment_sum(src, seg, n):
    out = torch.zeros((n,) + src.shape[1:], dtype=src.dtype)
    return out.index_add_(0, seg, src)
def _pad(x, pw):
    flat = tuple(v for pair in reversed(pw) for v in pair)
    return torch.nn.functional.pad(x, flat)

kernel_name = 'gated_mix__ssm_conv_h3__glu_gated_glu__prompt'

def setup_inputs():

    _w = (lambda a: (lambda t: t.to(torch.bfloat16) if t.is_floating_point() else t)(torch.as_tensor(a)))
    def _A_setup():
        B, S, D = 1, 2048, 576
        ks = 4
        return {
            "q": _w((lambda *s: torch.randn(*s, dtype=torch.bfloat16) * 0.05)(B, S, D)),
            "k": _w((lambda *s: torch.randn(*s, dtype=torch.bfloat16) * 0.8)(B, S, D)),
            "v": _w((lambda *s: torch.randn(*s, dtype=torch.bfloat16) * 0.8)(B, S, D)),
            "shift_k": _w((lambda *s: torch.randn(*s, dtype=torch.bfloat16) * 0.8)(D, ks) * 0.5),
            "ssm_k": _w((lambda *s: torch.randn(*s, dtype=torch.bfloat16) * 0.8)(D, S) * (1.0 / S ** 0.5)),
            "ssm_D": _w((lambda *s: torch.randn(*s, dtype=torch.bfloat16) * 0.8)(D)),
        }
    _A_in = _A_setup()

    def _B_setup():
        B, S, D, F = 1, 2048, 576, 4608
        return {
            "x": _w((lambda *s: torch.randn(*s, dtype=torch.bfloat16) * 0.05)(B, S, D)),
            "w_gate": _w((lambda *s: torch.randn(*s, dtype=torch.bfloat16) * 0.4)(D, F)),
            "w_up": _w((lambda *s: torch.randn(*s, dtype=torch.bfloat16) * 0.05)(D, F)),
            "w_down": _w((lambda *s: torch.randn(*s, dtype=torch.bfloat16) * 0.05)(F, D)),
        }
    _B_in = _B_setup()

    return {
        "A_q": _A_in["q"],
        "A_k": _A_in["k"],
        "A_v": _A_in["v"],
        "A_shift_k": _A_in["shift_k"],
        "A_ssm_k": _A_in["ssm_k"],
        "A_ssm_D": _A_in["ssm_D"],
        "B_x": _B_in["x"],
        "B_w_gate": _B_in["w_gate"],
        "B_w_up": _B_in["w_up"],
        "B_w_down": _B_in["w_down"],
        "gate_w": _w((lambda *s: torch.randn(*s, dtype=torch.bfloat16) * 0.05)(576) * 16.0),
    }

def reference(A_q, A_k, A_v, A_shift_k, A_ssm_k, A_ssm_D, B_x, B_w_gate, B_w_up, B_w_down, gate_w):
    def _A_ref(q, k, v, shift_k, ssm_k, ssm_D):
        B, S, D = q.shape
        ks = shift_k.shape[-1]
        k_pad = _pad(k, ((0, 0), (ks - 1, 0), (0, 0)))
        k_shift = torch.zeros_like(k)
        for t in range(ks):
            k_shift = k_shift + k_pad[:, t:t + S, :] * shift_k[:, ks - 1 - t][None, None, :]
        kv = k_shift * v
        L = 2 * S
        kv_pad = _pad(kv, ((0, 0), (0, S), (0, 0)))
        kf_pad = _pad(ssm_k, ((0, 0), (0, S)))
        kv_f = (lambda x, axes=(-2,-1): torch.fft.rfft2(x.float(), dim=axes))(kv_pad[:, None, :, :], axes=(1, 2))
        kf_f = (lambda x, axes=(-2,-1): torch.fft.rfft2(x.float(), dim=axes))(kf_pad[:, None, :], axes=(1, 2))
        kf_f = (lambda x, *d: x.permute(*d))(kf_f, 1, 2, 0)
        y_f = kv_f * kf_f[None, :, :, :]
        y = (lambda x, s, axes=(-2,-1): torch.fft.irfft2(x, s=s, dim=axes).to(torch.bfloat16))(y_f, (1, L), axes=(1, 2))[:, 0, :S, :]
        y = y + kv * ssm_D[None, None, :]
        return q * y

    def _B_ref(x, w_gate, w_up, w_down):
        g = torch.einsum("bsd,df->bsf", x, w_gate)
        u = torch.einsum("bsd,df->bsf", x, w_up)
        h = _sigmoid(g) * u
        return torch.einsum("bsf,fd->bsd", h, w_down)

    x = A_q
    g = _sigmoid((x * gate_w).sum(-1, keepdims=True))
    a = _A_ref(x, A_k, A_v, A_shift_k, A_ssm_k, A_ssm_D)
    b = _B_ref(x, B_w_gate, B_w_up, B_w_down)
    return g * a + (1 - g) * b
```

```asm
; @launch grid=(256,1,1) block=(256,1,1) lds=163840
.amdgcn_target "amdgcn-amd-amdhsa--gfx950"
.text
.globl gated_mix__ssm_conv_h3__glu_gated_glu__prompt_kernel
.p2align 8
.type gated_mix__ssm_conv_h3__glu_gated_glu__prompt_kernel,@function
gated_mix__ssm_conv_h3__glu_gated_glu__prompt_kernel:
    s_cmp_ge_u32 s2, 256
    s_cbranch_scc1 L_exit
    s_load_dwordx8 s[4:11], s[0:1], 0
    s_load_dwordx8 s[44:51], s[0:1], 56
    s_load_dwordx4 s[52:55], s[0:1], 96
    s_load_dwordx2 s[62:63], s[0:1], 32
    v_lshrrev_b32 v1, 6, v0
    v_and_b32 v2, 63, v0
    v_readfirstlane_b32 s24, v1
    s_and_b32 s33, s2, 7
    s_lshr_b32 s34, s2, 3
L_pf_here:
    s_getpc_b64 s[60:61]
    s_and_b32 s98, s34, 31
    s_lshl_b32 s98, s98, 2
    s_add_u32 s98, s98, s24
    s_lshl_b32 s98, s98, 7
    s_add_u32 s98, s98, 0
    s_min_u32 s98, s98, L_code_end-L_pf_here-8
    v_mov_b32 v45, s98
    s_mov_b64 exec, 1
    global_load_dword v60, v45, s[60:61]
    s_mov_b64 exec, -1
    s_and_b32 s3, s34, 3
    s_lshr_b32 s97, s34, 2
    s_lshl_b32 s37, s33, 2
    s_add_u32 s37, s37, s3
    s_mul_i32 s26, s37, 144
    s_lshl_b32 s25, s97, 8
    s_lshl_b32 s35, s24, 6
    s_add_u32 s25, s25, s35
    v_lshrrev_b32 v46, 3, v2
    v_mul_u32_u24 v46, 1152, v46
    v_and_b32 v47, 7, v2
    v_lshrrev_b32 v48, 4, v2
    v_xor_b32 v47, v47, v48
    v_lshl_add_u32 v12, v47, 4, v46
    v_xor_b32 v47, 4, v47
    v_lshl_add_u32 v13, v47, 4, v46
    v_add_u32 v13, 8*1152, v13
    s_mul_i32 s28, s25, 1152
    s_lshl_b32 s31, s24, 13
    s_add_u32 s31, s31, 110592
    s_xor_b32 s93, s3, 0
    s_mul_i32 s93, s93, 16*1152
    s_add_u32 s93, s93, s28
    s_xor_b32 s94, s3, 1
    s_mul_i32 s94, s94, 16*1152
    s_add_u32 s94, s94, s28
    s_xor_b32 s95, s3, 2
    s_mul_i32 s95, s95, 16*1152
    s_add_u32 s95, s95, s28
    s_xor_b32 s96, s3, 3
    s_mul_i32 s96, s96, 16*1152
    s_add_u32 s96, s96, s28
    s_and_b32 s35, s24, 1
    s_lshr_b32 s36, s24, 1
    s_mul_i32 s29, s35, 32*9216
    s_lshl_b32 s38, s26, 1
    s_add_u32 s29, s29, s38
    s_mul_i32 s30, s24, 9216
    s_add_u32 s41, s30, 73728
    s_lshl_b32 s27, s97, 6
    s_lshl_b32 s84, s97, 10
    s_add_u32 s84, s84, s30
    v_add_u32 v46, s27, v2
    s_add_u32 s97, s97, 1
    s_cmp_eq_u32 s97, 9
    s_cselect_b32 s97, 0, s97
    v_mul_u32_u24 v47, 3641, v46
    v_lshrrev_b32 v47, 16, v47
    v_mul_u32_u24 v49, 288, v47
    v_lshlrev_b32 v50, 4, v46
    v_sub_u32 v49, v50, v49
    v_and_b32 v50, 12, v47
    v_and_b32 v51, 3, v47
    v_lshl_add_u32 v50, v50, 1, v51
    v_lshrrev_b32 v51, 4, v47
    v_lshl_add_u32 v50, v51, 2, v50
    v_mul_u32_u24 v50, 9216, v50
    v_add_u32 v3, v50, v49
    s_lshl_b32 s27, s97, 6
    s_lshl_b32 s85, s97, 10
    s_add_u32 s85, s85, s30
    v_add_u32 v46, s27, v2
    s_add_u32 s97, s97, 1
    s_cmp_eq_u32 s97, 9
    s_cselect_b32 s97, 0, s97
    v_mul_u32_u24 v47, 3641, v46
    v_lshrrev_b32 v47, 16, v47
    v_mul_u32_u24 v49, 288, v47
    v_lshlrev_b32 v50, 4, v46
    v_sub_u32 v49, v50, v49
    v_and_b32 v50, 12, v47
    v_and_b32 v51, 3, v47
    v_lshl_add_u32 v50, v50, 1, v51
    v_lshrrev_b32 v51, 4, v47
    v_lshl_add_u32 v50, v51, 2, v50
    v_mul_u32_u24 v50, 9216, v50
    v_add_u32 v4, v50, v49
    s_waitcnt lgkmcnt(0)
    s_mov_b32 s12, s4
    s_mov_b32 s13, s5
    s_mov_b32 s14, 0x240000
    s_mov_b32 s15, 0x20000
    s_add_u32 s99, s93, 0
    s_add_u32 m0, s31, 0
    s_nop 0
    buffer_load_dwordx4 v12, s[12:15], s99 offen lds
    s_add_u32 m0, s31, 1024
    s_nop 0
    buffer_load_dwordx4 v13, s[12:15], s99 offen lds
    s_cmp_eq_u32 s36, 0
    s_cselect_b32 s16, s44, s46
    s_cselect_b32 s17, s45, s47
    s_mov_b32 s18, 5308416
    s_mov_b32 s19, 0x20000
    s_add_u32 m0, s84, 0
    s_nop 0
    buffer_load_dwordx4 v3, s[16:19], s29 offen lds
    s_add_u32 m0, s85, 0
    s_nop 0
    buffer_load_dwordx4 v4, s[16:19], s29 offen lds
    s_add_u32 s99, s94, 0
    s_add_u32 m0, s31, 2048
    s_nop 0
    buffer_load_dwordx4 v12, s[12:15], s99 offen lds
    s_add_u32 m0, s31, 3072
    s_nop 0
    buffer_load_dwordx4 v13, s[12:15], s99 offen lds
    s_add_u32 s99, s95, 0
    s_add_u32 m0, s31, 4096
    s_nop 0
    buffer_load_dwordx4 v12, s[12:15], s99 offen lds
    s_add_u32 m0, s31, 5120
    s_nop 0
    buffer_load_dwordx4 v13, s[12:15], s99 offen lds
    s_add_u32 s99, s96, 0
    s_add_u32 m0, s31, 6144
    s_nop 0
    buffer_load_dwordx4 v12, s[12:15], s99 offen lds
    s_add_u32 m0, s31, 7168
    s_nop 0
    buffer_load_dwordx4 v13, s[12:15], s99 offen lds
    s_lshl_b32 s27, s97, 6
    s_lshl_b32 s86, s97, 10
    s_add_u32 s86, s86, s30
    v_add_u32 v46, s27, v2
    s_add_u32 s97, s97, 1
    s_cmp_eq_u32 s97, 9
    s_cselect_b32 s97, 0, s97
    v_mul_u32_u24 v47, 3641, v46
    v_lshrrev_b32 v47, 16, v47
    v_mul_u32_u24 v49, 288, v47
    v_lshlrev_b32 v50, 4, v46
    v_sub_u32 v49, v50, v49
    v_and_b32 v50, 12, v47
    v_and_b32 v51, 3, v47
    v_lshl_add_u32 v50, v50, 1, v51
    v_lshrrev_b32 v51, 4, v47
    v_lshl_add_u32 v50, v51, 2, v50
    v_mul_u32_u24 v50, 9216, v50
    v_add_u32 v5, v50, v49
    s_add_u32 m0, s86, 0
    s_nop 0
    buffer_load_dwordx4 v5, s[16:19], s29 offen lds
    s_lshl_b32 s27, s97, 6
    s_lshl_b32 s87, s97, 10
    s_add_u32 s87, s87, s30
    v_add_u32 v46, s27, v2
    s_add_u32 s97, s97, 1
    s_cmp_eq_u32 s97, 9
    s_cselect_b32 s97, 0, s97
    v_mul_u32_u24 v47, 3641, v46
    v_lshrrev_b32 v47, 16, v47
    v_mul_u32_u24 v49, 288, v47
    v_lshlrev_b32 v50, 4, v46
    v_sub_u32 v49, v50, v49
    v_and_b32 v50, 12, v47
    v_and_b32 v51, 3, v47
    v_lshl_add_u32 v50, v50, 1, v51
    v_lshrrev_b32 v51, 4, v47
    v_lshl_add_u32 v50, v51, 2, v50
    v_mul_u32_u24 v50, 9216, v50
    v_add_u32 v6, v50, v49
    s_add_u32 m0, s87, 0
    s_nop 0
    buffer_load_dwordx4 v6, s[16:19], s29 offen lds
    s_lshl_b32 s27, s97, 6
    s_lshl_b32 s88, s97, 10
    s_add_u32 s88, s88, s30
    v_add_u32 v46, s27, v2
    s_add_u32 s97, s97, 1
    s_cmp_eq_u32 s97, 9
    s_cselect_b32 s97, 0, s97
    v_mul_u32_u24 v47, 3641, v46
    v_lshrrev_b32 v47, 16, v47
    v_mul_u32_u24 v49, 288, v47
    v_lshlrev_b32 v50, 4, v46
    v_sub_u32 v49, v50, v49
    v_and_b32 v50, 12, v47
    v_and_b32 v51, 3, v47
    v_lshl_add_u32 v50, v50, 1, v51
    v_lshrrev_b32 v51, 4, v47
    v_lshl_add_u32 v50, v51, 2, v50
    v_mul_u32_u24 v50, 9216, v50
    v_add_u32 v7, v50, v49
    s_add_u32 m0, s88, 0
    s_nop 0
    buffer_load_dwordx4 v7, s[16:19], s29 offen lds
    s_lshl_b32 s27, s97, 6
    s_lshl_b32 s89, s97, 10
    s_add_u32 s89, s89, s30
    v_add_u32 v46, s27, v2
    s_add_u32 s97, s97, 1
    s_cmp_eq_u32 s97, 9
    s_cselect_b32 s97, 0, s97
    v_mul_u32_u24 v47, 3641, v46
    v_lshrrev_b32 v47, 16, v47
    v_mul_u32_u24 v49, 288, v47
    v_lshlrev_b32 v50, 4, v46
    v_sub_u32 v49, v50, v49
    v_and_b32 v50, 12, v47
    v_and_b32 v51, 3, v47
    v_lshl_add_u32 v50, v50, 1, v51
    v_lshrrev_b32 v51, 4, v47
    v_lshl_add_u32 v50, v51, 2, v50
    v_mul_u32_u24 v50, 9216, v50
    v_add_u32 v8, v50, v49
    s_add_u32 m0, s89, 0
    s_nop 0
    buffer_load_dwordx4 v8, s[16:19], s29 offen lds
    s_lshl_b32 s27, s97, 6
    s_lshl_b32 s90, s97, 10
    s_add_u32 s90, s90, s30
    v_add_u32 v46, s27, v2
    s_add_u32 s97, s97, 1
    s_cmp_eq_u32 s97, 9
    s_cselect_b32 s97, 0, s97
    v_mul_u32_u24 v47, 3641, v46
    v_lshrrev_b32 v47, 16, v47
    v_mul_u32_u24 v49, 288, v47
    v_lshlrev_b32 v50, 4, v46
    v_sub_u32 v49, v50, v49
    v_and_b32 v50, 12, v47
    v_and_b32 v51, 3, v47
    v_lshl_add_u32 v50, v50, 1, v51
    v_lshrrev_b32 v51, 4, v47
    v_lshl_add_u32 v50, v51, 2, v50
    v_mul_u32_u24 v50, 9216, v50
    v_add_u32 v9, v50, v49
    s_add_u32 m0, s90, 0
    s_nop 0
    buffer_load_dwordx4 v9, s[16:19], s29 offen lds
    s_lshl_b32 s27, s97, 6
    s_lshl_b32 s91, s97, 10
    s_add_u32 s91, s91, s30
    v_add_u32 v46, s27, v2
    s_add_u32 s97, s97, 1
    s_cmp_eq_u32 s97, 9
    s_cselect_b32 s97, 0, s97
    v_mul_u32_u24 v47, 3641, v46
    v_lshrrev_b32 v47, 16, v47
    v_mul_u32_u24 v49, 288, v47
    v_lshlrev_b32 v50, 4, v46
    v_sub_u32 v49, v50, v49
    v_and_b32 v50, 12, v47
    v_and_b32 v51, 3, v47
    v_lshl_add_u32 v50, v50, 1, v51
    v_lshrrev_b32 v51, 4, v47
    v_lshl_add_u32 v50, v51, 2, v50
    v_mul_u32_u24 v50, 9216, v50
    v_add_u32 v10, v50, v49
    s_add_u32 m0, s91, 0
    s_nop 0
    buffer_load_dwordx4 v10, s[16:19], s29 offen lds
    s_lshl_b32 s27, s97, 6
    s_lshl_b32 s92, s97, 10
    s_add_u32 s92, s92, s30
    v_add_u32 v46, s27, v2
    s_add_u32 s97, s97, 1
    s_cmp_eq_u32 s97, 9
    s_cselect_b32 s97, 0, s97
    v_mul_u32_u24 v47, 3641, v46
    v_lshrrev_b32 v47, 16, v47
    v_mul_u32_u24 v49, 288, v47
    v_lshlrev_b32 v50, 4, v46
    v_sub_u32 v49, v50, v49
    v_and_b32 v50, 12, v47
    v_and_b32 v51, 3, v47
    v_lshl_add_u32 v50, v50, 1, v51
    v_lshrrev_b32 v51, 4, v47
    v_lshl_add_u32 v50, v51, 2, v50
    v_mul_u32_u24 v50, 9216, v50
    v_add_u32 v11, v50, v49
    s_add_u32 m0, s92, 0
    s_nop 0
    buffer_load_dwordx4 v11, s[16:19], s29 offen lds
    s_add_u32 s29, s29, 64*9216
    s_mov_b32 s20, s54
    s_mov_b32 s21, s55
    s_mov_b32 s22, 0x3000000
    s_mov_b32 s23, 0x20000
    v_lshlrev_b32 v1, 4, v2
    v_and_b32 v46, 15, v2
    v_bfe_u32 v47, v2, 1, 3
    v_xor_b32 v47, v47, v48
    v_lshlrev_b32 v49, 7, v46
    v_xor_b32 v50, 0, v47
    v_lshl_add_u32 v50, v50, 4, v49
    v_add_u32 v14, s31, v50
    v_add_u32 v62, s41, v50
    v_xor_b32 v50, 4, v47
    v_lshl_add_u32 v50, v50, 4, v49
    v_add_u32 v15, s31, v50
    v_add_u32 v63, s41, v50
    v_lshrrev_b32 v49, 2, v2
    v_mul_u32_u24 v49, 288, v49
    v_and_b32 v50, 3, v2
    v_lshl_add_u32 v16, v50, 3, v49
    v_add_u32 v17, 36864, v16
    v_add_u32 v18, 73728, v16
    s_add_u32 s99, s93, 128
    s_add_u32 m0, s41, 0
    s_nop 0
    buffer_load_dwordx4 v12, s[12:15], s99 offen lds
    s_add_u32 m0, s41, 1024
    s_nop 0
    buffer_load_dwordx4 v13, s[12:15], s99 offen lds
    s_add_u32 s99, s94, 128
    s_add_u32 m0, s41, 2048
    s_nop 0
    buffer_load_dwordx4 v12, s[12:15], s99 offen lds
    s_add_u32 m0, s41, 3072
    s_nop 0
    buffer_load_dwordx4 v13, s[12:15], s99 offen lds
    s_add_u32 s99, s95, 128
    s_add_u32 m0, s41, 4096
    s_nop 0
    buffer_load_dwordx4 v12, s[12:15], s99 offen lds
    s_add_u32 m0, s41, 5120
    s_nop 0
    buffer_load_dwordx4 v13, s[12:15], s99 offen lds
    s_add_u32 s99, s96, 128
    s_add_u32 m0, s41, 6144
    s_nop 0
    buffer_load_dwordx4 v12, s[12:15], s99 offen lds
    s_add_u32 m0, s41, 7168
    s_nop 0
    buffer_load_dwordx4 v13, s[12:15], s99 offen lds
    s_waitcnt vmcnt(8)
    ds_read_b128 a[96:99], v14 offset:0
    ds_read_b128 a[100:103], v14 offset:2048
    ds_read_b128 a[104:107], v14 offset:4096
    ds_read_b128 a[108:111], v14 offset:6144
    ds_read_b128 a[112:115], v15 offset:0
    ds_read_b128 a[116:119], v15 offset:2048
    ds_read_b128 a[120:123], v15 offset:4096
    ds_read_b128 a[124:127], v15 offset:6144
    s_barrier
    ds_read_b64_tr_b16 a[160:161], v16 offset:0
    ds_read_b64_tr_b16 a[162:163], v16 offset:4608
    ds_read_b64_tr_b16 a[164:165], v16 offset:9216
    ds_read_b64_tr_b16 a[166:167], v16 offset:13824
    ds_read_b64_tr_b16 a[168:169], v16 offset:18432
    ds_read_b64_tr_b16 a[170:171], v16 offset:23040
    ds_read_b64_tr_b16 a[172:173], v16 offset:27648
    ds_read_b64_tr_b16 a[174:175], v16 offset:32256
    s_waitcnt lgkmcnt(4)
    v_mfma_f32_16x16x32_bf16 v[64:67], a[160:163], a[96:99], 0
    s_add_u32 m0, s84, 36864
    s_sub_u32 s41, s2, 64
    s_lshl_b32 s41, s41, 12
    v_mfma_f32_16x16x32_bf16 v[64:67], a[164:167], a[112:115], v[64:67]
    ds_read_b64_tr_b16 a[176:177], v16 offset:32
    s_cmp_eq_u32 s24, 1
    s_cselect_b32 s41, s41, 2147483632
    v_mfma_f32_16x16x32_bf16 v[68:71], a[160:163], a[100:103], 0
    buffer_load_dwordx4 v3, s[16:19], s29 offen lds
    s_add_u32 m0, s85, 36864
    v_mfma_f32_16x16x32_bf16 v[68:71], a[164:167], a[116:119], v[68:71]
    ds_read_b64_tr_b16 a[178:179], v16 offset:4640
    s_add_u32 s100, s41, 24838144
    v_mfma_f32_16x16x32_bf16 v[72:75], a[160:163], a[104:107], 0
    v_mov_b32 v40, 0
    v_mov_b32 v41, 0
    v_mfma_f32_16x16x32_bf16 v[72:75], a[164:167], a[120:123], v[72:75]
    ds_read_b64_tr_b16 a[180:181], v16 offset:9248
    v_mov_b32 v42, 0
    v_mfma_f32_16x16x32_bf16 v[76:79], a[160:163], a[108:111], 0
    v_mov_b32 v43, 0
    v_mov_b32 v44, 0
    v_mfma_f32_16x16x32_bf16 v[76:79], a[164:167], a[124:127], v[76:79]
    s_waitcnt lgkmcnt(3)
    ds_read_b64_tr_b16 a[182:183], v16 offset:13856
    v_mfma_f32_16x16x32_bf16 a[0:3], a[168:171], a[96:99], 0
    buffer_load_dwordx4 v4, s[16:19], s29 offen lds
    s_add_u32 m0, s86, 36864
    v_mfma_f32_16x16x32_bf16 a[0:3], a[172:175], a[112:115], a[0:3]
    ds_read_b64_tr_b16 a[184:185], v16 offset:18464
    v_mov_b32 v45, 1
    v_mfma_f32_16x16x32_bf16 a[4:7], a[168:171], a[100:103], 0
    v_mfma_f32_16x16x32_bf16 a[4:7], a[172:175], a[116:119], a[4:7]
    ds_read_b64_tr_b16 a[186:187], v16 offset:23072
    v_mfma_f32_16x16x32_bf16 a[8:11], a[168:171], a[104:107], 0
    s_cmp_lt_u32 s41, 77824
    s_cbranch_scc0 L_sz_1
    buffer_store_dwordx4 v[40:43], v1, s[20:23], s100 offen offset:0 sc1
    buffer_store_dwordx4 v[40:43], v1, s[20:23], s100 offen offset:1024 sc1
    buffer_store_dwordx4 v[40:43], v1, s[20:23], s100 offen offset:2048 sc1
    buffer_store_dwordx4 v[40:43], v1, s[20:23], s100 offen offset:3072 sc1
L_sz_1:
    s_mul_i32 s28, s24, 5120
    v_mfma_f32_16x16x32_bf16 a[8:11], a[172:175], a[120:123], a[8:11]
    ds_read_b64_tr_b16 a[188:189], v16 offset:27680
    s_add_u32 s28, s28, 143648
    v_mfma_f32_16x16x32_bf16 a[12:15], a[168:171], a[108:111], 0
    s_mov_b32 s44, s48
    s_mov_b32 s45, s49
    s_mov_b32 s46, 5308416
    v_mfma_f32_16x16x32_bf16 a[12:15], a[172:175], a[124:127], a[12:15]
    s_waitcnt lgkmcnt(3)
    ds_read_b64_tr_b16 a[190:191], v16 offset:32288
    v_mfma_f32_16x16x32_bf16 v[80:83], a[176:179], a[96:99], 0
    buffer_load_dwordx4 v5, s[16:19], s29 offen lds
    s_add_u32 m0, s87, 36864
    v_mfma_f32_16x16x32_bf16 v[80:83], a[180:183], a[112:115], v[80:83]
    ds_read_b64_tr_b16 a[192:193], v16 offset:64
    s_mov_b32 s47, 0x20000
    v_mfma_f32_16x16x32_bf16 v[84:87], a[176:179], a[100:103], 0
    s_lshl_b32 s100, s2, 2
    s_add_u32 s100, s100, s24
    s_mul_i32 s101, s100, 7282
    v_mfma_f32_16x16x32_bf16 v[84:87], a[180:183], a[116:119], v[84:87]
    ds_read_b64_tr_b16 a[194:195], v16 offset:4672
    s_lshr_b32 s101, s101, 16
    v_mfma_f32_16x16x32_bf16 v[88:91], a[176:179], a[104:107], 0
    buffer_load_dwordx4 v6, s[16:19], s29 offen lds
    s_add_u32 m0, s88, 36864
    v_mfma_f32_16x16x32_bf16 v[88:91], a[180:183], a[120:123], v[88:91]
    ds_read_b64_tr_b16 a[196:197], v16 offset:9280
    s_mul_i32 s98, s101, 9
    v_mfma_f32_16x16x32_bf16 v[92:95], a[176:179], a[108:111], 0
    s_sub_u32 s100, s100, s98
    s_mul_i32 s54, s101, 32*1152
    s_lshl_b32 s98, s100, 7
    v_mfma_f32_16x16x32_bf16 v[92:95], a[180:183], a[124:127], v[92:95]
    s_waitcnt lgkmcnt(3)
    ds_read_b64_tr_b16 a[198:199], v16 offset:13888
    v_mfma_f32_16x16x32_bf16 a[16:19], a[184:187], a[96:99], 0
    buffer_load_dwordx4 v7, s[16:19], s29 offen lds
    s_add_u32 m0, s89, 36864
    v_mfma_f32_16x16x32_bf16 a[16:19], a[188:191], a[112:115], a[16:19]
    ds_read_b64_tr_b16 a[200:201], v16 offset:18496
    s_add_u32 s54, s54, s98
    v_mfma_f32_16x16x32_bf16 a[20:23], a[184:187], a[100:103], 0
    s_mul_i32 s55, s100, 580
    s_add_u32 s55, s55, s101
    s_lshl_b32 s55, s55, 10
    v_mfma_f32_16x16x32_bf16 a[20:23], a[188:191], a[116:119], a[20:23]
    ds_read_b64_tr_b16 a[202:203], v16 offset:23104
    s_add_u32 s55, s55, 25165824
    v_mfma_f32_16x16x32_bf16 a[24:27], a[184:187], a[104:107], 0
    s_cmp_lt_u32 s101, 144
    s_cselect_b32 s55, s55, 1072693248
    s_sub_u32 s100, 7, s24
    s_lshl_b32 s100, s100, 8
    v_mfma_f32_16x16x32_bf16 a[24:27], a[188:191], a[120:123], a[24:27]
    ds_read_b64_tr_b16 a[204:205], v16 offset:27712
    s_xor_b32 s101, s2, 160
    v_mfma_f32_16x16x32_bf16 a[28:31], a[184:187], a[108:111], 0
    buffer_load_dwordx4 v8, s[16:19], s29 offen lds
    s_add_u32 m0, s90, 36864
    v_mfma_f32_16x16x32_bf16 a[28:31], a[188:191], a[124:127], a[28:31]
    s_waitcnt lgkmcnt(3)
    ds_read_b64_tr_b16 a[206:207], v16 offset:32320
    v_mfma_f32_16x16x32_bf16 v[96:99], a[192:195], a[96:99], 0
    s_add_u32 s100, s100, s101
    s_mul_i32 s101, s100, 7282
    s_lshr_b32 s101, s101, 16
    v_mfma_f32_16x16x32_bf16 v[96:99], a[196:199], a[112:115], v[96:99]
    ds_read_b64_tr_b16 a[160:161], v16 offset:96
    s_mul_i32 s98, s101, 9
    v_mfma_f32_16x16x32_bf16 v[100:103], a[192:195], a[100:103], 0
    buffer_load_dwordx4 v9, s[16:19], s29 offen lds
    s_add_u32 m0, s91, 36864
    v_mfma_f32_16x16x32_bf16 v[100:103], a[196:199], a[116:119], v[100:103]
    ds_read_b64_tr_b16 a[162:163], v16 offset:4704
    s_sub_u32 s100, s100, s98
    v_mfma_f32_16x16x32_bf16 v[104:107], a[192:195], a[104:107], 0
    s_mul_i32 s48, s101, 32*1152
    s_lshl_b32 s98, s100, 7
    s_add_u32 s48, s48, s98
    v_mfma_f32_16x16x32_bf16 v[104:107], a[196:199], a[120:123], v[104:107]
    ds_read_b64_tr_b16 a[164:165], v16 offset:9312
    s_mul_i32 s49, s100, 580
    v_mfma_f32_16x16x32_bf16 v[108:111], a[192:195], a[108:111], 0
    s_add_u32 s49, s49, s101
    s_lshl_b32 s49, s49, 10
    s_add_u32 s49, s49, 25165824
    v_mfma_f32_16x16x32_bf16 v[108:111], a[196:199], a[124:127], v[108:111]
    s_waitcnt lgkmcnt(3)
    ds_read_b64_tr_b16 a[166:167], v16 offset:13920
    v_mfma_f32_16x16x32_bf16 a[32:35], a[200:203], a[96:99], 0
    buffer_load_dwordx4 v10, s[16:19], s29 offen lds
    s_add_u32 m0, s92, 36864
    v_mfma_f32_16x16x32_bf16 a[32:35], a[204:207], a[112:115], a[32:35]
    ds_read_b64_tr_b16 a[168:169], v16 offset:18528
    s_cmp_lt_u32 s101, 144
    s_cselect_b32 s49, s49, 1072693248
    v_mfma_f32_16x16x32_bf16 a[36:39], a[200:203], a[100:103], 0
    v_lshrrev_b32 v52, 3, v2
    v_mul_u32_u24 v52, 1152, v52
    v_mfma_f32_16x16x32_bf16 a[36:39], a[204:207], a[116:119], a[36:39]
    ds_read_b64_tr_b16 a[170:171], v16 offset:23136
    v_and_b32 v49, 7, v2
    v_mfma_f32_16x16x32_bf16 a[40:43], a[200:203], a[104:107], 0
    v_lshl_add_u32 v52, v49, 4, v52
    v_and_b32 v47, 3, v2
    v_mfma_f32_16x16x32_bf16 a[40:43], a[204:207], a[120:123], a[40:43]
    ds_read_b64_tr_b16 a[172:173], v16 offset:27744
    v_bfe_u32 v21, v2, 2, 2
    v_mfma_f32_16x16x32_bf16 a[44:47], a[200:203], a[108:111], 0
    buffer_load_dwordx4 v11, s[16:19], s29 offen lds
    s_add_u32 s29, s29, 64*9216
    v_mfma_f32_16x16x32_bf16 a[44:47], a[204:207], a[124:127], a[44:47]
    s_waitcnt lgkmcnt(3)
    ds_read_b64_tr_b16 a[174:175], v16 offset:32352
    v_mfma_f32_16x16x32_bf16 v[112:115], a[160:163], a[96:99], 0
    s_add_u32 s99, s93, 256
    s_add_u32 m0, s31, 0
    v_lshl_add_u32 v21, v48, 3, v21
    v_mfma_f32_16x16x32_bf16 v[112:115], a[164:167], a[112:115], v[112:115]
    ds_read_b64_tr_b16 a[176:177], v16 offset:128
    v_mul_u32_u24 v21, 288, v21
    v_mfma_f32_16x16x32_bf16 v[116:119], a[160:163], a[100:103], 0
    buffer_load_dwordx4 v12, s[12:15], s99 offen lds
    s_add_u32 m0, s31, 1024
    v_mfma_f32_16x16x32_bf16 v[116:119], a[164:167], a[116:119], v[116:119]
    ds_read_b64_tr_b16 a[178:179], v16 offset:4736
    v_lshl_add_u32 v21, v47, 3, v21
    v_mfma_f32_16x16x32_bf16 v[120:123], a[160:163], a[104:107], 0
    s_lshl_b32 s98, s24, 5
    s_add_u32 s98, s98, 143360
    v_add_u32 v21, s98, v21
    v_mfma_f32_16x16x32_bf16 v[120:123], a[164:167], a[120:123], v[120:123]
    ds_read_b64_tr_b16 a[180:181], v16 offset:9344
    s_lshr_b32 s42, s34, 2
    v_mfma_f32_16x16x32_bf16 v[124:127], a[160:163], a[108:111], 0
    s_lshl_b32 s43, s33, 3
    s_add_u32 s43, s43, s42
    s_lshl_b32 s43, s43, 5
    v_mfma_f32_16x16x32_bf16 v[124:127], a[164:167], a[124:127], v[124:127]
    s_waitcnt lgkmcnt(3)
    ds_read_b64_tr_b16 a[182:183], v16 offset:13952
    v_mfma_f32_16x16x32_bf16 a[48:51], a[168:171], a[96:99], 0
    buffer_load_dwordx4 v13, s[12:15], s99 offen lds
    s_add_u32 s99, s94, 256
    v_mfma_f32_16x16x32_bf16 a[48:51], a[172:175], a[112:115], a[48:51]
    ds_read_b64_tr_b16 a[184:185], v16 offset:18560
    s_add_u32 m0, s31, 2048
    v_mfma_f32_16x16x32_bf16 a[52:55], a[168:171], a[100:103], 0
    s_mul_i32 s42, s3, 144
    s_cmp_eq_u32 s36, 0
    s_cselect_b32 s56, s6, s8
    s_cselect_b32 s57, s7, s9
    s_cselect_b32 s100, 3, 0
    s_mov_b32 s58, 2359296
    v_mfma_f32_16x16x32_bf16 a[52:55], a[172:175], a[116:119], a[52:55]
    ds_read_b64_tr_b16 a[186:187], v16 offset:23168
    s_mov_b32 s59, 0x20000
    v_mfma_f32_16x16x32_bf16 a[56:59], a[168:171], a[104:107], 0
    s_sub_u32 s100, s43, s100
    s_mul_i32 s100, s100, 1152
    s_lshl_b32 s98, s42, 1
    v_mfma_f32_16x16x32_bf16 a[56:59], a[172:175], a[120:123], a[56:59]
    ds_read_b64_tr_b16 a[188:189], v16 offset:27776
    s_add_u32 s100, s100, s98
    v_mfma_f32_16x16x32_bf16 a[60:63], a[168:171], a[108:111], 0
    buffer_load_dwordx4 v12, s[12:15], s99 offen lds
    s_add_u32 m0, s31, 3072
    v_mfma_f32_16x16x32_bf16 a[60:63], a[172:175], a[124:127], a[60:63]
    s_waitcnt lgkmcnt(3)
    ds_read_b64_tr_b16 a[190:191], v16 offset:32384
    v_mfma_f32_16x16x32_bf16 v[128:131], a[176:179], a[96:99], 0
    s_mul_i32 s98, s35, 5*64
    v_add_u32 v49, s98, v2
    v_mul_u32_u24 v47, 3641, v49
    v_mfma_f32_16x16x32_bf16 v[128:131], a[180:183], a[112:115], v[128:131]
    ds_read_b64_tr_b16 a[192:193], v16 offset:160
    v_lshrrev_b32 v47, 16, v47
    v_mfma_f32_16x16x32_bf16 v[132:135], a[176:179], a[100:103], 0
    buffer_load_dwordx4 v13, s[12:15], s99 offen lds
    s_add_u32 s99, s95, 256
    v_mfma_f32_16x16x32_bf16 v[132:135], a[180:183], a[116:119], v[132:135]
    ds_read_b64_tr_b16 a[194:195], v16 offset:4768
    s_add_u32 m0, s31, 4096
    v_mfma_f32_16x16x32_bf16 v[136:139], a[176:179], a[104:107], 0
    v_mul_u32_u24 v47, 1152-288, v47
    v_lshl_add_u32 v47, v49, 4, v47
    v_mfma_f32_16x16x32_bf16 v[136:139], a[180:183], a[120:123], v[136:139]
    ds_read_b64_tr_b16 a[196:197], v16 offset:9376
    v_add_u32 v28, s100, v47
    v_mfma_f32_16x16x32_bf16 v[140:143], a[176:179], a[108:111], 0
    v_add_u32 v49, 64, v49
    v_mul_u32_u24 v47, 3641, v49
    v_mfma_f32_16x16x32_bf16 v[140:143], a[180:183], a[124:127], v[140:143]
    s_waitcnt lgkmcnt(3)
    ds_read_b64_tr_b16 a[198:199], v16 offset:13984
    v_mfma_f32_16x16x32_bf16 a[64:67], a[184:187], a[96:99], 0
    buffer_load_dwordx4 v12, s[12:15], s99 offen lds
    s_add_u32 m0, s31, 5120
    v_mfma_f32_16x16x32_bf16 a[64:67], a[188:191], a[112:115], a[64:67]
    ds_read_b64_tr_b16 a[200:201], v16 offset:18592
    v_lshrrev_b32 v47, 16, v47
    v_mfma_f32_16x16x32_bf16 a[68:71], a[184:187], a[100:103], 0
    v_mul_u32_u24 v47, 1152-288, v47
    v_lshl_add_u32 v47, v49, 4, v47
    v_mfma_f32_16x16x32_bf16 a[68:71], a[188:191], a[116:119], a[68:71]
    ds_read_b64_tr_b16 a[202:203], v16 offset:23200
    v_add_u32 v29, s100, v47
    v_mfma_f32_16x16x32_bf16 a[72:75], a[184:187], a[104:107], 0
    v_add_u32 v49, 64, v49
    v_mul_u32_u24 v47, 3641, v49
    v_mfma_f32_16x16x32_bf16 a[72:75], a[188:191], a[120:123], a[72:75]
    ds_read_b64_tr_b16 a[204:205], v16 offset:27808
    v_lshrrev_b32 v47, 16, v47
    v_mfma_f32_16x16x32_bf16 a[76:79], a[184:187], a[108:111], 0
    buffer_load_dwordx4 v13, s[12:15], s99 offen lds
    s_add_u32 s99, s96, 256
    v_mfma_f32_16x16x32_bf16 a[76:79], a[188:191], a[124:127], a[76:79]
    s_waitcnt lgkmcnt(3)
    ds_read_b64_tr_b16 a[206:207], v16 offset:32416
    v_mfma_f32_16x16x32_bf16 v[144:147], a[192:195], a[96:99], 0
    s_add_u32 m0, s31, 6144
    v_mul_u32_u24 v47, 1152-288, v47
    v_lshl_add_u32 v47, v49, 4, v47
    v_mfma_f32_16x16x32_bf16 v[144:147], a[196:199], a[112:115], v[144:147]
    ds_read_b64_tr_b16 a[160:161], v16 offset:192
    v_add_u32 v30, s100, v47
    v_mfma_f32_16x16x32_bf16 v[148:151], a[192:195], a[100:103], 0
    v_add_u32 v49, 64, v49
    v_mul_u32_u24 v47, 3641, v49
    v_mfma_f32_16x16x32_bf16 v[148:151], a[196:199], a[116:119], v[148:151]
    ds_read_b64_tr_b16 a[162:163], v16 offset:4800
    v_lshrrev_b32 v47, 16, v47
    v_mfma_f32_16x16x32_bf16 v[152:155], a[192:195], a[104:107], 0
    buffer_load_dwordx4 v12, s[12:15], s99 offen lds
    s_add_u32 m0, s31, 7168
    v_mfma_f32_16x16x32_bf16 v[152:155], a[196:199], a[120:123], v[152:155]
    ds_read_b64_tr_b16 a[164:165], v16 offset:9408
    v_mul_u32_u24 v47, 1152-288, v47
    v_mfma_f32_16x16x32_bf16 v[156:159], a[192:195], a[108:111], 0
    v_lshl_add_u32 v47, v49, 4, v47
    v_add_u32 v31, s100, v47
    v_mfma_f32_16x16x32_bf16 v[156:159], a[196:199], a[124:127], v[156:159]
    s_waitcnt lgkmcnt(3)
    ds_read_b64_tr_b16 a[166:167], v16 offset:14016
    v_mfma_f32_16x16x32_bf16 a[80:83], a[200:203], a[96:99], 0
    buffer_load_dwordx4 v13, s[12:15], s99 offen lds
    s_waitcnt vmcnt(23)
    v_mfma_f32_16x16x32_bf16 a[80:83], a[204:207], a[112:115], a[80:83]
    ds_read_b64_tr_b16 a[168:169], v16 offset:18624
    v_add_u32 v49, 64, v49
    v_mfma_f32_16x16x32_bf16 a[84:87], a[200:203], a[100:103], 0
    ds_read_b128 a[128:131], v62 offset:0
    v_mul_u32_u24 v47, 3641, v49
    v_mfma_f32_16x16x32_bf16 a[84:87], a[204:207], a[116:119], a[84:87]
    ds_read_b64_tr_b16 a[170:171], v16 offset:23232
    v_lshrrev_b32 v47, 16, v47
    v_mfma_f32_16x16x32_bf16 a[88:91], a[200:203], a[104:107], 0
    ds_read_b128 a[144:147], v63 offset:0
    s_waitcnt vmcnt(21)
    v_mfma_f32_16x16x32_bf16 a[88:91], a[204:207], a[120:123], a[88:91]
    ds_read_b64_tr_b16 a[172:173], v16 offset:27840
    v_mul_u32_u24 v47, 1152-288, v47
    v_mfma_f32_16x16x32_bf16 a[92:95], a[200:203], a[108:111], 0
    ds_read_b128 a[132:135], v62 offset:2048
    v_lshl_add_u32 v47, v49, 4, v47
    v_mfma_f32_16x16x32_bf16 a[92:95], a[204:207], a[124:127], a[92:95]
    s_waitcnt lgkmcnt(6)
    ds_read_b64_tr_b16 a[174:175], v16 offset:32448
    v_mfma_f32_16x16x32_bf16 v[160:163], a[160:163], a[96:99], 0
    ds_read_b128 a[148:151], v63 offset:2048
    s_waitcnt vmcnt(19)
    v_mfma_f32_16x16x32_bf16 v[160:163], a[164:167], a[112:115], v[160:163]
    ds_read_b64_tr_b16 a[176:177], v16 offset:224
    v_add_u32 v32, s100, v47
    v_mfma_f32_16x16x32_bf16 v[164:167], a[160:163], a[100:103], 0
    ds_read_b128 a[136:139], v62 offset:4096
    s_mov_b32 s4, s10
    v_mfma_f32_16x16x32_bf16 v[164:167], a[164:167], a[116:119], v[164:167]
    ds_read_b64_tr_b16 a[178:179], v16 offset:4832
    s_mov_b32 s5, s11
    v_mfma_f32_16x16x32_bf16 v[168:171], a[160:163], a[104:107], 0
    ds_read_b128 a[152:155], v63 offset:4096
    s_waitcnt vmcnt(17)
    v_mfma_f32_16x16x32_bf16 v[168:171], a[164:167], a[120:123], v[168:171]
    ds_read_b64_tr_b16 a[180:181], v16 offset:9440
    s_mov_b32 s6, 4608
    v_mfma_f32_16x16x32_bf16 v[172:175], a[160:163], a[108:111], 0
    ds_read_b128 a[140:143], v62 offset:6144
    s_mov_b32 s7, 0x20000
    v_mfma_f32_16x16x32_bf16 v[172:175], a[164:167], a[124:127], v[172:175]
    s_waitcnt lgkmcnt(7)
    ds_read_b64_tr_b16 a[182:183], v16 offset:14048
    v_mfma_f32_16x16x32_bf16 v[208:211], a[168:171], a[96:99], 0
    ds_read_b128 a[156:159], v63 offset:6144
    s_waitcnt lgkmcnt(0)
    v_mfma_f32_16x16x32_bf16 v[208:211], a[172:175], a[112:115], v[208:211]
    ds_read_b64_tr_b16 a[184:185], v16 offset:18656
    s_add_u32 m0, s84, 73728
    v_mfma_f32_16x16x32_bf16 v[212:215], a[168:171], a[100:103], 0
    buffer_load_dwordx4 v3, s[16:19], s29 offen lds
    s_add_u32 m0, s85, 73728
    v_mfma_f32_16x16x32_bf16 v[212:215], a[172:175], a[116:119], v[212:215]
    ds_read_b64_tr_b16 a[186:187], v16 offset:23264
    s_lshl_b32 s98, s24, 4
    v_mfma_f32_16x16x32_bf16 v[216:219], a[168:171], a[104:107], 0
    s_add_u32 s98, s98, s42
    v_add_u32 v49, s98, v46
    v_lshlrev_b32 v33, 3, v49
    v_mfma_f32_16x16x32_bf16 v[216:219], a[172:175], a[120:123], v[216:219]
    ds_read_b64_tr_b16 a[188:189], v16 offset:27872
    v_lshlrev_b32 v20, 6, v49
    v_mfma_f32_16x16x32_bf16 v[220:223], a[168:171], a[108:111], 0
    buffer_load_dwordx4 v4, s[16:19], s29 offen lds
    s_add_u32 m0, s86, 73728
    v_mfma_f32_16x16x32_bf16 v[220:223], a[172:175], a[124:127], v[220:223]
    ds_read_b64_tr_b16 a[190:191], v16 offset:32480
    v_lshl_add_u32 v20, v48, 4, v20
    v_mfma_f32_16x16x32_bf16 v[176:179], a[176:179], a[96:99], 0
    s_mul_i32 s98, s43, 1156
    s_add_u32 s98, s98, 19922944
    v_add_u32 v20, s98, v20
    v_mfma_f32_16x16x32_bf16 v[176:179], a[180:183], a[112:115], v[176:179]
    ds_read_b64_tr_b16 a[192:193], v16 offset:256
    s_cmp_eq_u32 s24, 0
    s_mov_b32 s42, 2147483632
    s_cselect_b32 s42, 8192, s42
    v_mfma_f32_16x16x32_bf16 v[180:183], a[176:179], a[100:103], 0
    buffer_load_dwordx4 v5, s[16:19], s29 offen lds
    s_add_u32 m0, s87, 73728
    v_mfma_f32_16x16x32_bf16 v[180:183], a[180:183], a[116:119], v[180:183]
    ds_read_b64_tr_b16 a[194:195], v16 offset:4864
    s_mov_b32 s43, 4096
    v_mfma_f32_16x16x32_bf16 v[184:187], a[176:179], a[104:107], 0
    s_mov_b32 s8, s52
    s_mov_b32 s9, s53
    s_mov_b32 s11, 0x20000
    v_mfma_f32_16x16x32_bf16 v[184:187], a[180:183], a[120:123], v[184:187]
    ds_read_b64_tr_b16 a[196:197], v16 offset:9472
    s_cmp_eq_u32 s24, 3
    s_cselect_b32 s35, 19, 0
    s_cselect_b32 s36, 1, 0
    v_mfma_f32_16x16x32_bf16 v[188:191], a[176:179], a[108:111], 0
    buffer_load_dwordx4 v6, s[16:19], s29 offen lds
    s_add_u32 m0, s88, 73728
    v_mfma_f32_16x16x32_bf16 v[188:191], a[180:183], a[124:127], v[188:191]
    s_waitcnt lgkmcnt(3)
    ds_read_b64_tr_b16 a[198:199], v16 offset:14080
    v_mfma_f32_16x16x32_bf16 v[224:227], a[184:187], a[96:99], 0
    v_mfma_f32_16x16x32_bf16 v[224:227], a[188:191], a[112:115], v[224:227]
    ds_read_b64_tr_b16 a[200:201], v16 offset:18688
    v_mfma_f32_16x16x32_bf16 v[228:231], a[184:187], a[100:103], 0
    buffer_load_dwordx4 v7, s[16:19], s29 offen lds
    s_add_u32 m0, s89, 73728
    v_mfma_f32_16x16x32_bf16 v[228:231], a[188:191], a[116:119], v[228:231]
    ds_read_b64_tr_b16 a[202:203], v16 offset:23296
    v_mfma_f32_16x16x32_bf16 v[232:235], a[184:187], a[104:107], 0
    v_mfma_f32_16x16x32_bf16 v[232:235], a[188:191], a[120:123], v[232:235]
    ds_read_b64_tr_b16 a[204:205], v16 offset:27904
    v_mfma_f32_16x16x32_bf16 v[236:239], a[184:187], a[108:111], 0
    buffer_load_dwordx4 v8, s[16:19], s29 offen lds
    s_add_u32 m0, s90, 73728
    v_mfma_f32_16x16x32_bf16 v[236:239], a[188:191], a[124:127], v[236:239]
    s_waitcnt lgkmcnt(3)
    ds_read_b64_tr_b16 a[206:207], v16 offset:32512
    v_mfma_f32_16x16x32_bf16 v[192:195], a[192:195], a[96:99], 0
    v_mfma_f32_16x16x32_bf16 v[192:195], a[196:199], a[112:115], v[192:195]
    v_mfma_f32_16x16x32_bf16 v[196:199], a[192:195], a[100:103], 0
    buffer_load_dwordx4 v9, s[16:19], s29 offen lds
    s_add_u32 m0, s91, 73728
    v_mfma_f32_16x16x32_bf16 v[196:199], a[196:199], a[116:119], v[196:199]
    s_waitcnt lgkmcnt(0)
    s_waitcnt vmcnt(15)
    s_barrier
    v_mfma_f32_16x16x32_bf16 v[200:203], a[192:195], a[104:107], 0
    ds_read_b64_tr_b16 a[160:161], v17 offset:0
    v_mfma_f32_16x16x32_bf16 v[200:203], a[196:199], a[120:123], v[200:203]
    ds_read_b64_tr_b16 a[162:163], v17 offset:4608
    v_mfma_f32_16x16x32_bf16 v[204:207], a[192:195], a[108:111], 0
    ds_read_b64_tr_b16 a[164:165], v17 offset:9216
    v_mfma_f32_16x16x32_bf16 v[204:207], a[196:199], a[124:127], v[204:207]
    ds_read_b64_tr_b16 a[166:167], v17 offset:13824
    v_mfma_f32_16x16x32_bf16 v[240:243], a[200:203], a[96:99], 0
    buffer_load_dwordx4 v10, s[16:19], s29 offen lds
    s_add_u32 m0, s92, 73728
    v_mfma_f32_16x16x32_bf16 v[240:243], a[204:207], a[112:115], v[240:243]
    ds_read_b64_tr_b16 a[168:169], v17 offset:18432
    v_mfma_f32_16x16x32_bf16 v[244:247], a[200:203], a[100:103], 0
    v_mfma_f32_16x16x32_bf16 v[244:247], a[204:207], a[116:119], v[244:247]
    ds_read_b64_tr_b16 a[170:171], v17 offset:23040
    v_mfma_f32_16x16x32_bf16 v[248:251], a[200:203], a[104:107], 0
    buffer_load_dwordx4 v11, s[16:19], s29 offen lds
    s_add_u32 s29, s29, 64*9216
    v_mfma_f32_16x16x32_bf16 v[248:251], a[204:207], a[120:123], v[248:251]
    ds_read_b64_tr_b16 a[172:173], v17 offset:27648
    v_mfma_f32_16x16x32_bf16 v[252:255], a[200:203], a[108:111], 0
    v_mfma_f32_16x16x32_bf16 v[252:255], a[204:207], a[124:127], v[252:255]
    s_waitcnt lgkmcnt(3)
    ds_read_b64_tr_b16 a[174:175], v17 offset:32256
    v_mfma_f32_16x16x32_bf16 v[64:67], a[160:163], a[128:131], v[64:67]
    s_waitcnt vmcnt(15)
    ds_read_b128 a[96:99], v14 offset:0
    v_mfma_f32_16x16x32_bf16 v[64:67], a[164:167], a[144:147], v[64:67]
    ds_read_b64_tr_b16 a[176:177], v17 offset:32
    s_mov_b32 s10, 256
    v_mfma_f32_16x16x32_bf16 v[68:71], a[160:163], a[132:135], v[68:71]
    ds_read_b128 a[112:115], v15 offset:0
    s_add_u32 m0, s84, 0
    v_mfma_f32_16x16x32_bf16 v[68:71], a[164:167], a[148:151], v[68:71]
    ds_read_b64_tr_b16 a[178:179], v17 offset:4640
    v_mfma_f32_16x16x32_bf16 v[72:75], a[160:163], a[136:139], v[72:75]
    s_cmp_lt_u32 s41, 77824
    s_cbranch_scc0 L_sz_2
    s_mov_b64 exec, 1
    buffer_atomic_add v45, v44, s[8:11], 0 offen sc1
    s_mov_b64 exec, -1
L_sz_2:
    s_lshl_b32 s10, s36, 2
    v_mfma_f32_16x16x32_bf16 v[72:75], a[164:167], a[152:155], v[72:75]
    ds_read_b64_tr_b16 a[180:181], v17 offset:9248
    v_xor_b32 v49, s3, v48
    v_mfma_f32_16x16x32_bf16 v[76:79], a[160:163], a[140:143], v[76:79]
    v_and_b32 v49, 1, v49
    v_mul_u32_u24 v49, 148480, v49
    v_mfma_f32_16x16x32_bf16 v[76:79], a[164:167], a[156:159], v[76:79]
    s_waitcnt lgkmcnt(5)
    ds_read_b64_tr_b16 a[182:183], v17 offset:13856
    v_mfma_f32_16x16x32_bf16 a[0:3], a[168:171], a[128:131], a[0:3]
    buffer_load_dwordx4 v3, s[16:19], s29 offen lds
    v_lshrrev_b32 v51, 1, v48
    v_mfma_f32_16x16x32_bf16 a[0:3], a[172:175], a[144:147], a[0:3]
    ds_read_b64_tr_b16 a[184:185], v17 offset:18464
    v_lshl_add_u32 v49, v51, 8, v49
    v_mfma_f32_16x16x32_bf16 a[4:7], a[168:171], a[132:135], a[4:7]
    v_lshl_add_u32 v19, v46, 4, v49
    s_lshr_b32 s98, s25, 6
    v_mfma_f32_16x16x32_bf16 a[4:7], a[172:175], a[148:151], a[4:7]
    ds_read_b64_tr_b16 a[186:187], v17 offset:23072
    s_lshl_b32 s98, s98, 9
    v_mfma_f32_16x16x32_bf16 a[8:11], a[168:171], a[136:139], a[8:11]
    buffer_load_dwordx2 v[22:23], v33, s[4:7], 0 offen offset:0
    s_waitcnt lgkmcnt(5)
    v_mfma_f32_16x16x32_bf16 a[8:11], a[172:175], a[152:155], a[8:11]
    ds_read_b64_tr_b16 a[188:189], v17 offset:27680
    s_add_u32 s99, s93, 384
    v_mfma_f32_16x16x32_bf16 a[12:15], a[168:171], a[140:143], a[12:15]
    s_add_u32 m0, s31, 0
    s_lshr_b32 s27, s37, 3
    s_lshl_b32 s27, s27, 7
    v_mfma_f32_16x16x32_bf16 a[12:15], a[172:175], a[156:159], a[12:15]
    s_waitcnt lgkmcnt(3)
    ds_read_b64_tr_b16 a[190:191], v17 offset:32288
    v_mfma_f32_16x16x32_bf16 v[80:83], a[176:179], a[128:131], v[80:83]
    buffer_load_dwordx4 v12, s[12:15], s99 offen lds
    s_add_u32 m0, s31, 1024
    v_mfma_f32_16x16x32_bf16 v[80:83], a[180:183], a[144:147], v[80:83]
    ds_read_b64_tr_b16 a[192:193], v17 offset:64
    s_add_u32 s27, s27, s98
    v_mfma_f32_16x16x32_bf16 v[84:87], a[176:179], a[132:135], v[84:87]
    s_and_b32 s98, s37, 7
    s_lshl_b32 s98, s98, 2
    s_add_u32 s27, s27, s98
    v_mfma_f32_16x16x32_bf16 v[84:87], a[180:183], a[148:151], v[84:87]
    ds_read_b64_tr_b16 a[194:195], v17 offset:4672
    s_add_u32 s27, s27, 24864768
    v_mfma_f32_16x16x32_bf16 v[88:91], a[176:179], a[136:139], v[88:91]
    buffer_load_dwordx4 v13, s[12:15], s99 offen lds
    s_lshr_b32 s37, s25, 4
    v_mfma_f32_16x16x32_bf16 v[88:91], a[180:183], a[152:155], v[88:91]
    ds_read_b64_tr_b16 a[196:197], v17 offset:9280
    s_mul_i32 s37, s37, 148480
    v_mfma_f32_16x16x32_bf16 v[92:95], a[176:179], a[140:143], v[92:95]
    s_lshl_b32 s38, s26, 5
    s_add_u32 s37, s37, s38
    s_and_b32 s38, s3, 2
    v_mfma_f32_16x16x32_bf16 v[92:95], a[180:183], a[156:159], v[92:95]
    s_waitcnt lgkmcnt(3)
    ds_read_b64_tr_b16 a[198:199], v17 offset:13888
    v_mfma_f32_16x16x32_bf16 a[16:19], a[184:187], a[128:131], a[16:19]
    buffer_load_dwordx2 v[24:25], v33, s[4:7], 0 offen offset:512
    s_add_u32 m0, s85, 0
    v_mfma_f32_16x16x32_bf16 a[16:19], a[188:191], a[144:147], a[16:19]
    ds_read_b64_tr_b16 a[200:201], v17 offset:18496
    s_xor_b32 s39, s38, 2
    v_mfma_f32_16x16x32_bf16 a[20:23], a[184:187], a[132:135], a[20:23]
    s_mul_i32 s38, s38, 148480
    s_mul_i32 s39, s39, 148480
    s_add_u32 s39, s39, s37
    v_mfma_f32_16x16x32_bf16 a[20:23], a[188:191], a[148:151], a[20:23]
    ds_read_b64_tr_b16 a[202:203], v17 offset:23104
    s_add_u32 s37, s37, s38
    v_mfma_f32_16x16x32_bf16 a[24:27], a[184:187], a[136:139], a[24:27]
    s_add_u32 s38, s37, 4096
    s_add_u32 s40, s39, 4096
    s_mov_b32 s32, 0xbfb8aa3b
    v_mfma_f32_16x16x32_bf16 a[24:27], a[188:191], a[152:155], a[24:27]
    ds_read_b64_tr_b16 a[204:205], v17 offset:27712
    v_mfma_f32_16x16x32_bf16 a[28:31], a[184:187], a[140:143], a[28:31]
    buffer_load_dwordx4 v4, s[16:19], s29 offen lds
    s_waitcnt vmcnt(19)
    v_mfma_f32_16x16x32_bf16 a[28:31], a[188:191], a[156:159], a[28:31]
    s_waitcnt lgkmcnt(3)
    ds_read_b64_tr_b16 a[206:207], v17 offset:32320
    v_mfma_f32_16x16x32_bf16 v[96:99], a[192:195], a[128:131], v[96:99]
    ds_read_b128 a[100:103], v14 offset:2048
    v_mfma_f32_16x16x32_bf16 v[96:99], a[196:199], a[144:147], v[96:99]
    ds_read_b64_tr_b16 a[160:161], v17 offset:96
    v_mfma_f32_16x16x32_bf16 v[100:103], a[192:195], a[132:135], v[100:103]
    ds_read_b128 a[116:119], v15 offset:2048
    s_add_u32 m0, s86, 0
    v_mfma_f32_16x16x32_bf16 v[100:103], a[196:199], a[148:151], v[100:103]
    ds_read_b64_tr_b16 a[162:163], v17 offset:4704
    v_mfma_f32_16x16x32_bf16 v[104:107], a[192:195], a[136:139], v[104:107]
    buffer_load_dwordx4 v5, s[16:19], s29 offen lds
    v_mfma_f32_16x16x32_bf16 v[104:107], a[196:199], a[152:155], v[104:107]
    ds_read_b64_tr_b16 a[164:165], v17 offset:9312
    v_mfma_f32_16x16x32_bf16 v[108:111], a[192:195], a[140:143], v[108:111]
    v_mfma_f32_16x16x32_bf16 v[108:111], a[196:199], a[156:159], v[108:111]
    s_waitcnt lgkmcnt(5)
    ds_read_b64_tr_b16 a[166:167], v17 offset:13920
    v_mfma_f32_16x16x32_bf16 a[32:35], a[200:203], a[128:131], a[32:35]
    buffer_load_dwordx2 v[26:27], v33, s[4:7], 0 offen offset:1024
    s_waitcnt lgkmcnt(3)
    v_mfma_f32_16x16x32_bf16 a[32:35], a[204:207], a[144:147], a[32:35]
    ds_read_b64_tr_b16 a[168:169], v17 offset:18528
    s_add_u32 s99, s94, 384
    v_mfma_f32_16x16x32_bf16 a[36:39], a[200:203], a[132:135], a[36:39]
    s_add_u32 m0, s31, 2048
    v_mfma_f32_16x16x32_bf16 a[36:39], a[204:207], a[148:151], a[36:39]
    ds_read_b64_tr_b16 a[170:171], v17 offset:23136
    v_mfma_f32_16x16x32_bf16 a[40:43], a[200:203], a[136:139], a[40:43]
    v_mfma_f32_16x16x32_bf16 a[40:43], a[204:207], a[152:155], a[40:43]
    ds_read_b64_tr_b16 a[172:173], v17 offset:27744
    v_mfma_f32_16x16x32_bf16 a[44:47], a[200:203], a[140:143], a[44:47]
    buffer_load_dwordx4 v12, s[12:15], s99 offen lds
    s_add_u32 m0, s31, 3072
    v_mfma_f32_16x16x32_bf16 a[44:47], a[204:207], a[156:159], a[44:47]
    s_waitcnt lgkmcnt(3)
    ds_read_b64_tr_b16 a[174:175], v17 offset:32352
    v_mfma_f32_16x16x32_bf16 v[112:115], a[160:163], a[128:131], v[112:115]
    v_mfma_f32_16x16x32_bf16 v[112:115], a[164:167], a[144:147], v[112:115]
    ds_read_b64_tr_b16 a[176:177], v17 offset:128
    v_mfma_f32_16x16x32_bf16 v[116:119], a[160:163], a[132:135], v[116:119]
    buffer_load_dwordx4 v13, s[12:15], s99 offen lds
    s_add_u32 m0, s28, 0
    v_mfma_f32_16x16x32_bf16 v[116:119], a[164:167], a[148:151], v[116:119]
    ds_read_b64_tr_b16 a[178:179], v17 offset:4736
    v_mfma_f32_16x16x32_bf16 v[120:123], a[160:163], a[136:139], v[120:123]
    v_mfma_f32_16x16x32_bf16 v[120:123], a[164:167], a[152:155], v[120:123]
    ds_read_b64_tr_b16 a[180:181], v17 offset:9344
    v_mfma_f32_16x16x32_bf16 v[124:127], a[160:163], a[140:143], v[124:127]
    v_mfma_f32_16x16x32_bf16 v[124:127], a[164:167], a[156:159], v[124:127]
    s_waitcnt lgkmcnt(3)
    ds_read_b64_tr_b16 a[182:183], v17 offset:13952
    v_mfma_f32_16x16x32_bf16 a[48:51], a[168:171], a[128:131], a[48:51]
    buffer_load_dwordx4 v28, s[56:59], 0 offen lds
    s_add_u32 m0, s87, 0
    v_mfma_f32_16x16x32_bf16 a[48:51], a[172:175], a[144:147], a[48:51]
    ds_read_b64_tr_b16 a[184:185], v17 offset:18560
    v_mfma_f32_16x16x32_bf16 a[52:55], a[168:171], a[132:135], a[52:55]
    v_mfma_f32_16x16x32_bf16 a[52:55], a[172:175], a[148:151], a[52:55]
    ds_read_b64_tr_b16 a[186:187], v17 offset:23168
    v_mfma_f32_16x16x32_bf16 a[56:59], a[168:171], a[136:139], a[56:59]
    v_mfma_f32_16x16x32_bf16 a[56:59], a[172:175], a[152:155], a[56:59]
    ds_read_b64_tr_b16 a[188:189], v17 offset:27776
    v_mfma_f32_16x16x32_bf16 a[60:63], a[168:171], a[140:143], a[60:63]
    buffer_load_dwordx4 v6, s[16:19], s29 offen lds
    s_waitcnt vmcnt(23)
    v_mfma_f32_16x16x32_bf16 a[60:63], a[172:175], a[156:159], a[60:63]
    s_waitcnt lgkmcnt(3)
    ds_read_b64_tr_b16 a[190:191], v17 offset:32384
    v_mfma_f32_16x16x32_bf16 v[128:131], a[176:179], a[128:131], v[128:131]
    ds_read_b128 a[104:107], v14 offset:4096
    v_mfma_f32_16x16x32_bf16 v[128:131], a[180:183], a[144:147], v[128:131]
    ds_read_b64_tr_b16 a[192:193], v17 offset:160
    v_mfma_f32_16x16x32_bf16 v[132:135], a[176:179], a[132:135], v[132:135]
    ds_read_b128 a[120:123], v15 offset:4096
    s_add_u32 m0, s88, 0
    v_mfma_f32_16x16x32_bf16 v[132:135], a[180:183], a[148:151], v[132:135]
    ds_read_b64_tr_b16 a[194:195], v17 offset:4768
    v_mfma_f32_16x16x32_bf16 v[136:139], a[176:179], a[136:139], v[136:139]
    buffer_load_dwordx4 v7, s[16:19], s29 offen lds
    s_add_u32 m0, s28, 1024
    v_mfma_f32_16x16x32_bf16 v[136:139], a[180:183], a[152:155], v[136:139]
    ds_read_b64_tr_b16 a[196:197], v17 offset:9376
    v_mfma_f32_16x16x32_bf16 v[140:143], a[176:179], a[140:143], v[140:143]
    v_mfma_f32_16x16x32_bf16 v[140:143], a[180:183], a[156:159], v[140:143]
    s_waitcnt lgkmcnt(5)
    ds_read_b64_tr_b16 a[198:199], v17 offset:13984
    v_mfma_f32_16x16x32_bf16 a[64:67], a[184:187], a[128:131], a[64:67]
    buffer_load_dwordx4 v29, s[56:59], 0 offen lds
    s_waitcnt lgkmcnt(3)
    v_mfma_f32_16x16x32_bf16 a[64:67], a[188:191], a[144:147], a[64:67]
    ds_read_b64_tr_b16 a[200:201], v17 offset:18592
    s_add_u32 s99, s95, 384
    v_mfma_f32_16x16x32_bf16 a[68:71], a[184:187], a[132:135], a[68:71]
    s_add_u32 m0, s31, 4096
    v_mfma_f32_16x16x32_bf16 a[68:71], a[188:191], a[148:151], a[68:71]
    ds_read_b64_tr_b16 a[202:203], v17 offset:23200
    v_mfma_f32_16x16x32_bf16 a[72:75], a[184:187], a[136:139], a[72:75]
    v_mfma_f32_16x16x32_bf16 a[72:75], a[188:191], a[152:155], a[72:75]
    ds_read_b64_tr_b16 a[204:205], v17 offset:27808
    v_mfma_f32_16x16x32_bf16 a[76:79], a[184:187], a[140:143], a[76:79]
    buffer_load_dwordx4 v12, s[12:15], s99 offen lds
    s_add_u32 m0, s31, 5120
    v_mfma_f32_16x16x32_bf16 a[76:79], a[188:191], a[156:159], a[76:79]
    s_waitcnt lgkmcnt(3)
    ds_read_b64_tr_b16 a[206:207], v17 offset:32416
    v_mfma_f32_16x16x32_bf16 v[144:147], a[192:195], a[128:131], v[144:147]
    v_mfma_f32_16x16x32_bf16 v[144:147], a[196:199], a[144:147], v[144:147]
    ds_read_b64_tr_b16 a[160:161], v17 offset:192
    v_mfma_f32_16x16x32_bf16 v[148:151], a[192:195], a[132:135], v[148:151]
    v_mfma_f32_16x16x32_bf16 v[148:151], a[196:199], a[148:151], v[148:151]
    ds_read_b64_tr_b16 a[162:163], v17 offset:4800
    v_mfma_f32_16x16x32_bf16 v[152:155], a[192:195], a[136:139], v[152:155]
    buffer_load_dwordx4 v13, s[12:15], s99 offen lds
    v_mfma_f32_16x16x32_bf16 v[152:155], a[196:199], a[152:155], v[152:155]
    ds_read_b64_tr_b16 a[164:165], v17 offset:9408
    v_mfma_f32_16x16x32_bf16 v[156:159], a[192:195], a[140:143], v[156:159]
    v_mfma_f32_16x16x32_bf16 v[156:159], a[196:199], a[156:159], v[156:159]
    s_waitcnt lgkmcnt(3)
    ds_read_b64_tr_b16 a[166:167], v17 offset:14016
    v_mfma_f32_16x16x32_bf16 a[80:83], a[200:203], a[128:131], a[80:83]
    buffer_load_dwordx4 a[208:211], v52, s[44:47], s54 offen
    s_add_u32 s54, s54, 8*1152
    v_mfma_f32_16x16x32_bf16 a[80:83], a[204:207], a[144:147], a[80:83]
    ds_read_b64_tr_b16 a[168:169], v17 offset:18624
    s_add_u32 m0, s89, 0
    v_mfma_f32_16x16x32_bf16 a[84:87], a[200:203], a[132:135], a[84:87]
    v_mfma_f32_16x16x32_bf16 a[84:87], a[204:207], a[148:151], a[84:87]
    ds_read_b64_tr_b16 a[170:171], v17 offset:23232
    v_mfma_f32_16x16x32_bf16 a[88:91], a[200:203], a[136:139], a[88:91]
    v_mfma_f32_16x16x32_bf16 a[88:91], a[204:207], a[152:155], a[88:91]
    ds_read_b64_tr_b16 a[172:173], v17 offset:27840
    v_mfma_f32_16x16x32_bf16 a[92:95], a[200:203], a[140:143], a[92:95]
    buffer_load_dwordx4 v8, s[16:19], s29 offen lds
    s_waitcnt vmcnt(27)
    v_mfma_f32_16x16x32_bf16 a[92:95], a[204:207], a[156:159], a[92:95]
    s_waitcnt lgkmcnt(3)
    ds_read_b64_tr_b16 a[174:175], v17 offset:32448
    v_mfma_f32_16x16x32_bf16 v[160:163], a[160:163], a[128:131], v[160:163]
    ds_read_b128 a[108:111], v14 offset:6144
    v_mfma_f32_16x16x32_bf16 v[160:163], a[164:167], a[144:147], v[160:163]
    ds_read_b64_tr_b16 a[176:177], v17 offset:224
    v_mfma_f32_16x16x32_bf16 v[164:167], a[160:163], a[132:135], v[164:167]
    ds_read_b128 a[124:127], v15 offset:6144
    s_add_u32 m0, s90, 0
    v_mfma_f32_16x16x32_bf16 v[164:167], a[164:167], a[148:151], v[164:167]
    ds_read_b64_tr_b16 a[178:179], v17 offset:4832
    v_mfma_f32_16x16x32_bf16 v[168:171], a[160:163], a[136:139], v[168:171]
    buffer_load_dwordx4 v9, s[16:19], s29 offen lds
    s_add_u32 m0, s28, 2048
    v_mfma_f32_16x16x32_bf16 v[168:171], a[164:167], a[152:155], v[168:171]
    ds_read_b64_tr_b16 a[180:181], v17 offset:9440
    v_mfma_f32_16x16x32_bf16 v[172:175], a[160:163], a[140:143], v[172:175]
    v_mfma_f32_16x16x32_bf16 v[172:175], a[164:167], a[156:159], v[172:175]
    s_waitcnt lgkmcnt(5)
    ds_read_b64_tr_b16 a[182:183], v17 offset:14048
    v_mfma_f32_16x16x32_bf16 v[208:211], a[168:171], a[128:131], v[208:211]
    buffer_load_dwordx4 v30, s[56:59], 0 offen lds
    s_waitcnt lgkmcnt(3)
    v_mfma_f32_16x16x32_bf16 v[208:211], a[172:175], a[144:147], v[208:211]
    ds_read_b64_tr_b16 a[184:185], v17 offset:18656
    s_add_u32 s99, s96, 384
    v_mfma_f32_16x16x32_bf16 v[212:215], a[168:171], a[132:135], v[212:215]
    s_add_u32 m0, s31, 6144
    v_mfma_f32_16x16x32_bf16 v[212:215], a[172:175], a[148:151], v[212:215]
    ds_read_b64_tr_b16 a[186:187], v17 offset:23264
    v_mfma_f32_16x16x32_bf16 v[216:219], a[168:171], a[136:139], v[216:219]
    v_mfma_f32_16x16x32_bf16 v[216:219], a[172:175], a[152:155], v[216:219]
    ds_read_b64_tr_b16 a[188:189], v17 offset:27872
    v_mfma_f32_16x16x32_bf16 v[220:223], a[168:171], a[140:143], v[220:223]
    buffer_load_dwordx4 v12, s[12:15], s99 offen lds
    s_add_u32 m0, s31, 7168
    v_mfma_f32_16x16x32_bf16 v[220:223], a[172:175], a[156:159], v[220:223]
    s_waitcnt lgkmcnt(3)
    ds_read_b64_tr_b16 a[190:191], v17 offset:32480
    v_mfma_f32_16x16x32_bf16 v[176:179], a[176:179], a[128:131], v[176:179]
    v_mfma_f32_16x16x32_bf16 v[176:179], a[180:183], a[144:147], v[176:179]
    ds_read_b64_tr_b16 a[192:193], v17 offset:256
    v_mfma_f32_16x16x32_bf16 v[180:183], a[176:179], a[132:135], v[180:183]
    v_mfma_f32_16x16x32_bf16 v[180:183], a[180:183], a[148:151], v[180:183]
    ds_read_b64_tr_b16 a[194:195], v17 offset:4864
    v_mfma_f32_16x16x32_bf16 v[184:187], a[176:179], a[136:139], v[184:187]
    buffer_load_dwordx4 v13, s[12:15], s99 offen lds
    v_mfma_f32_16x16x32_bf16 v[184:187], a[180:183], a[152:155], v[184:187]
    ds_read_b64_tr_b16 a[196:197], v17 offset:9472
    v_mfma_f32_16x16x32_bf16 v[188:191], a[176:179], a[140:143], v[188:191]
    v_mfma_f32_16x16x32_bf16 v[188:191], a[180:183], a[156:159], v[188:191]
    s_waitcnt lgkmcnt(3)
    ds_read_b64_tr_b16 a[198:199], v17 offset:14080
    v_mfma_f32_16x16x32_bf16 v[224:227], a[184:187], a[128:131], v[224:227]
    s_cmp_lt_u32 s49, 1072693248
    s_cbranch_scc0 L_sk_3
    buffer_load_dwordx4 a[224:227], v52, s[44:47], s48 offen
L_sk_3:
    s_add_u32 s48, s48, 8*1152
    v_mfma_f32_16x16x32_bf16 v[224:227], a[188:191], a[144:147], v[224:227]
    ds_read_b64_tr_b16 a[200:201], v17 offset:18688
    s_add_u32 m0, s91, 0
    v_mfma_f32_16x16x32_bf16 v[228:231], a[184:187], a[132:135], v[228:231]
    v_mfma_f32_16x16x32_bf16 v[228:231], a[188:191], a[148:151], v[228:231]
    ds_read_b64_tr_b16 a[202:203], v17 offset:23296
    v_mfma_f32_16x16x32_bf16 v[232:235], a[184:187], a[136:139], v[232:235]
    v_mfma_f32_16x16x32_bf16 v[232:235], a[188:191], a[152:155], v[232:235]
    ds_read_b64_tr_b16 a[204:205], v17 offset:27904
    v_mfma_f32_16x16x32_bf16 v[236:239], a[184:187], a[140:143], v[236:239]
    buffer_load_dwordx4 v10, s[16:19], s29 offen lds
    s_add_u32 m0, s92, 0
    v_mfma_f32_16x16x32_bf16 v[236:239], a[188:191], a[156:159], v[236:239]
    s_waitcnt lgkmcnt(3)
    ds_read_b64_tr_b16 a[206:207], v17 offset:32512
    v_mfma_f32_16x16x32_bf16 v[192:195], a[192:195], a[128:131], v[192:195]
    v_mfma_f32_16x16x32_bf16 v[192:195], a[196:199], a[144:147], v[192:195]
    v_mfma_f32_16x16x32_bf16 v[196:199], a[192:195], a[132:135], v[196:199]
    v_mfma_f32_16x16x32_bf16 v[196:199], a[196:199], a[148:151], v[196:199]
    s_waitcnt lgkmcnt(0)
    s_waitcnt vmcnt(23)
    s_barrier
    v_mfma_f32_16x16x32_bf16 v[200:203], a[192:195], a[136:139], v[200:203]
    ds_read_b64_tr_b16 a[160:161], v18 offset:0
    v_mfma_f32_16x16x32_bf16 v[200:203], a[196:199], a[152:155], v[200:203]
    ds_read_b64_tr_b16 a[162:163], v18 offset:4608
    v_mfma_f32_16x16x32_bf16 v[204:207], a[192:195], a[140:143], v[204:207]
    ds_read_b64_tr_b16 a[164:165], v18 offset:9216
    v_mfma_f32_16x16x32_bf16 v[204:207], a[196:199], a[156:159], v[204:207]
    ds_read_b64_tr_b16 a[166:167], v18 offset:13824
    v_mfma_f32_16x16x32_bf16 v[240:243], a[200:203], a[128:131], v[240:243]
    buffer_load_dwordx4 v11, s[16:19], s29 offen lds
    s_add_u32 m0, s28, 3072
    v_mfma_f32_16x16x32_bf16 v[240:243], a[204:207], a[144:147], v[240:243]
    ds_read_b64_tr_b16 a[168:169], v18 offset:18432
    v_mfma_f32_16x16x32_bf16 v[244:247], a[200:203], a[132:135], v[244:247]
    v_mfma_f32_16x16x32_bf16 v[244:247], a[204:207], a[148:151], v[244:247]
    ds_read_b64_tr_b16 a[170:171], v18 offset:23040
    v_mfma_f32_16x16x32_bf16 v[248:251], a[200:203], a[136:139], v[248:251]
    buffer_load_dwordx4 v31, s[56:59], 0 offen lds
    s_add_u32 s29, s29, 64*9216
    v_mfma_f32_16x16x32_bf16 v[248:251], a[204:207], a[152:155], v[248:251]
    ds_read_b64_tr_b16 a[172:173], v18 offset:27648
    v_mfma_f32_16x16x32_bf16 v[252:255], a[200:203], a[140:143], v[252:255]
    v_mfma_f32_16x16x32_bf16 v[252:255], a[204:207], a[156:159], v[252:255]
    s_waitcnt lgkmcnt(3)
    ds_read_b64_tr_b16 a[174:175], v18 offset:32256
    v_mfma_f32_16x16x32_bf16 v[64:67], a[160:163], a[96:99], v[64:67]
    buffer_load_dword v63, v12, s[8:11], 0 offen sc1
    s_waitcnt vmcnt(22)
    v_mfma_f32_16x16x32_bf16 v[64:67], a[164:167], a[112:115], v[64:67]
    ds_read_b64_tr_b16 a[176:177], v18 offset:32
    s_lshl_b32 s26, s2, 1
    v_mfma_f32_16x16x32_bf16 v[68:71], a[160:163], a[100:103], v[68:71]
    ds_read_b128 a[128:131], v14 offset:0
    s_add_u32 s26, s26, s24
    v_mfma_f32_16x16x32_bf16 v[68:71], a[164:167], a[116:119], v[68:71]
    ds_read_b64_tr_b16 a[178:179], v18 offset:4640
    s_lshl_b32 s100, s33, 3
    v_mfma_f32_16x16x32_bf16 v[72:75], a[160:163], a[104:107], v[72:75]
    ds_read_b128 a[144:147], v15 offset:0
    s_add_u32 m0, s84, 36864
    v_mfma_f32_16x16x32_bf16 v[72:75], a[164:167], a[120:123], v[72:75]
    ds_read_b64_tr_b16 a[180:181], v18 offset:9248
    s_lshr_b32 s101, s34, 2
    v_mfma_f32_16x16x32_bf16 v[76:79], a[160:163], a[108:111], v[76:79]
    buffer_load_dwordx4 v3, s[16:19], s29 offen lds
    s_add_u32 m0, s28, 4096
    v_mfma_f32_16x16x32_bf16 v[76:79], a[164:167], a[124:127], v[76:79]
    s_waitcnt lgkmcnt(5)
    ds_read_b64_tr_b16 a[182:183], v18 offset:13856
    v_mfma_f32_16x16x32_bf16 a[0:3], a[168:171], a[96:99], a[0:3]
    s_add_u32 s100, s100, s101
    s_add_u32 s100, s100, 512
    s_lshl_b32 s101, s3, 2
    v_mfma_f32_16x16x32_bf16 a[0:3], a[172:175], a[112:115], a[0:3]
    ds_read_b64_tr_b16 a[184:185], v18 offset:18464
    s_add_u32 s101, s101, s24
    v_mfma_f32_16x16x32_bf16 a[4:7], a[168:171], a[100:103], a[4:7]
    buffer_load_dwordx4 v32, s[56:59], 0 offen lds
    s_waitcnt lgkmcnt(3)
    v_mfma_f32_16x16x32_bf16 a[4:7], a[172:175], a[116:119], a[4:7]
    ds_read_b64_tr_b16 a[186:187], v18 offset:23072
    s_add_u32 s99, s93, 512
    v_mfma_f32_16x16x32_bf16 a[8:11], a[168:171], a[104:107], a[8:11]
    s_add_u32 m0, s31, 0
    s_cmp_eq_u32 s101, 2
    s_cselect_b32 s100, s100, 0x1000
    s_cmp_lt_u32 s24, 2
    s_cselect_b32 s26, s26, s100
    s_lshl_b32 s25, s26, 12
    v_mfma_f32_16x16x32_bf16 a[8:11], a[172:175], a[120:123], a[8:11]
    ds_read_b64_tr_b16 a[188:189], v18 offset:27680
    s_cmp_lt_u32 s26, 576
    s_cselect_b32 s6, 4096, 0
    s_cselect_b32 s100, s25, 0
    s_add_u32 s4, s62, s100
    s_addc_u32 s5, s63, 0
    v_mfma_f32_16x16x32_bf16 a[12:15], a[168:171], a[108:111], a[12:15]
    buffer_load_dwordx4 v12, s[12:15], s99 offen lds
    s_add_u32 m0, s31, 1024
    v_mfma_f32_16x16x32_bf16 a[12:15], a[172:175], a[124:127], a[12:15]
    s_waitcnt lgkmcnt(3)
    ds_read_b64_tr_b16 a[190:191], v18 offset:32288
    v_mfma_f32_16x16x32_bf16 v[80:83], a[176:179], a[96:99], v[80:83]
    v_mfma_f32_16x16x32_bf16 v[80:83], a[180:183], a[112:115], v[80:83]
    ds_read_b64_tr_b16 a[192:193], v18 offset:64
    v_mfma_f32_16x16x32_bf16 v[84:87], a[176:179], a[100:103], v[84:87]
    v_mfma_f32_16x16x32_bf16 v[84:87], a[180:183], a[116:119], v[84:87]
    ds_read_b64_tr_b16 a[194:195], v18 offset:4672
    v_mfma_f32_16x16x32_bf16 v[88:91], a[176:179], a[104:107], v[88:91]
    buffer_load_dwordx4 v13, s[12:15], s99 offen lds
    v_mfma_f32_16x16x32_bf16 v[88:91], a[180:183], a[120:123], v[88:91]
    ds_read_b64_tr_b16 a[196:197], v18 offset:9280
    v_mfma_f32_16x16x32_bf16 v[92:95], a[176:179], a[108:111], v[92:95]
    v_mfma_f32_16x16x32_bf16 v[92:95], a[180:183], a[124:127], v[92:95]
    s_waitcnt lgkmcnt(3)
    ds_read_b64_tr_b16 a[198:199], v18 offset:13888
    v_mfma_f32_16x16x32_bf16 a[16:19], a[184:187], a[96:99], a[16:19]
    v_mfma_f32_16x16x32_bf16 a[16:19], a[188:191], a[112:115], a[16:19]
    ds_read_b64_tr_b16 a[200:201], v18 offset:18496
    v_mfma_f32_16x16x32_bf16 a[20:23], a[184:187], a[100:103], a[20:23]
    buffer_load_dwordx4 a[212:215], v52, s[44:47], s54 offen
    s_add_u32 s54, s54, 8*1152
    v_mfma_f32_16x16x32_bf16 a[20:23], a[188:191], a[116:119], a[20:23]
    ds_read_b64_tr_b16 a[202:203], v18 offset:23104
    s_add_u32 m0, s85, 36864
    v_mfma_f32_16x16x32_bf16 a[24:27], a[184:187], a[104:107], a[24:27]
    v_mfma_f32_16x16x32_bf16 a[24:27], a[188:191], a[120:123], a[24:27]
    ds_read_b64_tr_b16 a[204:205], v18 offset:27712
    v_mfma_f32_16x16x32_bf16 a[28:31], a[184:187], a[108:111], a[28:31]
    v_mfma_f32_16x16x32_bf16 a[28:31], a[188:191], a[124:127], a[28:31]
    s_waitcnt lgkmcnt(3)
    ds_read_b64_tr_b16 a[206:207], v18 offset:32320
    v_mfma_f32_16x16x32_bf16 v[96:99], a[192:195], a[96:99], v[96:99]
    buffer_load_dwordx4 v4, s[16:19], s29 offen lds
    s_waitcnt vmcnt(22)
    v_mfma_f32_16x16x32_bf16 v[96:99], a[196:199], a[112:115], v[96:99]
    ds_read_b64_tr_b16 a[160:161], v18 offset:96
    v_mfma_f32_16x16x32_bf16 v[100:103], a[192:195], a[100:103], v[100:103]
    ds_read_b128 a[132:135], v14 offset:2048
    v_mfma_f32_16x16x32_bf16 v[100:103], a[196:199], a[116:119], v[100:103]
    ds_read_b64_tr_b16 a[162:163], v18 offset:4704
    v_mfma_f32_16x16x32_bf16 v[104:107], a[192:195], a[104:107], v[104:107]
    ds_read_b128 a[148:151], v15 offset:2048
    s_add_u32 m0, s86, 36864
    v_mfma_f32_16x16x32_bf16 v[104:107], a[196:199], a[120:123], v[104:107]
    ds_read_b64_tr_b16 a[164:165], v18 offset:9312
    v_mfma_f32_16x16x32_bf16 v[108:111], a[192:195], a[108:111], v[108:111]
    buffer_load_dwordx4 v5, s[16:19], s29 offen lds
    v_mfma_f32_16x16x32_bf16 v[108:111], a[196:199], a[124:127], v[108:111]
    s_waitcnt lgkmcnt(5)
    ds_read_b64_tr_b16 a[166:167], v18 offset:13920
    v_mfma_f32_16x16x32_bf16 a[32:35], a[200:203], a[96:99], a[32:35]
    v_mfma_f32_16x16x32_bf16 a[32:35], a[204:207], a[112:115], a[32:35]
    ds_read_b64_tr_b16 a[168:169], v18 offset:18528
    v_mfma_f32_16x16x32_bf16 a[36:39], a[200:203], a[100:103], a[36:39]
    v_mfma_f32_16x16x32_bf16 a[36:39], a[204:207], a[116:119], a[36:39]
    ds_read_b64_tr_b16 a[170:171], v18 offset:23136
    v_mfma_f32_16x16x32_bf16 a[40:43], a[200:203], a[104:107], a[40:43]
    s_cmp_lt_u32 s49, 1072693248
    s_cbranch_scc0 L_sk_4
    buffer_load_dwordx4 a[228:231], v52, s[44:47], s48 offen
L_sk_4:
    s_add_u32 s48, s48, 8*1152
    v_mfma_f32_16x16x32_bf16 a[40:43], a[204:207], a[120:123], a[40:43]
    ds_read_b64_tr_b16 a[172:173], v18 offset:27744
    s_waitcnt lgkmcnt(5)
    v_mfma_f32_16x16x32_bf16 a[44:47], a[200:203], a[108:111], a[44:47]
    s_add_u32 s99, s94, 512
    s_add_u32 m0, s31, 2048
    v_mfma_f32_16x16x32_bf16 a[44:47], a[204:207], a[124:127], a[44:47]
    s_waitcnt lgkmcnt(3)
    ds_read_b64_tr_b16 a[174:175], v18 offset:32352
    v_mfma_f32_16x16x32_bf16 v[112:115], a[160:163], a[96:99], v[112:115]
    v_mfma_f32_16x16x32_bf16 v[112:115], a[164:167], a[112:115], v[112:115]
    ds_read_b64_tr_b16 a[176:177], v18 offset:128
    v_mfma_f32_16x16x32_bf16 v[116:119], a[160:163], a[100:103], v[116:119]
    buffer_load_dwordx4 v12, s[12:15], s99 offen lds
    s_add_u32 m0, s31, 3072
    v_mfma_f32_16x16x32_bf16 v[116:119], a[164:167], a[116:119], v[116:119]
    ds_read_b64_tr_b16 a[178:179], v18 offset:4736
    v_mfma_f32_16x16x32_bf16 v[120:123], a[160:163], a[104:107], v[120:123]
    v_mfma_f32_16x16x32_bf16 v[120:123], a[164:167], a[120:123], v[120:123]
    ds_read_b64_tr_b16 a[180:181], v18 offset:9344
    v_mfma_f32_16x16x32_bf16 v[124:127], a[160:163], a[108:111], v[124:127]
    v_mfma_f32_16x16x32_bf16 v[124:127], a[164:167], a[124:127], v[124:127]
    s_waitcnt lgkmcnt(3)
    ds_read_b64_tr_b16 a[182:183], v18 offset:13952
    v_mfma_f32_16x16x32_bf16 a[48:51], a[168:171], a[96:99], a[48:51]
    buffer_load_dwordx4 v13, s[12:15], s99 offen lds
    v_mfma_f32_16x16x32_bf16 a[48:51], a[172:175], a[112:115], a[48:51]
    ds_read_b64_tr_b16 a[184:185], v18 offset:18560
    v_mfma_f32_16x16x32_bf16 a[52:55], a[168:171], a[100:103], a[52:55]
    v_mfma_f32_16x16x32_bf16 a[52:55], a[172:175], a[116:119], a[52:55]
    ds_read_b64_tr_b16 a[186:187], v18 offset:23168
    v_mfma_f32_16x16x32_bf16 a[56:59], a[168:171], a[104:107], a[56:59]
    v_mfma_f32_16x16x32_bf16 a[56:59], a[172:175], a[120:123], a[56:59]
    ds_read_b64_tr_b16 a[188:189], v18 offset:27776
    v_mfma_f32_16x16x32_bf16 a[60:63], a[168:171], a[108:111], a[60:63]
    buffer_load_dwordx4 a[216:219], v52, s[44:47], s54 offen
    s_add_u32 s54, s54, 8*1152
    v_mfma_f32_16x16x32_bf16 a[60:63], a[172:175], a[124:127], a[60:63]
    s_waitcnt lgkmcnt(3)
    ds_read_b64_tr_b16 a[190:191], v18 offset:32384
    v_mfma_f32_16x16x32_bf16 v[128:131], a[176:179], a[96:99], v[128:131]
    s_add_u32 m0, s87, 36864
    v_mfma_f32_16x16x32_bf16 v[128:131], a[180:183], a[112:115], v[128:131]
    ds_read_b64_tr_b16 a[192:193], v18 offset:160
    v_mfma_f32_16x16x32_bf16 v[132:135], a[176:179], a[100:103], v[132:135]
    buffer_load_dwordx4 v6, s[16:19], s29 offen lds
    s_waitcnt vmcnt(21)
    v_mfma_f32_16x16x32_bf16 v[132:135], a[180:183], a[116:119], v[132:135]
    ds_read_b64_tr_b16 a[194:195], v18 offset:4768
    v_mfma_f32_16x16x32_bf16 v[136:139], a[176:179], a[104:107], v[136:139]
    ds_read_b128 a[136:139], v14 offset:4096
    v_mfma_f32_16x16x32_bf16 v[136:139], a[180:183], a[120:123], v[136:139]
    ds_read_b64_tr_b16 a[196:197], v18 offset:9376
    v_mfma_f32_16x16x32_bf16 v[140:143], a[176:179], a[108:111], v[140:143]
    ds_read_b128 a[152:155], v15 offset:4096
    s_add_u32 m0, s88, 36864
    v_mfma_f32_16x16x32_bf16 v[140:143], a[180:183], a[124:127], v[140:143]
    s_waitcnt lgkmcnt(5)
    ds_read_b64_tr_b16 a[198:199], v18 offset:13984
    v_mfma_f32_16x16x32_bf16 a[64:67], a[184:187], a[96:99], a[64:67]
    buffer_load_dwordx4 v7, s[16:19], s29 offen lds
    v_mfma_f32_16x16x32_bf16 a[64:67], a[188:191], a[112:115], a[64:67]
    ds_read_b64_tr_b16 a[200:201], v18 offset:18592
    v_mfma_f32_16x16x32_bf16 a[68:71], a[184:187], a[100:103], a[68:71]
    v_mfma_f32_16x16x32_bf16 a[68:71], a[188:191], a[116:119], a[68:71]
    ds_read_b64_tr_b16 a[202:203], v18 offset:23200
    v_mfma_f32_16x16x32_bf16 a[72:75], a[184:187], a[104:107], a[72:75]
    s_and_b32 s98, s34, 31
    s_lshl_b32 s98, s98, 2
    s_add_u32 s98, s98, s24
    s_lshl_b32 s98, s98, 7
    s_add_u32 s98, s98, 14336
    s_min_u32 s98, s98, L_code_end-L_pf_here-8
    v_mov_b32 v61, s98
    s_mov_b64 exec, 1
    global_load_dword v0, v61, s[60:61]
    s_mov_b64 exec, -1
    v_mfma_f32_16x16x32_bf16 a[72:75], a[188:191], a[120:123], a[72:75]
    ds_read_b64_tr_b16 a[204:205], v18 offset:27808
    v_mfma_f32_16x16x32_bf16 a[76:79], a[184:187], a[108:111], a[76:79]
    s_cmp_lt_u32 s49, 1072693248
    s_cbranch_scc0 L_sk_5
    buffer_load_dwordx4 a[232:235], v52, s[44:47], s48 offen
L_sk_5:
    s_add_u32 s48, s48, 8*1152
    v_mfma_f32_16x16x32_bf16 a[76:79], a[188:191], a[124:127], a[76:79]
    s_waitcnt lgkmcnt(3)
    ds_read_b64_tr_b16 a[206:207], v18 offset:32416
    v_mfma_f32_16x16x32_bf16 v[144:147], a[192:195], a[96:99], v[144:147]
    s_add_u32 s99, s95, 512
    s_add_u32 m0, s31, 4096
    v_mfma_f32_16x16x32_bf16 v[144:147], a[196:199], a[112:115], v[144:147]
    ds_read_b64_tr_b16 a[160:161], v18 offset:192
    v_mfma_f32_16x16x32_bf16 v[148:151], a[192:195], a[100:103], v[148:151]
    v_mfma_f32_16x16x32_bf16 v[148:151], a[196:199], a[116:119], v[148:151]
    ds_read_b64_tr_b16 a[162:163], v18 offset:4800
    v_mfma_f32_16x16x32_bf16 v[152:155], a[192:195], a[104:107], v[152:155]
    buffer_load_dwordx4 v12, s[12:15], s99 offen lds
    s_add_u32 m0, s31, 5120
    v_mfma_f32_16x16x32_bf16 v[152:155], a[196:199], a[120:123], v[152:155]
    ds_read_b64_tr_b16 a[164:165], v18 offset:9408
    v_mfma_f32_16x16x32_bf16 v[156:159], a[192:195], a[108:111], v[156:159]
    v_mfma_f32_16x16x32_bf16 v[156:159], a[196:199], a[124:127], v[156:159]
    s_waitcnt lgkmcnt(3)
    ds_read_b64_tr_b16 a[166:167], v18 offset:14016
    v_mfma_f32_16x16x32_bf16 a[80:83], a[200:203], a[96:99], a[80:83]
    v_mfma_f32_16x16x32_bf16 a[80:83], a[204:207], a[112:115], a[80:83]
    ds_read_b64_tr_b16 a[168:169], v18 offset:18624
    v_mfma_f32_16x16x32_bf16 a[84:87], a[200:203], a[100:103], a[84:87]
    buffer_load_dwordx4 v13, s[12:15], s99 offen lds
    v_mfma_f32_16x16x32_bf16 a[84:87], a[204:207], a[116:119], a[84:87]
    ds_read_b64_tr_b16 a[170:171], v18 offset:23232
    v_mfma_f32_16x16x32_bf16 a[88:91], a[200:203], a[104:107], a[88:91]
    v_mfma_f32_16x16x32_bf16 a[88:91], a[204:207], a[120:123], a[88:91]
    ds_read_b64_tr_b16 a[172:173], v18 offset:27840
    v_mfma_f32_16x16x32_bf16 a[92:95], a[200:203], a[108:111], a[92:95]
    v_mfma_f32_16x16x32_bf16 a[92:95], a[204:207], a[124:127], a[92:95]
    s_waitcnt lgkmcnt(3)
    ds_read_b64_tr_b16 a[174:175], v18 offset:32448
    v_mfma_f32_16x16x32_bf16 v[160:163], a[160:163], a[96:99], v[160:163]
    buffer_load_dwordx4 a[220:223], v52, s[44:47], s54 offen
    s_add_u32 s54, s54, 8*1152
    v_mfma_f32_16x16x32_bf16 v[160:163], a[164:167], a[112:115], v[160:163]
    ds_read_b64_tr_b16 a[176:177], v18 offset:224
    s_add_u32 m0, s89, 36864
    v_mfma_f32_16x16x32_bf16 v[164:167], a[160:163], a[100:103], v[164:167]
    v_mfma_f32_16x16x32_bf16 v[164:167], a[164:167], a[116:119], v[164:167]
    ds_read_b64_tr_b16 a[178:179], v18 offset:4832
    v_mfma_f32_16x16x32_bf16 v[168:171], a[160:163], a[104:107], v[168:171]
    v_mfma_f32_16x16x32_bf16 v[168:171], a[164:167], a[120:123], v[168:171]
    ds_read_b64_tr_b16 a[180:181], v18 offset:9440
    v_mfma_f32_16x16x32_bf16 v[172:175], a[160:163], a[108:111], v[172:175]
    buffer_load_dwordx4 v8, s[16:19], s29 offen lds
    s_waitcnt vmcnt(21)
    v_mfma_f32_16x16x32_bf16 v[172:175], a[164:167], a[124:127], v[172:175]
    s_waitcnt lgkmcnt(3)
    ds_read_b64_tr_b16 a[182:183], v18 offset:14048
    v_mfma_f32_16x16x32_bf16 v[208:211], a[168:171], a[96:99], v[208:211]
    ds_read_b128 a[140:143], v14 offset:6144
    v_mfma_f32_16x16x32_bf16 v[208:211], a[172:175], a[112:115], v[208:211]
    ds_read_b64_tr_b16 a[184:185], v18 offset:18656
    v_mfma_f32_16x16x32_bf16 v[212:215], a[168:171], a[100:103], v[212:215]
    ds_read_b128 a[156:159], v15 offset:6144
    s_add_u32 m0, s90, 36864
    v_mfma_f32_16x16x32_bf16 v[212:215], a[172:175], a[116:119], v[212:215]
    ds_read_b64_tr_b16 a[186:187], v18 offset:23264
    v_mfma_f32_16x16x32_bf16 v[216:219], a[168:171], a[104:107], v[216:219]
    buffer_load_dwordx4 v9, s[16:19], s29 offen lds
    v_mfma_f32_16x16x32_bf16 v[216:219], a[172:175], a[120:123], v[216:219]
    ds_read_b64_tr_b16 a[188:189], v18 offset:27872
    v_mfma_f32_16x16x32_bf16 v[220:223], a[168:171], a[108:111], v[220:223]
    v_mfma_f32_16x16x32_bf16 v[220:223], a[172:175], a[124:127], v[220:223]
    s_waitcnt lgkmcnt(5)
    ds_read_b64_tr_b16 a[190:191], v18 offset:32480
    v_mfma_f32_16x16x32_bf16 v[176:179], a[176:179], a[96:99], v[176:179]
    v_mfma_f32_16x16x32_bf16 v[176:179], a[180:183], a[112:115], v[176:179]
    ds_read_b64_tr_b16 a[192:193], v18 offset:256
    v_mfma_f32_16x16x32_bf16 v[180:183], a[176:179], a[100:103], v[180:183]
    s_cmp_lt_u32 s49, 1072693248
    s_cbranch_scc0 L_sk_6
    buffer_load_dwordx4 a[236:239], v52, s[44:47], s48 offen
L_sk_6:
    s_add_u32 s48, s48, 8*1152
    v_mfma_f32_16x16x32_bf16 v[180:183], a[180:183], a[116:119], v[180:183]
    ds_read_b64_tr_b16 a[194:195], v18 offset:4864
    s_waitcnt lgkmcnt(5)
    v_mfma_f32_16x16x32_bf16 v[184:187], a[176:179], a[104:107], v[184:187]
    s_add_u32 s99, s96, 512
    s_add_u32 m0, s31, 6144
    v_mfma_f32_16x16x32_bf16 v[184:187], a[180:183], a[120:123], v[184:187]
    ds_read_b64_tr_b16 a[196:197], v18 offset:9472
    v_mfma_f32_16x16x32_bf16 v[188:191], a[176:179], a[108:111], v[188:191]
    v_mfma_f32_16x16x32_bf16 v[188:191], a[180:183], a[124:127], v[188:191]
    s_waitcnt lgkmcnt(3)
    ds_read_b64_tr_b16 a[198:199], v18 offset:14080
    v_mfma_f32_16x16x32_bf16 v[224:227], a[184:187], a[96:99], v[224:227]
    buffer_load_dwordx4 v12, s[12:15], s99 offen lds
    s_add_u32 m0, s31, 7168
    v_mfma_f32_16x16x32_bf16 v[224:227], a[188:191], a[112:115], v[224:227]
    ds_read_b64_tr_b16 a[200:201], v18 offset:18688
    v_mfma_f32_16x16x32_bf16 v[228:231], a[184:187], a[100:103], v[228:231]
    v_mfma_f32_16x16x32_bf16 v[228:231], a[188:191], a[116:119], v[228:231]
    ds_read_b64_tr_b16 a[202:203], v18 offset:23296
    v_mfma_f32_16x16x32_bf16 v[232:235], a[184:187], a[104:107], v[232:235]
    v_mfma_f32_16x16x32_bf16 v[232:235], a[188:191], a[120:123], v[232:235]
    ds_read_b64_tr_b16 a[204:205], v18 offset:27904
    v_mfma_f32_16x16x32_bf16 v[236:239], a[184:187], a[108:111], v[236:239]
    buffer_load_dwordx4 v13, s[12:15], s99 offen lds
    s_add_u32 m0, s91, 36864
    v_mfma_f32_16x16x32_bf16 v[236:239], a[188:191], a[124:127], v[236:239]
    s_waitcnt lgkmcnt(3)
    ds_read_b64_tr_b16 a[206:207], v18 offset:32512
    v_mfma_f32_16x16x32_bf16 v[192:195], a[192:195], a[96:99], v[192:195]
    v_mfma_f32_16x16x32_bf16 v[192:195], a[196:199], a[112:115], v[192:195]
    v_mfma_f32_16x16x32_bf16 v[196:199], a[192:195], a[100:103], v[196:199]
    v_mfma_f32_16x16x32_bf16 v[196:199], a[196:199], a[116:119], v[196:199]
    s_waitcnt lgkmcnt(0)
    s_waitcnt vmcnt(18)
    s_barrier
    v_mfma_f32_16x16x32_bf16 v[200:203], a[192:195], a[104:107], v[200:203]
    ds_read_b64_tr_b16 a[160:161], v16 offset:0
    v_mfma_f32_16x16x32_bf16 v[200:203], a[196:199], a[120:123], v[200:203]
    ds_read_b64_tr_b16 a[162:163], v16 offset:4608
    v_mfma_f32_16x16x32_bf16 v[204:207], a[192:195], a[108:111], v[204:207]
    ds_read_b64_tr_b16 a[164:165], v16 offset:9216
    v_mfma_f32_16x16x32_bf16 v[204:207], a[196:199], a[124:127], v[204:207]
    ds_read_b64_tr_b16 a[166:167], v16 offset:13824
    v_mfma_f32_16x16x32_bf16 v[240:243], a[200:203], a[96:99], v[240:243]
    buffer_load_dwordx4 v10, s[16:19], s29 offen lds
    s_add_u32 m0, s92, 36864
    v_mfma_f32_16x16x32_bf16 v[240:243], a[204:207], a[112:115], v[240:243]
    ds_read_b64_tr_b16 a[168:169], v16 offset:18432
    v_mfma_f32_16x16x32_bf16 v[244:247], a[200:203], a[100:103], v[244:247]
    v_mfma_f32_16x16x32_bf16 v[244:247], a[204:207], a[116:119], v[244:247]
    ds_read_b64_tr_b16 a[170:171], v16 offset:23040
    v_mfma_f32_16x16x32_bf16 v[248:251], a[200:203], a[104:107], v[248:251]
    buffer_load_dwordx4 v11, s[16:19], s29 offen lds
    s_add_u32 s29, s29, 64*9216
    v_mfma_f32_16x16x32_bf16 v[248:251], a[204:207], a[120:123], v[248:251]
    ds_read_b64_tr_b16 a[172:173], v16 offset:27648
    v_mfma_f32_16x16x32_bf16 v[252:255], a[200:203], a[108:111], v[252:255]
    v_mfma_f32_16x16x32_bf16 v[252:255], a[204:207], a[124:127], v[252:255]
    s_waitcnt lgkmcnt(3)
    ds_read_b64_tr_b16 a[174:175], v16 offset:32256
    v_mfma_f32_16x16x32_bf16 v[64:67], a[160:163], a[128:131], v[64:67]
    s_waitcnt vmcnt(18)
    ds_read_b128 a[96:99], v14 offset:0
    v_mfma_f32_16x16x32_bf16 v[64:67], a[164:167], a[144:147], v[64:67]
    ds_read_b64_tr_b16 a[176:177], v16 offset:32
    v_mfma_f32_16x16x32_bf16 v[68:71], a[160:163], a[132:135], v[68:71]
    ds_read_b128 a[112:115], v15 offset:0
    s_add_u32 m0, s84, 73728
    v_mfma_f32_16x16x32_bf16 v[68:71], a[164:167], a[148:151], v[68:71]
    ds_read_b64_tr_b16 a[178:179], v16 offset:4640
    v_mfma_f32_16x16x32_bf16 v[72:75], a[160:163], a[136:139], v[72:75]
    buffer_load_dwordx4 v3, s[16:19], s29 offen lds
    s_waitcnt lgkmcnt(1)
    v_mfma_f32_16x16x32_bf16 v[72:75], a[164:167], a[152:155], v[72:75]
    ds_read_b64_tr_b16 a[180:181], v16 offset:9248
    s_add_u32 s99, s93, 640
    v_mfma_f32_16x16x32_bf16 v[76:79], a[160:163], a[140:143], v[76:79]
    s_add_u32 m0, s31, 0
    ds_read_b64_tr_b16 v[28:29], v21 offset:0
    v_mfma_f32_16x16x32_bf16 v[76:79], a[164:167], a[156:159], v[76:79]
    ds_read_b64_tr_b16 a[182:183], v16 offset:13856
    v_mfma_f32_16x16x32_bf16 a[0:3], a[168:171], a[128:131], a[0:3]
    ds_read_b64_tr_b16 v[30:31], v21 offset:1152
    v_mfma_f32_16x16x32_bf16 a[0:3], a[172:175], a[144:147], a[0:3]
    ds_read_b64_tr_b16 a[184:185], v16 offset:18464
    v_mfma_f32_16x16x32_bf16 a[4:7], a[168:171], a[132:135], a[4:7]
    buffer_load_dwordx4 v12, s[12:15], s99 offen lds
    v_mfma_f32_16x16x32_bf16 a[4:7], a[172:175], a[148:151], a[4:7]
    ds_read_b64_tr_b16 a[186:187], v16 offset:23072
    v_mfma_f32_16x16x32_bf16 a[8:11], a[168:171], a[136:139], a[8:11]
    ds_read_b64_tr_b16 v[32:33], v21 offset:2304
    v_mfma_f32_16x16x32_bf16 a[8:11], a[172:175], a[152:155], a[8:11]
    ds_read_b64_tr_b16 a[188:189], v16 offset:27680
    v_mfma_f32_16x16x32_bf16 a[12:15], a[168:171], a[140:143], a[12:15]
    ds_read_b64_tr_b16 v[34:35], v21 offset:10528
    v_mfma_f32_16x16x32_bf16 a[12:15], a[172:175], a[156:159], a[12:15]
    s_waitcnt lgkmcnt(6)
    ds_read_b64_tr_b16 a[190:191], v16 offset:32288
    v_mfma_f32_16x16x32_bf16 v[80:83], a[176:179], a[128:131], v[80:83]
    buffer_load_dwordx4 a[240:243], v1, s[4:7], 0 offen offset:0
    s_add_u32 m0, s31, 1024
    v_mfma_f32_16x16x32_bf16 v[80:83], a[180:183], a[144:147], v[80:83]
    ds_read_b64_tr_b16 a[192:193], v16 offset:64
    v_mfma_f32_16x16x32_bf16 v[84:87], a[176:179], a[132:135], v[84:87]
    ds_read_b64_tr_b16 v[36:37], v21 offset:11680
    v_alignbit_b32 v38, v22, v22, 16
    v_mfma_f32_16x16x32_bf16 v[84:87], a[180:183], a[148:151], v[84:87]
    ds_read_b64_tr_b16 a[194:195], v16 offset:4672
    v_alignbit_b32 v39, v23, v23, 16
    v_mfma_f32_16x16x32_bf16 v[88:91], a[176:179], a[136:139], v[88:91]
    v_mfma_f32_16x16x32_bf16 v[88:91], a[180:183], a[152:155], v[88:91]
    ds_read_b64_tr_b16 a[196:197], v16 offset:9280
    v_mfma_f32_16x16x32_bf16 v[92:95], a[176:179], a[140:143], v[92:95]
    v_mfma_f32_16x16x32_bf16 v[92:95], a[180:183], a[156:159], v[92:95]
    s_waitcnt lgkmcnt(4)
    ds_read_b64_tr_b16 a[198:199], v16 offset:13888
    v_mfma_f32_16x16x32_bf16 a[16:19], a[184:187], a[128:131], a[16:19]
    buffer_load_dwordx4 v13, s[12:15], s99 offen lds
    s_add_u32 m0, s85, 73728
    v_mfma_f32_16x16x32_bf16 a[16:19], a[188:191], a[144:147], a[16:19]
    ds_read_b64_tr_b16 a[200:201], v16 offset:18496
    s_waitcnt lgkmcnt(4)
    v_mfma_f32_16x16x32_bf16 a[20:23], a[184:187], a[132:135], a[20:23]
    v_alignbit_b32 v40, v29, v28, 16
    v_alignbit_b32 v41, v30, v29, 16
    v_mfma_f32_16x16x32_bf16 a[20:23], a[188:191], a[148:151], a[20:23]
    ds_read_b64_tr_b16 a[202:203], v16 offset:23104
    v_alignbit_b32 v42, v31, v30, 16
    v_mfma_f32_16x16x32_bf16 a[24:27], a[184:187], a[136:139], a[24:27]
    v_alignbit_b32 v43, v32, v31, 16
    v_alignbit_b32 v62, v33, v32, 16
    v_mfma_f32_16x16x32_bf16 a[24:27], a[188:191], a[152:155], a[24:27]
    ds_read_b64_tr_b16 a[204:205], v16 offset:27712
    v_lshlrev_b32 v54, 16, v34
    v_mfma_f32_16x16x32_bf16 a[28:31], a[184:187], a[140:143], a[28:31]
    buffer_load_dwordx4 v4, s[16:19], s29 offen lds
    s_waitcnt vmcnt(18)
    v_mfma_f32_16x16x32_bf16 a[28:31], a[188:191], a[156:159], a[28:31]
    s_waitcnt lgkmcnt(3)
    ds_read_b64_tr_b16 a[206:207], v16 offset:32320
    v_mfma_f32_16x16x32_bf16 v[96:99], a[192:195], a[128:131], v[96:99]
    ds_read_b128 a[100:103], v14 offset:2048
    v_and_b32 v55, 0xffff0000, v34
    v_mfma_f32_16x16x32_bf16 v[96:99], a[196:199], a[144:147], v[96:99]
    ds_read_b64_tr_b16 a[160:161], v16 offset:96
    v_lshlrev_b32 v56, 16, v35
    v_mfma_f32_16x16x32_bf16 v[100:103], a[192:195], a[132:135], v[100:103]
    ds_read_b128 a[116:119], v15 offset:2048
    s_add_u32 m0, s86, 73728
    v_mfma_f32_16x16x32_bf16 v[100:103], a[196:199], a[148:151], v[100:103]
    ds_read_b64_tr_b16 a[162:163], v16 offset:4704
    v_and_b32 v57, 0xffff0000, v35
    v_mfma_f32_16x16x32_bf16 v[104:107], a[192:195], a[136:139], v[104:107]
    buffer_load_dwordx4 v5, s[16:19], s29 offen lds
    s_waitcnt lgkmcnt(1)
    v_mfma_f32_16x16x32_bf16 v[104:107], a[196:199], a[152:155], v[104:107]
    ds_read_b64_tr_b16 a[164:165], v16 offset:9312
    s_add_u32 s99, s94, 640
    v_mfma_f32_16x16x32_bf16 v[108:111], a[192:195], a[140:143], v[108:111]
    s_add_u32 m0, s31, 2048
    v_lshlrev_b32 v58, 16, v36
    v_and_b32 v59, 0xffff0000, v36
    v_mfma_f32_16x16x32_bf16 v[108:111], a[196:199], a[156:159], v[108:111]
    ds_read_b64_tr_b16 a[166:167], v16 offset:13920
    v_lshlrev_b32 v60, 16, v37
    v_mfma_f32_16x16x32_bf16 a[32:35], a[200:203], a[128:131], a[32:35]
    v_and_b32 v61, 0xffff0000, v37
    v_mfma_f32_16x16x32_bf16 a[32:35], a[204:207], a[144:147], a[32:35]
    ds_read_b64_tr_b16 a[168:169], v16 offset:18528
    v_mfma_f32_16x16x32_bf16 a[36:39], a[200:203], a[132:135], a[36:39]
    v_dot2_f32_bf16 v46, v40, v39, 0
    v_dot2_f32_bf16 v47, v29, v39, 0
    v_dot2_f32_bf16 v48, v41, v39, 0
    v_dot2_f32_bf16 v49, v30, v39, 0
    v_dot2_f32_bf16 v50, v42, v39, 0
    v_dot2_f32_bf16 v51, v31, v39, 0
    v_dot2_f32_bf16 v52, v43, v39, 0
    v_dot2_f32_bf16 v53, v32, v39, 0
    v_dot2_f32_bf16 v46, v41, v38, v46
    v_dot2_f32_bf16 v47, v30, v38, v47
    v_dot2_f32_bf16 v48, v42, v38, v48
    v_dot2_f32_bf16 v49, v31, v38, v49
    v_dot2_f32_bf16 v50, v43, v38, v50
    v_dot2_f32_bf16 v51, v32, v38, v51
    v_dot2_f32_bf16 v52, v62, v38, v52
    v_dot2_f32_bf16 v53, v33, v38, v53
    v_pk_mul_f32 v[46:47], v[46:47], v[54:55]
    v_pk_mul_f32 v[48:49], v[48:49], v[56:57]
    v_pk_mul_f32 v[50:51], v[50:51], v[58:59]
    v_pk_mul_f32 v[52:53], v[52:53], v[60:61]
    v_mfma_f32_16x16x32_bf16 a[36:39], a[204:207], a[148:151], a[36:39]
    ds_read_b64_tr_b16 a[170:171], v16 offset:23136
    v_cvt_pk_bf16_f32 v40, v53, v52
    v_mfma_f32_16x16x32_bf16 a[40:43], a[200:203], a[136:139], a[40:43]
    buffer_load_dwordx4 v12, s[12:15], s99 offen lds
    v_cvt_pk_bf16_f32 v41, v51, v50
    v_mfma_f32_16x16x32_bf16 a[40:43], a[204:207], a[152:155], a[40:43]
    ds_read_b64_tr_b16 a[172:173], v16 offset:27744
    v_cvt_pk_bf16_f32 v42, v49, v48
    v_mfma_f32_16x16x32_bf16 a[44:47], a[200:203], a[140:143], a[44:47]
    v_cvt_pk_bf16_f32 v43, v47, v46
    v_mfma_f32_16x16x32_bf16 a[44:47], a[204:207], a[156:159], a[44:47]
    s_waitcnt lgkmcnt(3)
    ds_read_b64_tr_b16 a[174:175], v16 offset:32352
    v_mfma_f32_16x16x32_bf16 v[112:115], a[160:163], a[128:131], v[112:115]
    buffer_store_dwordx4 v[40:43], v20, s[20:23], 0 offen sc1
    v_mfma_f32_16x16x32_bf16 v[112:115], a[164:167], a[144:147], v[112:115]
    ds_read_b64_tr_b16 a[176:177], v16 offset:128
    v_mfma_f32_16x16x32_bf16 v[116:119], a[160:163], a[132:135], v[116:119]
    ds_read_b64_tr_b16 v[28:29], v21 offset:128
    v_mfma_f32_16x16x32_bf16 v[116:119], a[164:167], a[148:151], v[116:119]
    ds_read_b64_tr_b16 a[178:179], v16 offset:4736
    v_mfma_f32_16x16x32_bf16 v[120:123], a[160:163], a[136:139], v[120:123]
    ds_read_b64_tr_b16 v[30:31], v21 offset:1280
    v_mfma_f32_16x16x32_bf16 v[120:123], a[164:167], a[152:155], v[120:123]
    ds_read_b64_tr_b16 a[180:181], v16 offset:9344
    v_mfma_f32_16x16x32_bf16 v[124:127], a[160:163], a[140:143], v[124:127]
    ds_read_b64_tr_b16 v[32:33], v21 offset:2432
    v_mfma_f32_16x16x32_bf16 v[124:127], a[164:167], a[156:159], v[124:127]
    s_waitcnt lgkmcnt(6)
    ds_read_b64_tr_b16 a[182:183], v16 offset:13952
    v_mfma_f32_16x16x32_bf16 a[48:51], a[168:171], a[128:131], a[48:51]
    ds_read_b64_tr_b16 v[34:35], v21 offset:10656
    v_mfma_f32_16x16x32_bf16 a[48:51], a[172:175], a[144:147], a[48:51]
    ds_read_b64_tr_b16 a[184:185], v16 offset:18560
    v_mfma_f32_16x16x32_bf16 a[52:55], a[168:171], a[132:135], a[52:55]
    ds_read_b64_tr_b16 v[36:37], v21 offset:11808
    v_alignbit_b32 v38, v24, v24, 16
    v_mfma_f32_16x16x32_bf16 a[52:55], a[172:175], a[148:151], a[52:55]
    ds_read_b64_tr_b16 a[186:187], v16 offset:23168
    v_alignbit_b32 v39, v25, v25, 16
    v_mfma_f32_16x16x32_bf16 a[56:59], a[168:171], a[136:139], a[56:59]
    buffer_load_dwordx4 a[244:247], v1, s[4:7], 0 offen offset:1024
    s_add_u32 m0, s31, 3072
    v_mfma_f32_16x16x32_bf16 a[56:59], a[172:175], a[152:155], a[56:59]
    ds_read_b64_tr_b16 a[188:189], v16 offset:27776
    v_mfma_f32_16x16x32_bf16 a[60:63], a[168:171], a[140:143], a[60:63]
    v_mfma_f32_16x16x32_bf16 a[60:63], a[172:175], a[156:159], a[60:63]
    s_waitcnt lgkmcnt(5)
    ds_read_b64_tr_b16 a[190:191], v16 offset:32384
    v_mfma_f32_16x16x32_bf16 v[128:131], a[176:179], a[128:131], v[128:131]
    buffer_load_dwordx4 v13, s[12:15], s99 offen lds
    s_add_u32 m0, s87, 73728
    v_mfma_f32_16x16x32_bf16 v[128:131], a[180:183], a[144:147], v[128:131]
    ds_read_b64_tr_b16 a[192:193], v16 offset:160
    s_waitcnt lgkmcnt(4)
    v_mfma_f32_16x16x32_bf16 v[132:135], a[176:179], a[132:135], v[132:135]
    v_alignbit_b32 v40, v29, v28, 16
    v_alignbit_b32 v41, v30, v29, 16
    v_mfma_f32_16x16x32_bf16 v[132:135], a[180:183], a[148:151], v[132:135]
    ds_read_b64_tr_b16 a[194:195], v16 offset:4768
    v_alignbit_b32 v42, v31, v30, 16
    v_mfma_f32_16x16x32_bf16 v[136:139], a[176:179], a[136:139], v[136:139]
    buffer_load_dwordx4 v6, s[16:19], s29 offen lds
    s_waitcnt vmcnt(18)
    v_mfma_f32_16x16x32_bf16 v[136:139], a[180:183], a[152:155], v[136:139]
    ds_read_b64_tr_b16 a[196:197], v16 offset:9376
    v_alignbit_b32 v43, v32, v31, 16
    v_mfma_f32_16x16x32_bf16 v[140:143], a[176:179], a[140:143], v[140:143]
    ds_read_b128 a[104:107], v14 offset:4096
    v_alignbit_b32 v62, v33, v32, 16
    v_mfma_f32_16x16x32_bf16 v[140:143], a[180:183], a[156:159], v[140:143]
    s_waitcnt lgkmcnt(4)
    ds_read_b64_tr_b16 a[198:199], v16 offset:13984
    v_mfma_f32_16x16x32_bf16 a[64:67], a[184:187], a[128:131], a[64:67]
    ds_read_b128 a[120:123], v15 offset:4096
    s_add_u32 m0, s88, 73728
    v_mfma_f32_16x16x32_bf16 a[64:67], a[188:191], a[144:147], a[64:67]
    ds_read_b64_tr_b16 a[200:201], v16 offset:18592
    v_lshlrev_b32 v54, 16, v34
    v_mfma_f32_16x16x32_bf16 a[68:71], a[184:187], a[132:135], a[68:71]
    buffer_load_dwordx4 v7, s[16:19], s29 offen lds
    s_waitcnt lgkmcnt(1)
    v_mfma_f32_16x16x32_bf16 a[68:71], a[188:191], a[148:151], a[68:71]
    ds_read_b64_tr_b16 a[202:203], v16 offset:23200
    s_add_u32 s99, s95, 640
    v_mfma_f32_16x16x32_bf16 a[72:75], a[184:187], a[136:139], a[72:75]
    s_add_u32 m0, s31, 4096
    v_and_b32 v55, 0xffff0000, v34
    v_lshlrev_b32 v56, 16, v35
    v_mfma_f32_16x16x32_bf16 a[72:75], a[188:191], a[152:155], a[72:75]
    ds_read_b64_tr_b16 a[204:205], v16 offset:27808
    v_and_b32 v57, 0xffff0000, v35
    v_mfma_f32_16x16x32_bf16 a[76:79], a[184:187], a[140:143], a[76:79]
    buffer_load_dwordx4 v12, s[12:15], s99 offen lds
    v_lshlrev_b32 v58, 16, v36
    v_mfma_f32_16x16x32_bf16 a[76:79], a[188:191], a[156:159], a[76:79]
    ds_read_b64_tr_b16 a[206:207], v16 offset:32416
    v_and_b32 v59, 0xffff0000, v36
    v_mfma_f32_16x16x32_bf16 v[144:147], a[192:195], a[128:131], v[144:147]
    v_lshlrev_b32 v60, 16, v37
    v_and_b32 v61, 0xffff0000, v37
    v_mfma_f32_16x16x32_bf16 v[144:147], a[196:199], a[144:147], v[144:147]
    ds_read_b64_tr_b16 a[160:161], v16 offset:192
    v_mfma_f32_16x16x32_bf16 v[148:151], a[192:195], a[132:135], v[148:151]
    v_dot2_f32_bf16 v46, v40, v39, 0
    v_dot2_f32_bf16 v47, v29, v39, 0
    v_dot2_f32_bf16 v48, v41, v39, 0
    v_dot2_f32_bf16 v49, v30, v39, 0
    v_dot2_f32_bf16 v50, v42, v39, 0
    v_dot2_f32_bf16 v51, v31, v39, 0
    v_dot2_f32_bf16 v52, v43, v39, 0
    v_dot2_f32_bf16 v53, v32, v39, 0
    v_dot2_f32_bf16 v46, v41, v38, v46
    v_dot2_f32_bf16 v47, v30, v38, v47
    v_dot2_f32_bf16 v48, v42, v38, v48
    v_dot2_f32_bf16 v49, v31, v38, v49
    v_dot2_f32_bf16 v50, v43, v38, v50
    v_dot2_f32_bf16 v51, v32, v38, v51
    v_dot2_f32_bf16 v52, v62, v38, v52
    v_dot2_f32_bf16 v53, v33, v38, v53
    v_pk_mul_f32 v[46:47], v[46:47], v[54:55]
    v_pk_mul_f32 v[48:49], v[48:49], v[56:57]
    v_pk_mul_f32 v[50:51], v[50:51], v[58:59]
    v_pk_mul_f32 v[52:53], v[52:53], v[60:61]
    v_mfma_f32_16x16x32_bf16 v[148:151], a[196:199], a[148:151], v[148:151]
    ds_read_b64_tr_b16 a[162:163], v16 offset:4800
    v_cvt_pk_bf16_f32 v40, v53, v52
    v_mfma_f32_16x16x32_bf16 v[152:155], a[192:195], a[136:139], v[152:155]
    buffer_load_dwordx4 a[248:251], v1, s[4:7], 0 offen offset:2048
    s_add_u32 m0, s31, 5120
    v_mfma_f32_16x16x32_bf16 v[152:155], a[196:199], a[152:155], v[152:155]
    ds_read_b64_tr_b16 a[164:165], v16 offset:9408
    v_cvt_pk_bf16_f32 v41, v51, v50
    v_mfma_f32_16x16x32_bf16 v[156:159], a[192:195], a[140:143], v[156:159]
    v_cvt_pk_bf16_f32 v42, v49, v48
    v_cvt_pk_bf16_f32 v43, v47, v46
    v_mfma_f32_16x16x32_bf16 v[156:159], a[196:199], a[156:159], v[156:159]
    s_waitcnt lgkmcnt(3)
    ds_read_b64_tr_b16 a[166:167], v16 offset:14016
    v_mfma_f32_16x16x32_bf16 a[80:83], a[200:203], a[128:131], a[80:83]
    buffer_store_dwordx4 v[40:43], v20, s[20:23], s43 offen sc1
    v_mfma_f32_16x16x32_bf16 a[80:83], a[204:207], a[144:147], a[80:83]
    ds_read_b64_tr_b16 a[168:169], v16 offset:18624
    v_mfma_f32_16x16x32_bf16 a[84:87], a[200:203], a[132:135], a[84:87]
    ds_read_b64_tr_b16 v[28:29], v21 offset:256
    v_mfma_f32_16x16x32_bf16 a[84:87], a[204:207], a[148:151], a[84:87]
    ds_read_b64_tr_b16 a[170:171], v16 offset:23232
    v_mfma_f32_16x16x32_bf16 a[88:91], a[200:203], a[136:139], a[88:91]
    ds_read_b64_tr_b16 v[30:31], v21 offset:1408
    v_mfma_f32_16x16x32_bf16 a[88:91], a[204:207], a[152:155], a[88:91]
    ds_read_b64_tr_b16 a[172:173], v16 offset:27840
    v_mfma_f32_16x16x32_bf16 a[92:95], a[200:203], a[140:143], a[92:95]
    ds_read_b64_tr_b16 v[32:33], v21 offset:2560
    v_mfma_f32_16x16x32_bf16 a[92:95], a[204:207], a[156:159], a[92:95]
    s_waitcnt lgkmcnt(6)
    ds_read_b64_tr_b16 a[174:175], v16 offset:32448
    v_mfma_f32_16x16x32_bf16 v[160:163], a[160:163], a[128:131], v[160:163]
    ds_read_b64_tr_b16 v[34:35], v21 offset:10784
    v_mfma_f32_16x16x32_bf16 v[160:163], a[164:167], a[144:147], v[160:163]
    ds_read_b64_tr_b16 a[176:177], v16 offset:224
    v_mfma_f32_16x16x32_bf16 v[164:167], a[160:163], a[132:135], v[164:167]
    ds_read_b64_tr_b16 v[36:37], v21 offset:11936
    v_alignbit_b32 v38, v26, v26, 16
    v_mfma_f32_16x16x32_bf16 v[164:167], a[164:167], a[148:151], v[164:167]
    ds_read_b64_tr_b16 a[178:179], v16 offset:4832
    v_alignbit_b32 v39, v27, v27, 16
    v_mfma_f32_16x16x32_bf16 v[168:171], a[160:163], a[136:139], v[168:171]
    buffer_load_dwordx4 v13, s[12:15], s99 offen lds
    s_add_u32 m0, s89, 73728
    v_mfma_f32_16x16x32_bf16 v[168:171], a[164:167], a[152:155], v[168:171]
    ds_read_b64_tr_b16 a[180:181], v16 offset:9440
    v_mfma_f32_16x16x32_bf16 v[172:175], a[160:163], a[140:143], v[172:175]
    v_mfma_f32_16x16x32_bf16 v[172:175], a[164:167], a[156:159], v[172:175]
    s_waitcnt lgkmcnt(5)
    ds_read_b64_tr_b16 a[182:183], v16 offset:14048
    v_mfma_f32_16x16x32_bf16 v[208:211], a[168:171], a[128:131], v[208:211]
    buffer_load_dwordx4 v8, s[16:19], s29 offen lds
    s_waitcnt vmcnt(19)
    v_mfma_f32_16x16x32_bf16 v[208:211], a[172:175], a[144:147], v[208:211]
    ds_read_b64_tr_b16 a[184:185], v16 offset:18656
    s_waitcnt lgkmcnt(4)
    v_mfma_f32_16x16x32_bf16 v[212:215], a[168:171], a[132:135], v[212:215]
    ds_read_b128 a[108:111], v14 offset:6144
    v_alignbit_b32 v40, v29, v28, 16
    v_mfma_f32_16x16x32_bf16 v[212:215], a[172:175], a[148:151], v[212:215]
    ds_read_b64_tr_b16 a[186:187], v16 offset:23264
    v_alignbit_b32 v41, v30, v29, 16
    v_mfma_f32_16x16x32_bf16 v[216:219], a[168:171], a[136:139], v[216:219]
    ds_read_b128 a[124:127], v15 offset:6144
    s_add_u32 m0, s90, 73728
    v_mfma_f32_16x16x32_bf16 v[216:219], a[172:175], a[152:155], v[216:219]
    ds_read_b64_tr_b16 a[188:189], v16 offset:27872
    v_alignbit_b32 v42, v31, v30, 16
    v_mfma_f32_16x16x32_bf16 v[220:223], a[168:171], a[140:143], v[220:223]
    buffer_load_dwordx4 v9, s[16:19], s29 offen lds
    s_waitcnt lgkmcnt(1)
    v_mfma_f32_16x16x32_bf16 v[220:223], a[172:175], a[156:159], v[220:223]
    ds_read_b64_tr_b16 a[190:191], v16 offset:32480
    s_add_u32 s99, s96, 640
    v_mfma_f32_16x16x32_bf16 v[176:179], a[176:179], a[128:131], v[176:179]
    s_add_u32 m0, s31, 6144
    v_alignbit_b32 v43, v32, v31, 16
    v_alignbit_b32 v62, v33, v32, 16
    v_mfma_f32_16x16x32_bf16 v[176:179], a[180:183], a[144:147], v[176:179]
    ds_read_b64_tr_b16 a[192:193], v16 offset:256
    v_lshlrev_b32 v54, 16, v34
    v_mfma_f32_16x16x32_bf16 v[180:183], a[176:179], a[132:135], v[180:183]
    buffer_load_dwordx4 v12, s[12:15], s99 offen lds
    v_and_b32 v55, 0xffff0000, v34
    v_mfma_f32_16x16x32_bf16 v[180:183], a[180:183], a[148:151], v[180:183]
    ds_read_b64_tr_b16 a[194:195], v16 offset:4864
    v_lshlrev_b32 v56, 16, v35
    v_mfma_f32_16x16x32_bf16 v[184:187], a[176:179], a[136:139], v[184:187]
    v_and_b32 v57, 0xffff0000, v35
    v_lshlrev_b32 v58, 16, v36
    v_mfma_f32_16x16x32_bf16 v[184:187], a[180:183], a[152:155], v[184:187]
    ds_read_b64_tr_b16 a[196:197], v16 offset:9472
    v_and_b32 v59, 0xffff0000, v36
    v_mfma_f32_16x16x32_bf16 v[188:191], a[176:179], a[140:143], v[188:191]
    buffer_load_dwordx4 a[252:255], v1, s[4:7], 0 offen offset:3072
    s_add_u32 m0, s31, 7168
    v_mfma_f32_16x16x32_bf16 v[188:191], a[180:183], a[156:159], v[188:191]
    s_waitcnt lgkmcnt(3)
    ds_read_b64_tr_b16 a[198:199], v16 offset:14080
    v_mfma_f32_16x16x32_bf16 v[224:227], a[184:187], a[128:131], v[224:227]
    v_lshlrev_b32 v60, 16, v37
    v_and_b32 v61, 0xffff0000, v37
    v_mfma_f32_16x16x32_bf16 v[224:227], a[188:191], a[144:147], v[224:227]
    ds_read_b64_tr_b16 a[200:201], v16 offset:18688
    v_mfma_f32_16x16x32_bf16 v[228:231], a[184:187], a[132:135], v[228:231]
    v_dot2_f32_bf16 v46, v40, v39, 0
    v_dot2_f32_bf16 v47, v29, v39, 0
    v_dot2_f32_bf16 v48, v41, v39, 0
    v_dot2_f32_bf16 v49, v30, v39, 0
    v_dot2_f32_bf16 v50, v42, v39, 0
    v_dot2_f32_bf16 v51, v31, v39, 0
    v_dot2_f32_bf16 v52, v43, v39, 0
    v_dot2_f32_bf16 v53, v32, v39, 0
    v_dot2_f32_bf16 v46, v41, v38, v46
    v_dot2_f32_bf16 v47, v30, v38, v47
    v_dot2_f32_bf16 v48, v42, v38, v48
    v_dot2_f32_bf16 v49, v31, v38, v49
    v_dot2_f32_bf16 v50, v43, v38, v50
    v_dot2_f32_bf16 v51, v32, v38, v51
    v_dot2_f32_bf16 v52, v62, v38, v52
    v_dot2_f32_bf16 v53, v33, v38, v53
    v_pk_mul_f32 v[46:47], v[46:47], v[54:55]
    v_pk_mul_f32 v[48:49], v[48:49], v[56:57]
    v_pk_mul_f32 v[50:51], v[50:51], v[58:59]
    v_pk_mul_f32 v[52:53], v[52:53], v[60:61]
    v_mfma_f32_16x16x32_bf16 v[228:231], a[188:191], a[148:151], v[228:231]
    ds_read_b64_tr_b16 a[202:203], v16 offset:23296
    v_cvt_pk_bf16_f32 v40, v53, v52
    v_mfma_f32_16x16x32_bf16 v[232:235], a[184:187], a[136:139], v[232:235]
    buffer_load_dwordx4 v13, s[12:15], s99 offen lds
    s_add_u32 m0, s91, 73728
    v_mfma_f32_16x16x32_bf16 v[232:235], a[188:191], a[152:155], v[232:235]
    ds_read_b64_tr_b16 a[204:205], v16 offset:27904
    v_cvt_pk_bf16_f32 v41, v51, v50
    v_mfma_f32_16x16x32_bf16 v[236:239], a[184:187], a[140:143], v[236:239]
    v_cvt_pk_bf16_f32 v42, v49, v48
    v_cvt_pk_bf16_f32 v43, v47, v46
    v_mfma_f32_16x16x32_bf16 v[236:239], a[188:191], a[156:159], v[236:239]
    s_waitcnt lgkmcnt(3)
    ds_read_b64_tr_b16 a[206:207], v16 offset:32512
    v_mfma_f32_16x16x32_bf16 v[192:195], a[192:195], a[128:131], v[192:195]
    buffer_store_dwordx4 v[40:43], v20, s[20:23], s42 offen sc1
    v_lshrrev_b32 v49, 4, v2
    v_mfma_f32_16x16x32_bf16 v[192:195], a[196:199], a[144:147], v[192:195]
    v_bfe_u32 v53, v2, 2, 2
    v_lshl_add_u32 v53, v49, 3, v53
    v_mfma_f32_16x16x32_bf16 v[196:199], a[192:195], a[132:135], v[196:199]
    v_lshlrev_b32 v53, 7, v53
    v_and_b32 v49, 3, v2
    v_mfma_f32_16x16x32_bf16 v[196:199], a[196:199], a[148:151], v[196:199]
    s_waitcnt lgkmcnt(0)
    s_waitcnt vmcnt(22)
    s_barrier
    v_mfma_f32_16x16x32_bf16 v[200:203], a[192:195], a[136:139], v[200:203]
    ds_read_b64_tr_b16 a[160:161], v17 offset:0
    v_lshl_add_u32 v53, v49, 3, v53
    v_mfma_f32_16x16x32_bf16 v[200:203], a[196:199], a[152:155], v[200:203]
    ds_read_b64_tr_b16 a[162:163], v17 offset:4608
    v_add_u32 v53, s28, v53
    v_mfma_f32_16x16x32_bf16 v[204:207], a[192:195], a[140:143], v[204:207]
    ds_read_b64_tr_b16 a[164:165], v17 offset:9216
    v_add_u32 v52, s28, v1
    v_mfma_f32_16x16x32_bf16 v[204:207], a[196:199], a[156:159], v[204:207]
    ds_read_b64_tr_b16 a[166:167], v17 offset:13824
    s_lshl_b32 s100, s2, 3
    v_mfma_f32_16x16x32_bf16 v[240:243], a[200:203], a[128:131], v[240:243]
    s_lshl_b32 s101, s24, 1
    s_add_u32 s100, s100, s101
    v_lshrrev_b32 v58, 5, v2
    v_mfma_f32_16x16x32_bf16 v[240:243], a[204:207], a[144:147], v[240:243]
    ds_read_b64_tr_b16 a[168:169], v17 offset:18432
    v_add_u32 v58, s100, v58
    v_mfma_f32_16x16x32_bf16 v[244:247], a[200:203], a[132:135], v[244:247]
    v_mul_u32_u24 v55, 1152, v58
    v_and_b32 v49, 31, v2
    v_mfma_f32_16x16x32_bf16 v[244:247], a[204:207], a[148:151], v[244:247]
    ds_read_b64_tr_b16 a[170:171], v17 offset:23040
    v_lshlrev_b32 v56, 4, v49
    v_mfma_f32_16x16x32_bf16 v[248:251], a[200:203], a[136:139], v[248:251]
    buffer_load_dwordx4 v10, s[16:19], s29 offen lds
    s_add_u32 m0, s92, 73728
    v_mfma_f32_16x16x32_bf16 v[248:251], a[204:207], a[152:155], v[248:251]
    ds_read_b64_tr_b16 a[172:173], v17 offset:27648
    v_add_u32 v55, v55, v56
    v_mfma_f32_16x16x32_bf16 v[252:255], a[200:203], a[140:143], v[252:255]
    v_cmp_gt_u32 vcc, 8, v49
    v_mov_b32 v51, 2147483632
    v_mfma_f32_16x16x32_bf16 v[252:255], a[204:207], a[156:159], v[252:255]
    s_waitcnt lgkmcnt(3)
    ds_read_b64_tr_b16 a[174:175], v17 offset:32256
    v_mfma_f32_16x16x32_bf16 v[64:67], a[160:163], a[96:99], v[64:67]
    v_lshlrev_b32 v58, 3, v58
    v_cndmask_b32 v57, v51, v55, vcc
    v_mfma_f32_16x16x32_bf16 v[64:67], a[164:167], a[112:115], v[64:67]
    ds_read_b64_tr_b16 a[176:177], v17 offset:32
    v_cmp_eq_u32 vcc, 0, v49
    v_mfma_f32_16x16x32_bf16 v[68:71], a[160:163], a[100:103], v[68:71]
    v_add_u32 v58, 24772608, v58
    v_nop
    v_mfma_f32_16x16x32_bf16 v[68:71], a[164:167], a[116:119], v[68:71]
    ds_read_b64_tr_b16 a[178:179], v17 offset:4640
    v_cndmask_b32 v58, v51, v58, vcc
    v_mfma_f32_16x16x32_bf16 v[72:75], a[160:163], a[104:107], v[72:75]
    buffer_load_dwordx4 v[20:23], v55, s[12:15], 0 offen offset:0
    v_mfma_f32_16x16x32_bf16 v[72:75], a[164:167], a[120:123], v[72:75]
    ds_read_b64_tr_b16 a[180:181], v17 offset:9248
    v_mfma_f32_16x16x32_bf16 v[76:79], a[160:163], a[108:111], v[76:79]
    v_mfma_f32_16x16x32_bf16 v[76:79], a[164:167], a[124:127], v[76:79]
    s_waitcnt lgkmcnt(3)
    ds_read_b64_tr_b16 a[182:183], v17 offset:13856
    v_mfma_f32_16x16x32_bf16 a[0:3], a[168:171], a[96:99], a[0:3]
    global_load_dwordx4 v[24:27], v56, s[50:51] offset:0
    v_mfma_f32_16x16x32_bf16 a[0:3], a[172:175], a[112:115], a[0:3]
    ds_read_b64_tr_b16 a[184:185], v17 offset:18464
    v_mfma_f32_16x16x32_bf16 a[4:7], a[168:171], a[100:103], a[4:7]
    v_mfma_f32_16x16x32_bf16 a[4:7], a[172:175], a[116:119], a[4:7]
    ds_read_b64_tr_b16 a[186:187], v17 offset:23072
    v_mfma_f32_16x16x32_bf16 a[8:11], a[168:171], a[104:107], a[8:11]
    buffer_load_dwordx4 v[28:31], v55, s[12:15], 0 offen offset:512
    v_mfma_f32_16x16x32_bf16 a[8:11], a[172:175], a[120:123], a[8:11]
    ds_read_b64_tr_b16 a[188:189], v17 offset:27680
    v_mfma_f32_16x16x32_bf16 a[12:15], a[168:171], a[108:111], a[12:15]
    v_mfma_f32_16x16x32_bf16 a[12:15], a[172:175], a[124:127], a[12:15]
    s_waitcnt lgkmcnt(3)
    ds_read_b64_tr_b16 a[190:191], v17 offset:32288
    v_mfma_f32_16x16x32_bf16 v[80:83], a[176:179], a[96:99], v[80:83]
    global_load_dwordx4 v[32:35], v56, s[50:51] offset:512
    v_min_u32 v56, 112, v56
    v_mfma_f32_16x16x32_bf16 v[80:83], a[180:183], a[112:115], v[80:83]
    ds_read_b64_tr_b16 a[192:193], v17 offset:64
    v_mfma_f32_16x16x32_bf16 v[84:87], a[176:179], a[100:103], v[84:87]
    v_mfma_f32_16x16x32_bf16 v[84:87], a[180:183], a[116:119], v[84:87]
    ds_read_b64_tr_b16 a[194:195], v17 offset:4672
    v_mfma_f32_16x16x32_bf16 v[88:91], a[176:179], a[104:107], v[88:91]
    buffer_load_dwordx4 v[36:39], v57, s[12:15], 0 offen offset:1024
    v_mfma_f32_16x16x32_bf16 v[88:91], a[180:183], a[120:123], v[88:91]
    ds_read_b64_tr_b16 a[196:197], v17 offset:9280
    v_mfma_f32_16x16x32_bf16 v[92:95], a[176:179], a[108:111], v[92:95]
    v_mfma_f32_16x16x32_bf16 v[92:95], a[180:183], a[124:127], v[92:95]
    s_waitcnt lgkmcnt(3)
    ds_read_b64_tr_b16 a[198:199], v17 offset:13888
    v_mfma_f32_16x16x32_bf16 a[16:19], a[184:187], a[96:99], a[16:19]
    global_load_dwordx4 v[40:43], v56, s[50:51] offset:1024
    s_waitcnt vmcnt(25)
    v_mfma_f32_16x16x32_bf16 a[16:19], a[188:191], a[112:115], a[16:19]
    ds_read_b64_tr_b16 a[200:201], v17 offset:18496
    v_mfma_f32_16x16x32_bf16 a[20:23], a[184:187], a[100:103], a[20:23]
    ds_write_b128 v52, a[208:211] offset:0
    v_mfma_f32_16x16x32_bf16 a[20:23], a[188:191], a[116:119], a[20:23]
    ds_read_b64_tr_b16 a[202:203], v17 offset:23104
    v_mfma_f32_16x16x32_bf16 a[24:27], a[184:187], a[104:107], a[24:27]
    buffer_load_dwordx4 v11, s[16:19], s29 offen lds
    s_add_u32 s29, s29, 64*9216
    v_mfma_f32_16x16x32_bf16 a[24:27], a[188:191], a[120:123], a[24:27]
    ds_read_b64_tr_b16 a[204:205], v17 offset:27712
    v_mfma_f32_16x16x32_bf16 a[28:31], a[184:187], a[108:111], a[28:31]
    ds_read_b128 a[128:131], v14 offset:0
    v_mfma_f32_16x16x32_bf16 a[28:31], a[188:191], a[124:127], a[28:31]
    s_waitcnt lgkmcnt(5)
    ds_read_b64_tr_b16 a[206:207], v17 offset:32320
    v_mfma_f32_16x16x32_bf16 v[96:99], a[192:195], a[96:99], v[96:99]
    ds_read_b128 a[144:147], v15 offset:0
    s_add_u32 m0, s84, 0
    v_mfma_f32_16x16x32_bf16 v[96:99], a[196:199], a[112:115], v[96:99]
    ds_read_b64_tr_b16 a[160:161], v17 offset:96
    v_mfma_f32_16x16x32_bf16 v[100:103], a[192:195], a[100:103], v[100:103]
    buffer_load_dwordx4 v3, s[16:19], s29 offen lds
    s_waitcnt lgkmcnt(1)
    v_mfma_f32_16x16x32_bf16 v[100:103], a[196:199], a[116:119], v[100:103]
    ds_read_b64_tr_b16 a[162:163], v17 offset:4704
    s_add_u32 s99, s93, 768
    v_mfma_f32_16x16x32_bf16 v[104:107], a[192:195], a[104:107], v[104:107]
    s_add_u32 m0, s31, 0
    ds_write_b128 v52, a[212:215] offset:1024
    v_mfma_f32_16x16x32_bf16 v[104:107], a[196:199], a[120:123], v[104:107]
    ds_read_b64_tr_b16 a[164:165], v17 offset:9312
    v_mfma_f32_16x16x32_bf16 v[108:111], a[192:195], a[108:111], v[108:111]
    buffer_load_dwordx4 v12, s[12:15], s99 offen lds
    s_add_u32 m0, s31, 1024
    v_mfma_f32_16x16x32_bf16 v[108:111], a[196:199], a[124:127], v[108:111]
    ds_read_b64_tr_b16 a[166:167], v17 offset:13920
    v_mfma_f32_16x16x32_bf16 a[32:35], a[200:203], a[96:99], a[32:35]
    ds_write_b128 v52, a[216:219] offset:2048
    v_mfma_f32_16x16x32_bf16 a[32:35], a[204:207], a[112:115], a[32:35]
    ds_read_b64_tr_b16 a[168:169], v17 offset:18528
    v_mfma_f32_16x16x32_bf16 a[36:39], a[200:203], a[100:103], a[36:39]
    buffer_load_dwordx4 v13, s[12:15], s99 offen lds
    s_add_u32 m0, s85, 0
    v_mfma_f32_16x16x32_bf16 a[36:39], a[204:207], a[116:119], a[36:39]
    ds_read_b64_tr_b16 a[170:171], v17 offset:23136
    v_mfma_f32_16x16x32_bf16 a[40:43], a[200:203], a[104:107], a[40:43]
    ds_write_b128 v52, a[220:223] offset:3072
    v_mfma_f32_16x16x32_bf16 a[40:43], a[204:207], a[120:123], a[40:43]
    ds_read_b64_tr_b16 a[172:173], v17 offset:27744
    v_mfma_f32_16x16x32_bf16 a[44:47], a[200:203], a[108:111], a[44:47]
    buffer_load_dwordx4 v4, s[16:19], s29 offen lds
    s_waitcnt vmcnt(24)
    v_mfma_f32_16x16x32_bf16 a[44:47], a[204:207], a[124:127], a[44:47]
    s_waitcnt lgkmcnt(5)
    ds_read_b64_tr_b16 a[174:175], v17 offset:32352
    v_mfma_f32_16x16x32_bf16 v[112:115], a[160:163], a[96:99], v[112:115]
    ds_read_b128 a[132:135], v14 offset:2048
    v_mfma_f32_16x16x32_bf16 v[112:115], a[164:167], a[112:115], v[112:115]
    ds_read_b64_tr_b16 a[176:177], v17 offset:128
    v_mfma_f32_16x16x32_bf16 v[116:119], a[160:163], a[100:103], v[116:119]
    ds_read_b128 a[148:151], v15 offset:2048
    s_add_u32 m0, s86, 0
    v_mfma_f32_16x16x32_bf16 v[116:119], a[164:167], a[116:119], v[116:119]
    ds_read_b64_tr_b16 a[178:179], v17 offset:4736
    s_waitcnt lgkmcnt(6)
    v_mfma_f32_16x16x32_bf16 v[120:123], a[160:163], a[104:107], v[120:123]
    buffer_load_dwordx4 v5, s[16:19], s29 offen lds
    s_waitcnt lgkmcnt(1)
    v_mfma_f32_16x16x32_bf16 v[120:123], a[164:167], a[120:123], v[120:123]
    ds_read_b64_tr_b16 a[180:181], v17 offset:9344
    s_add_u32 s99, s94, 768
    v_mfma_f32_16x16x32_bf16 v[124:127], a[160:163], a[108:111], v[124:127]
    s_add_u32 m0, s31, 2048
    ds_read_b64_tr_b16 a[208:209], v53 offset:0
    v_mfma_f32_16x16x32_bf16 v[124:127], a[164:167], a[124:127], v[124:127]
    ds_read_b64_tr_b16 a[182:183], v17 offset:13952
    v_mfma_f32_16x16x32_bf16 a[48:51], a[168:171], a[96:99], a[48:51]
    buffer_load_dwordx4 v12, s[12:15], s99 offen lds
    s_add_u32 m0, s31, 3072
    v_mfma_f32_16x16x32_bf16 a[48:51], a[172:175], a[112:115], a[48:51]
    ds_read_b64_tr_b16 a[184:185], v17 offset:18560
    v_mfma_f32_16x16x32_bf16 a[52:55], a[168:171], a[100:103], a[52:55]
    ds_read_b64_tr_b16 a[210:211], v53 offset:512
    v_mfma_f32_16x16x32_bf16 a[52:55], a[172:175], a[116:119], a[52:55]
    ds_read_b64_tr_b16 a[186:187], v17 offset:23168
    v_mfma_f32_16x16x32_bf16 a[56:59], a[168:171], a[104:107], a[56:59]
    buffer_load_dwordx4 v13, s[12:15], s99 offen lds
    s_add_u32 m0, s87, 0
    v_mfma_f32_16x16x32_bf16 a[56:59], a[172:175], a[120:123], a[56:59]
    ds_read_b64_tr_b16 a[188:189], v17 offset:27776
    v_mfma_f32_16x16x32_bf16 a[60:63], a[168:171], a[108:111], a[60:63]
    ds_read_b64_tr_b16 a[212:213], v53 offset:32
    v_mfma_f32_16x16x32_bf16 a[60:63], a[172:175], a[124:127], a[60:63]
    s_waitcnt lgkmcnt(5)
    ds_read_b64_tr_b16 a[190:191], v17 offset:32384
    v_mfma_f32_16x16x32_bf16 v[128:131], a[176:179], a[96:99], v[128:131]
    ds_read_b64_tr_b16 a[214:215], v53 offset:544
    v_mfma_f32_16x16x32_bf16 v[128:131], a[180:183], a[112:115], v[128:131]
    ds_read_b64_tr_b16 a[192:193], v17 offset:160
    v_mfma_f32_16x16x32_bf16 v[132:135], a[176:179], a[100:103], v[132:135]
    buffer_load_dwordx4 v6, s[16:19], s29 offen lds
    s_waitcnt vmcnt(22)
    v_mfma_f32_16x16x32_bf16 v[132:135], a[180:183], a[116:119], v[132:135]
    ds_read_b64_tr_b16 a[194:195], v17 offset:4768
    v_mfma_f32_16x16x32_bf16 v[136:139], a[176:179], a[104:107], v[136:139]
    ds_read_b128 a[136:139], v14 offset:4096
    v_mfma_f32_16x16x32_bf16 v[136:139], a[180:183], a[120:123], v[136:139]
    ds_read_b64_tr_b16 a[196:197], v17 offset:9376
    v_mfma_f32_16x16x32_bf16 v[140:143], a[176:179], a[108:111], v[140:143]
    ds_read_b128 a[152:155], v15 offset:4096
    s_add_u32 m0, s88, 0
    v_mfma_f32_16x16x32_bf16 v[140:143], a[180:183], a[124:127], v[140:143]
    s_waitcnt lgkmcnt(6)
    ds_read_b64_tr_b16 a[198:199], v17 offset:13984
    v_mfma_f32_16x16x32_bf16 a[64:67], a[184:187], a[96:99], a[64:67]
    ds_read_b64_tr_b16 a[216:217], v53 offset:64
    v_mfma_f32_16x16x32_bf16 a[64:67], a[188:191], a[112:115], a[64:67]
    ds_read_b64_tr_b16 a[200:201], v17 offset:18592
    v_mfma_f32_16x16x32_bf16 a[68:71], a[184:187], a[100:103], a[68:71]
    buffer_load_dwordx4 v7, s[16:19], s29 offen lds
    s_waitcnt lgkmcnt(3)
    v_mfma_f32_16x16x32_bf16 a[68:71], a[188:191], a[116:119], a[68:71]
    ds_read_b64_tr_b16 a[202:203], v17 offset:23200
    s_add_u32 s99, s95, 768
    v_mfma_f32_16x16x32_bf16 a[72:75], a[184:187], a[104:107], a[72:75]
    s_add_u32 m0, s31, 4096
    ds_read_b64_tr_b16 a[218:219], v53 offset:576
    v_mfma_f32_16x16x32_bf16 a[72:75], a[188:191], a[120:123], a[72:75]
    ds_read_b64_tr_b16 a[204:205], v17 offset:27808
    v_mfma_f32_16x16x32_bf16 a[76:79], a[184:187], a[108:111], a[76:79]
    ds_read_b64_tr_b16 a[220:221], v53 offset:96
    v_mfma_f32_16x16x32_bf16 a[76:79], a[188:191], a[124:127], a[76:79]
    s_waitcnt lgkmcnt(6)
    ds_read_b64_tr_b16 a[206:207], v17 offset:32416
    v_mfma_f32_16x16x32_bf16 v[144:147], a[192:195], a[96:99], v[144:147]
    ds_read_b64_tr_b16 a[222:223], v53 offset:608
    v_mfma_f32_16x16x32_bf16 v[144:147], a[196:199], a[112:115], v[144:147]
    ds_read_b64_tr_b16 a[160:161], v17 offset:192
    v_mfma_f32_16x16x32_bf16 v[148:151], a[192:195], a[100:103], v[148:151]
    buffer_load_dwordx4 v12, s[12:15], s99 offen lds
    s_add_u32 m0, s31, 5120
    v_mfma_f32_16x16x32_bf16 v[148:151], a[196:199], a[116:119], v[148:151]
    ds_read_b64_tr_b16 a[162:163], v17 offset:4800
    v_mfma_f32_16x16x32_bf16 v[152:155], a[192:195], a[104:107], v[152:155]
    v_mfma_f32_16x16x32_bf16 v[152:155], a[196:199], a[120:123], v[152:155]
    ds_read_b64_tr_b16 a[164:165], v17 offset:9408
    v_mfma_f32_16x16x32_bf16 v[156:159], a[192:195], a[108:111], v[156:159]
    s_waitcnt lgkmcnt(3)
    ds_write_b128 v52, a[224:227] offset:0
    v_mfma_f32_16x16x32_bf16 v[156:159], a[196:199], a[124:127], v[156:159]
    ds_read_b64_tr_b16 a[166:167], v17 offset:14016
    v_mfma_f32_16x16x32_bf16 a[80:83], a[200:203], a[96:99], a[80:83]
    buffer_store_dwordx4 a[208:211], v1, s[20:23], s55 offen sc1
    s_add_u32 s55, s55, 148480
    v_mfma_f32_16x16x32_bf16 a[80:83], a[204:207], a[112:115], a[80:83]
    ds_read_b64_tr_b16 a[168:169], v17 offset:18624
    v_mfma_f32_16x16x32_bf16 a[84:87], a[200:203], a[100:103], a[84:87]
    ds_write_b128 v52, a[228:231] offset:1024
    v_mfma_f32_16x16x32_bf16 a[84:87], a[204:207], a[116:119], a[84:87]
    ds_read_b64_tr_b16 a[170:171], v17 offset:23232
    v_mfma_f32_16x16x32_bf16 a[88:91], a[200:203], a[104:107], a[88:91]
    ds_write_b128 v52, a[232:235] offset:2048
    v_mfma_f32_16x16x32_bf16 a[88:91], a[204:207], a[120:123], a[88:91]
    ds_read_b64_tr_b16 a[172:173], v17 offset:27840
    v_mfma_f32_16x16x32_bf16 a[92:95], a[200:203], a[108:111], a[92:95]
    ds_write_b128 v52, a[236:239] offset:3072
    v_mfma_f32_16x16x32_bf16 a[92:95], a[204:207], a[124:127], a[92:95]
    s_waitcnt lgkmcnt(6)
    ds_read_b64_tr_b16 a[174:175], v17 offset:32448
    v_mfma_f32_16x16x32_bf16 v[160:163], a[160:163], a[96:99], v[160:163]
    v_mfma_f32_16x16x32_bf16 v[160:163], a[164:167], a[112:115], v[160:163]
    ds_read_b64_tr_b16 a[176:177], v17 offset:224
    v_mfma_f32_16x16x32_bf16 v[164:167], a[160:163], a[100:103], v[164:167]
    v_mfma_f32_16x16x32_bf16 v[164:167], a[164:167], a[116:119], v[164:167]
    ds_read_b64_tr_b16 a[178:179], v17 offset:4832
    v_mfma_f32_16x16x32_bf16 v[168:171], a[160:163], a[104:107], v[168:171]
    buffer_load_dwordx4 v13, s[12:15], s99 offen lds
    s_add_u32 m0, s89, 0
    v_mfma_f32_16x16x32_bf16 v[168:171], a[164:167], a[120:123], v[168:171]
    ds_read_b64_tr_b16 a[180:181], v17 offset:9440
    s_waitcnt lgkmcnt(4)
    v_mfma_f32_16x16x32_bf16 v[172:175], a[160:163], a[108:111], v[172:175]
    ds_read_b64_tr_b16 a[224:225], v53 offset:0
    v_mfma_f32_16x16x32_bf16 v[172:175], a[164:167], a[124:127], v[172:175]
    s_waitcnt lgkmcnt(4)
    ds_read_b64_tr_b16 a[182:183], v17 offset:14048
    v_mfma_f32_16x16x32_bf16 v[208:211], a[168:171], a[96:99], v[208:211]
    buffer_load_dwordx4 v8, s[16:19], s29 offen lds
    s_waitcnt vmcnt(22)
    v_mfma_f32_16x16x32_bf16 v[208:211], a[172:175], a[112:115], v[208:211]
    ds_read_b64_tr_b16 a[184:185], v17 offset:18656
    v_mfma_f32_16x16x32_bf16 v[212:215], a[168:171], a[100:103], v[212:215]
    ds_read_b128 a[140:143], v14 offset:6144
    v_mfma_f32_16x16x32_bf16 v[212:215], a[172:175], a[116:119], v[212:215]
    ds_read_b64_tr_b16 a[186:187], v17 offset:23264
    v_mfma_f32_16x16x32_bf16 v[216:219], a[168:171], a[104:107], v[216:219]
    buffer_store_dwordx4 a[212:215], v1, s[20:23], s55 offen sc1
    s_add_u32 s55, s55, 148480
    v_mfma_f32_16x16x32_bf16 v[216:219], a[172:175], a[120:123], v[216:219]
    ds_read_b64_tr_b16 a[188:189], v17 offset:27872
    v_mfma_f32_16x16x32_bf16 v[220:223], a[168:171], a[108:111], v[220:223]
    ds_read_b128 a[156:159], v15 offset:6144
    s_add_u32 m0, s90, 0
    v_mfma_f32_16x16x32_bf16 v[220:223], a[172:175], a[124:127], v[220:223]
    s_waitcnt lgkmcnt(5)
    ds_read_b64_tr_b16 a[190:191], v17 offset:32480
    v_mfma_f32_16x16x32_bf16 v[176:179], a[176:179], a[96:99], v[176:179]
    ds_read_b64_tr_b16 a[226:227], v53 offset:512
    v_mfma_f32_16x16x32_bf16 v[176:179], a[180:183], a[112:115], v[176:179]
    ds_read_b64_tr_b16 a[192:193], v17 offset:256
    v_mfma_f32_16x16x32_bf16 v[180:183], a[176:179], a[100:103], v[180:183]
    ds_read_b64_tr_b16 a[228:229], v53 offset:32
    v_mfma_f32_16x16x32_bf16 v[180:183], a[180:183], a[116:119], v[180:183]
    ds_read_b64_tr_b16 a[194:195], v17 offset:4864
    v_mfma_f32_16x16x32_bf16 v[184:187], a[176:179], a[104:107], v[184:187]
    ds_read_b64_tr_b16 a[230:231], v53 offset:544
    v_mfma_f32_16x16x32_bf16 v[184:187], a[180:183], a[120:123], v[184:187]
    ds_read_b64_tr_b16 a[196:197], v17 offset:9472
    v_mfma_f32_16x16x32_bf16 v[188:191], a[176:179], a[108:111], v[188:191]
    ds_read_b64_tr_b16 a[232:233], v53 offset:64
    v_mfma_f32_16x16x32_bf16 v[188:191], a[180:183], a[124:127], v[188:191]
    s_waitcnt lgkmcnt(7)
    ds_read_b64_tr_b16 a[198:199], v17 offset:14080
    v_mfma_f32_16x16x32_bf16 v[224:227], a[184:187], a[96:99], v[224:227]
    buffer_load_dwordx4 v9, s[16:19], s29 offen lds
    v_mfma_f32_16x16x32_bf16 v[224:227], a[188:191], a[112:115], v[224:227]
    ds_read_b64_tr_b16 a[200:201], v17 offset:18688
    s_add_u32 s99, s96, 768
    v_mfma_f32_16x16x32_bf16 v[228:231], a[184:187], a[100:103], v[228:231]
    s_add_u32 m0, s31, 6144
    ds_read_b64_tr_b16 a[234:235], v53 offset:576
    v_mfma_f32_16x16x32_bf16 v[228:231], a[188:191], a[116:119], v[228:231]
    ds_read_b64_tr_b16 a[202:203], v17 offset:23296
    v_mfma_f32_16x16x32_bf16 v[232:235], a[184:187], a[104:107], v[232:235]
    buffer_load_dwordx4 v12, s[12:15], s99 offen lds
    s_add_u32 m0, s31, 7168
    v_mfma_f32_16x16x32_bf16 v[232:235], a[188:191], a[120:123], v[232:235]
    ds_read_b64_tr_b16 a[204:205], v17 offset:27904
    v_mfma_f32_16x16x32_bf16 v[236:239], a[184:187], a[108:111], v[236:239]
    ds_read_b64_tr_b16 a[236:237], v53 offset:96
    v_mfma_f32_16x16x32_bf16 v[236:239], a[188:191], a[124:127], v[236:239]
    s_waitcnt lgkmcnt(5)
    ds_read_b64_tr_b16 a[206:207], v17 offset:32512
    v_mfma_f32_16x16x32_bf16 v[192:195], a[192:195], a[96:99], v[192:195]
    buffer_store_dwordx4 a[216:219], v1, s[20:23], s55 offen sc1
    s_add_u32 s55, s55, 148480
    v_mfma_f32_16x16x32_bf16 v[192:195], a[196:199], a[112:115], v[192:195]
    ds_read_b64_tr_b16 a[238:239], v53 offset:608
    v_mfma_f32_16x16x32_bf16 v[196:199], a[192:195], a[100:103], v[196:199]
    v_mfma_f32_16x16x32_bf16 v[196:199], a[196:199], a[116:119], v[196:199]
    s_waitcnt lgkmcnt(0)
    s_waitcnt vmcnt(17)
    s_barrier
    v_mfma_f32_16x16x32_bf16 v[200:203], a[192:195], a[104:107], v[200:203]
    ds_read_b64_tr_b16 a[160:161], v18 offset:0
    v_mfma_f32_16x16x32_bf16 v[200:203], a[196:199], a[120:123], v[200:203]
    ds_read_b64_tr_b16 a[162:163], v18 offset:4608
    v_mfma_f32_16x16x32_bf16 v[204:207], a[192:195], a[108:111], v[204:207]
    ds_read_b64_tr_b16 a[164:165], v18 offset:9216
    v_mfma_f32_16x16x32_bf16 v[204:207], a[196:199], a[124:127], v[204:207]
    ds_read_b64_tr_b16 a[166:167], v18 offset:13824
    v_mfma_f32_16x16x32_bf16 v[240:243], a[200:203], a[96:99], v[240:243]
    v_dot2_f32_bf16 v50, v20, v24, 0
    v_dot2_f32_bf16 v50, v21, v25, v50
    v_dot2_f32_bf16 v50, v22, v26, v50
    v_dot2_f32_bf16 v50, v23, v27, v50
    v_dot2_f32_bf16 v50, v28, v32, v50
    v_dot2_f32_bf16 v50, v29, v33, v50
    v_dot2_f32_bf16 v50, v30, v34, v50
    v_dot2_f32_bf16 v50, v31, v35, v50
    v_dot2_f32_bf16 v50, v36, v40, v50
    v_dot2_f32_bf16 v50, v37, v41, v50
    v_dot2_f32_bf16 v50, v38, v42, v50
    v_dot2_f32_bf16 v50, v39, v43, v50
    s_nop 0
    v_mfma_f32_16x16x32_bf16 v[240:243], a[204:207], a[112:115], v[240:243]
    ds_read_b64_tr_b16 a[168:169], v18 offset:18432
    v_mfma_f32_16x16x32_bf16 v[244:247], a[200:203], a[100:103], v[244:247]
    s_nop 1
    v_add_f32_dpp v50, v50, v50 row_ror:8 row_mask:0xf bank_mask:0xf
    v_mfma_f32_16x16x32_bf16 v[244:247], a[204:207], a[116:119], v[244:247]
    ds_read_b64_tr_b16 a[170:171], v18 offset:23040
    v_mfma_f32_16x16x32_bf16 v[248:251], a[200:203], a[104:107], v[248:251]
    buffer_load_dwordx4 v13, s[12:15], s99 offen lds
    s_add_u32 m0, s91, 0
    v_mfma_f32_16x16x32_bf16 v[248:251], a[204:207], a[120:123], v[248:251]
    ds_read_b64_tr_b16 a[172:173], v18 offset:27648
    v_mfma_f32_16x16x32_bf16 v[252:255], a[200:203], a[108:111], v[252:255]
    s_nop 1
    v_add_f32_dpp v50, v50, v50 row_ror:4 row_mask:0xf bank_mask:0xf
    v_mfma_f32_16x16x32_bf16 v[252:255], a[204:207], a[124:127], v[252:255]
    s_waitcnt lgkmcnt(3)
    ds_read_b64_tr_b16 a[174:175], v18 offset:32256
    v_mfma_f32_16x16x32_bf16 v[64:67], a[160:163], a[128:131], v[64:67]
    s_nop 1
    v_add_f32_dpp v50, v50, v50 row_ror:2 row_mask:0xf bank_mask:0xf
    v_mfma_f32_16x16x32_bf16 v[64:67], a[164:167], a[144:147], v[64:67]
    ds_read_b64_tr_b16 a[176:177], v18 offset:32
    v_mfma_f32_16x16x32_bf16 v[68:71], a[160:163], a[132:135], v[68:71]
    buffer_store_dwordx4 a[220:223], v1, s[20:23], s55 offen sc1
    s_add_u32 s55, s55, 148480
    v_mfma_f32_16x16x32_bf16 v[68:71], a[164:167], a[148:151], v[68:71]
    ds_read_b64_tr_b16 a[178:179], v18 offset:4640
    v_mfma_f32_16x16x32_bf16 v[72:75], a[160:163], a[136:139], v[72:75]
    s_nop 1
    v_add_f32_dpp v50, v50, v50 row_ror:1 row_mask:0xf bank_mask:0xf
    v_mfma_f32_16x16x32_bf16 v[72:75], a[164:167], a[152:155], v[72:75]
    ds_read_b64_tr_b16 a[180:181], v18 offset:9248
    v_mov_b32 v51, v50
    v_mfma_f32_16x16x32_bf16 v[76:79], a[160:163], a[140:143], v[76:79]
    s_nop 1
    v_permlane16_swap_b32 v50, v51
    v_mfma_f32_16x16x32_bf16 v[76:79], a[164:167], a[156:159], v[76:79]
    s_waitcnt lgkmcnt(3)
    ds_read_b64_tr_b16 a[182:183], v18 offset:13856
    v_mfma_f32_16x16x32_bf16 a[0:3], a[168:171], a[128:131], a[0:3]
    v_add_f32 v50, v50, v51
    v_cvt_pk_bf16_f32 v50, v50, v50
    v_mfma_f32_16x16x32_bf16 a[0:3], a[172:175], a[144:147], a[0:3]
    ds_read_b64_tr_b16 a[184:185], v18 offset:18464
    v_lshlrev_b32 v50, 16, v50
    v_mfma_f32_16x16x32_bf16 a[4:7], a[168:171], a[132:135], a[4:7]
    v_mul_f32 v50, s32, v50
    v_mfma_f32_16x16x32_bf16 a[4:7], a[172:175], a[148:151], a[4:7]
    ds_read_b64_tr_b16 a[186:187], v18 offset:23072
    v_mfma_f32_16x16x32_bf16 a[8:11], a[168:171], a[136:139], a[8:11]
    v_exp_f32 v50, v50
    s_nop 0
    v_mfma_f32_16x16x32_bf16 a[8:11], a[172:175], a[152:155], a[8:11]
    ds_read_b64_tr_b16 a[188:189], v18 offset:27680
    v_add_f32 v50, 1.0, v50
    v_mfma_f32_16x16x32_bf16 a[12:15], a[168:171], a[140:143], a[12:15]
    buffer_load_dwordx4 v10, s[16:19], s29 offen lds
    s_add_u32 m0, s92, 0
    v_mfma_f32_16x16x32_bf16 a[12:15], a[172:175], a[156:159], a[12:15]
    s_waitcnt lgkmcnt(3)
    ds_read_b64_tr_b16 a[190:191], v18 offset:32288
    v_mfma_f32_16x16x32_bf16 v[80:83], a[176:179], a[128:131], v[80:83]
    v_rcp_f32 v50, v50
    s_nop 0
    v_mfma_f32_16x16x32_bf16 v[80:83], a[180:183], a[144:147], v[80:83]
    ds_read_b64_tr_b16 a[192:193], v18 offset:64
    v_cvt_pk_bf16_f32 v50, v50, v50
    v_mfma_f32_16x16x32_bf16 v[84:87], a[176:179], a[132:135], v[84:87]
    buffer_load_dwordx4 v11, s[16:19], s29 offen lds
    s_add_u32 s29, s29, 64*9216
    v_mfma_f32_16x16x32_bf16 v[84:87], a[180:183], a[148:151], v[84:87]
    ds_read_b64_tr_b16 a[194:195], v18 offset:4672
    s_waitcnt vmcnt(18)
    v_mfma_f32_16x16x32_bf16 v[88:91], a[176:179], a[136:139], v[88:91]
    ds_read_b128 a[96:99], v14 offset:0
    v_lshlrev_b32 v50, 16, v50
    v_mfma_f32_16x16x32_bf16 v[88:91], a[180:183], a[152:155], v[88:91]
    ds_read_b64_tr_b16 a[196:197], v18 offset:9280
    v_sub_f32 v51, 1.0, v50
    v_mfma_f32_16x16x32_bf16 v[92:95], a[176:179], a[140:143], v[92:95]
    s_cmp_lt_u32 s49, 1072693248
    s_cbranch_scc0 L_sk_7
    buffer_store_dwordx4 a[224:227], v1, s[20:23], s49 offen sc1
L_sk_7:
    s_add_u32 s49, s49, 148480
    v_mfma_f32_16x16x32_bf16 v[92:95], a[180:183], a[156:159], v[92:95]
    s_waitcnt lgkmcnt(4)
    ds_read_b64_tr_b16 a[198:199], v18 offset:13888
    v_mfma_f32_16x16x32_bf16 a[16:19], a[184:187], a[128:131], a[16:19]
    ds_read_b128 a[112:115], v15 offset:0
    s_add_u32 m0, s84, 36864
    v_mfma_f32_16x16x32_bf16 a[16:19], a[188:191], a[144:147], a[16:19]
    ds_read_b64_tr_b16 a[200:201], v18 offset:18496
    v_cvt_pk_bf16_f32 v51, v51, v51
    v_mfma_f32_16x16x32_bf16 a[20:23], a[184:187], a[132:135], a[20:23]
    buffer_load_dwordx4 v3, s[16:19], s29 offen lds
    s_waitcnt lgkmcnt(1)
    v_mfma_f32_16x16x32_bf16 a[20:23], a[188:191], a[148:151], a[20:23]
    ds_read_b64_tr_b16 a[202:203], v18 offset:23104
    s_add_u32 s99, s93, 896
    v_mfma_f32_16x16x32_bf16 a[24:27], a[184:187], a[136:139], a[24:27]
    s_add_u32 m0, s31, 0
    v_lshlrev_b32 v51, 16, v51
    v_mfma_f32_16x16x32_bf16 a[24:27], a[188:191], a[152:155], a[24:27]
    ds_read_b64_tr_b16 a[204:205], v18 offset:27712
    v_mfma_f32_16x16x32_bf16 a[28:31], a[184:187], a[140:143], a[28:31]
    s_cmp_lt_u32 s49, 1072693248
    s_cbranch_scc0 L_sk_8
    buffer_store_dwordx4 a[228:231], v1, s[20:23], s49 offen sc1
L_sk_8:
    s_add_u32 s49, s49, 148480
    v_mfma_f32_16x16x32_bf16 a[28:31], a[188:191], a[156:159], a[28:31]
    ds_read_b64_tr_b16 a[206:207], v18 offset:32320
    v_mfma_f32_16x16x32_bf16 v[96:99], a[192:195], a[128:131], v[96:99]
    v_mfma_f32_16x16x32_bf16 v[96:99], a[196:199], a[144:147], v[96:99]
    ds_read_b64_tr_b16 a[160:161], v18 offset:96
    v_mfma_f32_16x16x32_bf16 v[100:103], a[192:195], a[132:135], v[100:103]
    buffer_store_dwordx2 v[50:51], v58, s[20:23], 0 offen sc1
    v_mfma_f32_16x16x32_bf16 v[100:103], a[196:199], a[148:151], v[100:103]
    ds_read_b64_tr_b16 a[162:163], v18 offset:4704
    v_mfma_f32_16x16x32_bf16 v[104:107], a[192:195], a[136:139], v[104:107]
    v_readfirstlane_b32 s98, v63
    s_nop 0
    s_cmp_ge_u32 s98, s35
    s_cbranch_scc0 L_spin_zc
L_back_zc:
    v_mfma_f32_16x16x32_bf16 v[104:107], a[196:199], a[152:155], v[104:107]
    ds_read_b64_tr_b16 a[164:165], v18 offset:9312
    s_and_b32 s41, s2, 63
    v_mfma_f32_16x16x32_bf16 v[108:111], a[192:195], a[140:143], v[108:111]
    s_lshl_b32 s41, s41, 7
    s_lshr_b32 s98, s2, 6
    s_lshl_b32 s98, s98, 2
    v_mfma_f32_16x16x32_bf16 v[108:111], a[196:199], a[156:159], v[108:111]
    s_waitcnt lgkmcnt(3)
    ds_read_b64_tr_b16 a[166:167], v18 offset:13920
    v_mfma_f32_16x16x32_bf16 a[32:35], a[200:203], a[128:131], a[32:35]
    s_add_u32 s41, s41, s98
    s_add_u32 s41, s41, 24856576
    v_lshlrev_b32 v50, 7, v2
    v_mfma_f32_16x16x32_bf16 a[32:35], a[204:207], a[144:147], a[32:35]
    ds_read_b64_tr_b16 a[168:169], v18 offset:18528
    s_cmp_eq_u32 s24, 0
    s_cselect_b32 s41, s41, 2147483632
    v_mfma_f32_16x16x32_bf16 a[36:39], a[200:203], a[132:135], a[36:39]
    s_mov_b32 s42, 2147483632
    s_cmp_eq_u32 s24, 3
    s_cselect_b32 s42, 24856576, s42
    s_lshl_b32 s43, s26, 6
    s_add_u32 s43, s43, 19922944
    v_mfma_f32_16x16x32_bf16 a[36:39], a[204:207], a[148:151], a[36:39]
    ds_read_b64_tr_b16 a[170:171], v18 offset:23136
    v_lshrrev_b32 v54, 2, v2
    v_mfma_f32_16x16x32_bf16 a[40:43], a[200:203], a[136:139], a[40:43]
    v_mul_u32_u24 v54, 36992, v54
    v_and_b32 v51, 3, v2
    v_mfma_f32_16x16x32_bf16 a[40:43], a[204:207], a[152:155], a[40:43]
    ds_read_b64_tr_b16 a[172:173], v18 offset:27744
    v_lshl_add_u32 v54, v51, 4, v54
    v_mfma_f32_16x16x32_bf16 a[44:47], a[200:203], a[140:143], a[44:47]
    s_cmp_lt_u32 s49, 1072693248
    s_cbranch_scc0 L_sk_9
    buffer_store_dwordx4 a[232:235], v1, s[20:23], s49 offen sc1
L_sk_9:
    s_add_u32 s49, s49, 148480
    v_mfma_f32_16x16x32_bf16 a[44:47], a[204:207], a[156:159], a[44:47]
    s_waitcnt lgkmcnt(3)
    ds_read_b64_tr_b16 a[174:175], v18 offset:32352
    v_mfma_f32_16x16x32_bf16 v[112:115], a[160:163], a[128:131], v[112:115]
    s_cmp_lt_u32 s26, 576
    s_cselect_b32 s43, s43, 2147483632
    v_mfma_f32_16x16x32_bf16 v[112:115], a[164:167], a[144:147], v[112:115]
    ds_read_b64_tr_b16 a[176:177], v18 offset:128
    v_mfma_f32_16x16x32_bf16 v[116:119], a[160:163], a[132:135], v[116:119]
    buffer_load_dwordx4 v12, s[12:15], s99 offen lds
    s_add_u32 m0, s31, 1024
    v_mfma_f32_16x16x32_bf16 v[116:119], a[164:167], a[148:151], v[116:119]
    ds_read_b64_tr_b16 a[178:179], v18 offset:4736
    v_mfma_f32_16x16x32_bf16 v[120:123], a[160:163], a[136:139], v[120:123]
    v_mfma_f32_16x16x32_bf16 v[120:123], a[164:167], a[152:155], v[120:123]
    ds_read_b64_tr_b16 a[180:181], v18 offset:9344
    v_mfma_f32_16x16x32_bf16 v[124:127], a[160:163], a[140:143], v[124:127]
    s_cmp_lt_u32 s49, 1072693248
    s_cbranch_scc0 L_sk_10
    buffer_store_dwordx4 a[236:239], v1, s[20:23], s49 offen sc1
L_sk_10:
    s_add_u32 s49, s49, 148480
    v_mfma_f32_16x16x32_bf16 v[124:127], a[164:167], a[156:159], v[124:127]
    s_waitcnt lgkmcnt(3)
    ds_read_b64_tr_b16 a[182:183], v18 offset:13952
    v_mfma_f32_16x16x32_bf16 a[48:51], a[168:171], a[128:131], a[48:51]
    v_mfma_f32_16x16x32_bf16 a[48:51], a[172:175], a[144:147], a[48:51]
    ds_read_b64_tr_b16 a[184:185], v18 offset:18560
    v_mfma_f32_16x16x32_bf16 a[52:55], a[168:171], a[132:135], a[52:55]
    buffer_load_dwordx4 v13, s[12:15], s99 offen lds
    s_add_u32 m0, s85, 36864
    v_mfma_f32_16x16x32_bf16 a[52:55], a[172:175], a[148:151], a[52:55]
    ds_read_b64_tr_b16 a[186:187], v18 offset:23168
    s_mul_i32 s100, s24, 21248
    v_mfma_f32_16x16x32_bf16 a[56:59], a[168:171], a[136:139], a[56:59]
    s_add_u32 s100, s100, 110592
    s_cmp_eq_u32 s24, 2
    s_cselect_b32 s100, 73728, s100
    v_add_u32 v46, s100, v1
    v_mfma_f32_16x16x32_bf16 a[56:59], a[172:175], a[152:155], a[56:59]
    ds_read_b64_tr_b16 a[188:189], v18 offset:27776
    v_lshlrev_b32 v60, 3, v2
    v_mfma_f32_16x16x32_bf16 a[60:63], a[168:171], a[140:143], a[60:63]
    buffer_load_dwordx4 v4, s[16:19], s29 offen lds
    s_waitcnt vmcnt(19)
    v_mfma_f32_16x16x32_bf16 a[60:63], a[172:175], a[156:159], a[60:63]
    s_waitcnt lgkmcnt(3)
    ds_read_b64_tr_b16 a[190:191], v18 offset:32384
    v_mfma_f32_16x16x32_bf16 v[128:131], a[176:179], a[128:131], v[128:131]
    ds_read_b128 a[100:103], v14 offset:2048
    v_add_u32 v60, s100, v60
    v_mfma_f32_16x16x32_bf16 v[128:131], a[180:183], a[144:147], v[128:131]
    ds_read_b64_tr_b16 a[192:193], v18 offset:160
    v_and_b32 v52, 3, v2
    v_mfma_f32_16x16x32_bf16 v[132:135], a[176:179], a[132:135], v[132:135]
    ds_read_b128 a[116:119], v15 offset:2048
    s_add_u32 m0, s86, 36864
    v_mfma_f32_16x16x32_bf16 v[132:135], a[180:183], a[148:151], v[132:135]
    ds_read_b64_tr_b16 a[194:195], v18 offset:4768
    v_mul_u32_u24 v47, 4160, v52
    v_mfma_f32_16x16x32_bf16 v[136:139], a[176:179], a[136:139], v[136:139]
    buffer_load_dwordx4 v5, s[16:19], s29 offen lds
    s_waitcnt lgkmcnt(1)
    v_mfma_f32_16x16x32_bf16 v[136:139], a[180:183], a[152:155], v[136:139]
    ds_read_b64_tr_b16 a[196:197], v18 offset:9376
    s_add_u32 s99, s94, 896
    v_mfma_f32_16x16x32_bf16 v[140:143], a[176:179], a[140:143], v[140:143]
    s_add_u32 m0, s31, 2048
    v_bfe_u32 v52, v2, 2, 2
    v_lshrrev_b32 v53, 4, v2
    v_mfma_f32_16x16x32_bf16 v[140:143], a[180:183], a[156:159], v[140:143]
    ds_read_b64_tr_b16 a[198:199], v18 offset:13984
    v_lshlrev_b32 v49, 1, v53
    v_mfma_f32_16x16x32_bf16 a[64:67], a[184:187], a[128:131], a[64:67]
    buffer_load_dwordx4 v12, s[12:15], s99 offen lds
    s_add_u32 m0, s31, 3072
    v_mfma_f32_16x16x32_bf16 a[64:67], a[188:191], a[144:147], a[64:67]
    ds_read_b64_tr_b16 a[200:201], v18 offset:18592
    v_sub_u32 v52, v52, v49
    v_mfma_f32_16x16x32_bf16 a[68:71], a[184:187], a[132:135], a[68:71]
    v_add_u32 v52, 6, v52
    v_lshl_add_u32 v47, v52, 3, v47
    v_mfma_f32_16x16x32_bf16 a[68:71], a[188:191], a[148:151], a[68:71]
    ds_read_b64_tr_b16 a[202:203], v18 offset:23200
    v_add_u32 v47, s100, v47
    v_mfma_f32_16x16x32_bf16 a[72:75], a[184:187], a[136:139], a[72:75]
    buffer_load_dwordx4 v13, s[12:15], s99 offen lds
    s_add_u32 m0, s87, 36864
    v_mfma_f32_16x16x32_bf16 a[72:75], a[188:191], a[152:155], a[72:75]
    ds_read_b64_tr_b16 a[204:205], v18 offset:27808
    s_add_u32 s101, s100, 16672
    v_mfma_f32_16x16x32_bf16 a[76:79], a[184:187], a[140:143], a[76:79]
    v_and_b32 v52, 15, v2
    v_lshl_add_u32 v48, v52, 1, v53
    v_mfma_f32_16x16x32_bf16 a[76:79], a[188:191], a[156:159], a[76:79]
    s_waitcnt lgkmcnt(3)
    ds_read_b64_tr_b16 a[206:207], v18 offset:32416
    v_mfma_f32_16x16x32_bf16 v[144:147], a[192:195], a[128:131], v[144:147]
    buffer_load_dwordx4 v6, s[16:19], s29 offen lds
    s_waitcnt vmcnt(18)
    v_mfma_f32_16x16x32_bf16 v[144:147], a[196:199], a[144:147], v[144:147]
    ds_read_b64_tr_b16 a[160:161], v18 offset:192
    v_lshlrev_b32 v48, 4, v48
    v_mfma_f32_16x16x32_bf16 v[148:151], a[192:195], a[132:135], v[148:151]
    ds_read_b128 a[104:107], v14 offset:4096
    v_add_u32 v48, s101, v48
    v_mfma_f32_16x16x32_bf16 v[148:151], a[196:199], a[148:151], v[148:151]
    ds_read_b64_tr_b16 a[162:163], v18 offset:4800
    v_lshlrev_b32 v62, 5, v52
    v_mfma_f32_16x16x32_bf16 v[152:155], a[192:195], a[136:139], v[152:155]
    ds_read_b128 a[120:123], v15 offset:4096
    s_add_u32 m0, s88, 36864
    v_mfma_f32_16x16x32_bf16 v[152:155], a[196:199], a[152:155], v[152:155]
    ds_read_b64_tr_b16 a[164:165], v18 offset:9408
    v_lshl_add_u32 v62, v53, 3, v62
    v_mfma_f32_16x16x32_bf16 v[156:159], a[192:195], a[140:143], v[156:159]
    buffer_load_dwordx4 v7, s[16:19], s29 offen lds
    s_waitcnt lgkmcnt(1)
    v_mfma_f32_16x16x32_bf16 v[156:159], a[196:199], a[156:159], v[156:159]
    ds_read_b64_tr_b16 a[166:167], v18 offset:14016
    s_add_u32 s99, s95, 896
    v_mfma_f32_16x16x32_bf16 a[80:83], a[200:203], a[128:131], a[80:83]
    s_add_u32 m0, s31, 4096
    v_add_u32 v62, s100, v62
    s_add_u32 s101, s100, 17160
    v_mfma_f32_16x16x32_bf16 a[80:83], a[204:207], a[144:147], a[80:83]
    ds_read_b64_tr_b16 a[168:169], v18 offset:18624
    v_lshrrev_b32 v49, 1, v53
    v_mfma_f32_16x16x32_bf16 a[84:87], a[200:203], a[132:135], a[84:87]
    buffer_load_dwordx4 v12, s[12:15], s99 offen lds
    s_add_u32 m0, s31, 5120
    v_mfma_f32_16x16x32_bf16 a[84:87], a[204:207], a[148:151], a[84:87]
    ds_read_b64_tr_b16 a[170:171], v18 offset:23232
    v_lshl_add_u32 v49, v52, 1, v49
    v_mfma_f32_16x16x32_bf16 a[88:91], a[200:203], a[136:139], a[88:91]
    v_lshlrev_b32 v49, 4, v49
    v_and_b32 v53, 1, v53
    v_mfma_f32_16x16x32_bf16 a[88:91], a[204:207], a[152:155], a[88:91]
    ds_read_b64_tr_b16 a[172:173], v18 offset:27840
    v_lshlrev_b32 v53, 3, v53
    v_mfma_f32_16x16x32_bf16 a[92:95], a[200:203], a[140:143], a[92:95]
    buffer_load_dwordx4 v13, s[12:15], s99 offen lds
    s_add_u32 m0, s89, 36864
    v_mfma_f32_16x16x32_bf16 a[92:95], a[204:207], a[156:159], a[92:95]
    s_waitcnt lgkmcnt(3)
    ds_read_b64_tr_b16 a[174:175], v18 offset:32448
    v_mfma_f32_16x16x32_bf16 v[160:163], a[160:163], a[128:131], v[160:163]
    v_sub_u32 v49, v49, v53
    v_add_u32 v49, s101, v49
    v_mfma_f32_16x16x32_bf16 v[160:163], a[164:167], a[144:147], v[160:163]
    ds_read_b64_tr_b16 a[176:177], v18 offset:224
    v_and_b32 v51, 7, v2
    v_mfma_f32_16x16x32_bf16 v[164:167], a[160:163], a[132:135], v[164:167]
    v_lshlrev_b32 v51, 2, v51
    v_add_u32 v59, 148480, v1
    v_mfma_f32_16x16x32_bf16 v[164:167], a[164:167], a[148:151], v[164:167]
    ds_read_b64_tr_b16 a[178:179], v18 offset:4832
    v_mov_b32 v52, 0
    v_mfma_f32_16x16x32_bf16 v[168:171], a[160:163], a[136:139], v[168:171]
    buffer_load_dwordx4 v8, s[16:19], s29 offen lds
    s_waitcnt vmcnt(16)
    v_mfma_f32_16x16x32_bf16 v[168:171], a[164:167], a[152:155], v[168:171]
    ds_read_b64_tr_b16 a[180:181], v18 offset:9440
    v_mov_b32 v53, 0
    v_mfma_f32_16x16x32_bf16 v[172:175], a[160:163], a[140:143], v[172:175]
    ds_read_b128 a[108:111], v14 offset:6144
    v_mfma_f32_16x16x32_bf16 v[172:175], a[164:167], a[156:159], v[172:175]
    s_waitcnt lgkmcnt(4)
    ds_read_b64_tr_b16 a[182:183], v18 offset:14048
    v_mfma_f32_16x16x32_bf16 v[208:211], a[168:171], a[128:131], v[208:211]
    ds_read_b128 a[124:127], v15 offset:6144
    s_add_u32 m0, s90, 36864
    v_mfma_f32_16x16x32_bf16 v[208:211], a[172:175], a[144:147], v[208:211]
    ds_read_b64_tr_b16 a[184:185], v18 offset:18656
    v_mfma_f32_16x16x32_bf16 v[212:215], a[168:171], a[132:135], v[212:215]
    v_mfma_f32_16x16x32_bf16 v[212:215], a[172:175], a[148:151], v[212:215]
    ds_read_b64_tr_b16 a[186:187], v18 offset:23264
    v_mfma_f32_16x16x32_bf16 v[216:219], a[168:171], a[136:139], v[216:219]
    buffer_load_dwordx4 v9, s[16:19], s29 offen lds
    s_waitcnt lgkmcnt(2)
    v_mfma_f32_16x16x32_bf16 v[216:219], a[172:175], a[152:155], v[216:219]
    ds_read_b64_tr_b16 a[188:189], v18 offset:27872
    s_add_u32 s99, s96, 896
    v_mfma_f32_16x16x32_bf16 v[220:223], a[168:171], a[140:143], v[220:223]
    s_add_u32 m0, s31, 6144
    v_mfma_f32_16x16x32_bf16 v[220:223], a[172:175], a[156:159], v[220:223]
    ds_read_b64_tr_b16 a[190:191], v18 offset:32480
    v_mfma_f32_16x16x32_bf16 v[176:179], a[176:179], a[128:131], v[176:179]
    v_mfma_f32_16x16x32_bf16 v[176:179], a[180:183], a[144:147], v[176:179]
    ds_read_b64_tr_b16 a[192:193], v18 offset:256
    v_mfma_f32_16x16x32_bf16 v[180:183], a[176:179], a[132:135], v[180:183]
    buffer_load_dwordx4 v12, s[12:15], s99 offen lds
    s_add_u32 m0, s31, 7168
    v_mfma_f32_16x16x32_bf16 v[180:183], a[180:183], a[148:151], v[180:183]
    ds_read_b64_tr_b16 a[194:195], v18 offset:4864
    v_mfma_f32_16x16x32_bf16 v[184:187], a[176:179], a[136:139], v[184:187]
    v_mfma_f32_16x16x32_bf16 v[184:187], a[180:183], a[152:155], v[184:187]
    ds_read_b64_tr_b16 a[196:197], v18 offset:9472
    v_mfma_f32_16x16x32_bf16 v[188:191], a[176:179], a[140:143], v[188:191]
    v_mfma_f32_16x16x32_bf16 v[188:191], a[180:183], a[156:159], v[188:191]
    s_waitcnt lgkmcnt(3)
    ds_read_b64_tr_b16 a[198:199], v18 offset:14080
    v_mfma_f32_16x16x32_bf16 v[224:227], a[184:187], a[128:131], v[224:227]
    v_mfma_f32_16x16x32_bf16 v[224:227], a[188:191], a[144:147], v[224:227]
    ds_read_b64_tr_b16 a[200:201], v18 offset:18688
    v_mfma_f32_16x16x32_bf16 v[228:231], a[184:187], a[132:135], v[228:231]
    buffer_load_dwordx4 v13, s[12:15], s99 offen lds
    s_add_u32 m0, s91, 36864
    v_mfma_f32_16x16x32_bf16 v[228:231], a[188:191], a[148:151], v[228:231]
    ds_read_b64_tr_b16 a[202:203], v18 offset:23296
    v_mfma_f32_16x16x32_bf16 v[232:235], a[184:187], a[136:139], v[232:235]
    v_mfma_f32_16x16x32_bf16 v[232:235], a[188:191], a[152:155], v[232:235]
    ds_read_b64_tr_b16 a[204:205], v18 offset:27904
    v_mfma_f32_16x16x32_bf16 v[236:239], a[184:187], a[140:143], v[236:239]
    v_mfma_f32_16x16x32_bf16 v[236:239], a[188:191], a[156:159], v[236:239]
    s_waitcnt lgkmcnt(3)
    ds_read_b64_tr_b16 a[206:207], v18 offset:32512
    v_mfma_f32_16x16x32_bf16 v[192:195], a[192:195], a[128:131], v[192:195]
    v_mfma_f32_16x16x32_bf16 v[192:195], a[196:199], a[144:147], v[192:195]
    buffer_load_dwordx4 v10, s[16:19], s29 offen lds
    s_add_u32 m0, s92, 36864
    v_mfma_f32_16x16x32_bf16 v[196:199], a[192:195], a[132:135], v[196:199]
    v_mfma_f32_16x16x32_bf16 v[196:199], a[196:199], a[148:151], v[196:199]
    s_waitcnt lgkmcnt(0)
    s_waitcnt vmcnt(15)
    s_waitcnt vmcnt(12)
    s_barrier
    v_mfma_f32_16x16x32_bf16 v[200:203], a[192:195], a[136:139], v[200:203]
    ds_read_b64_tr_b16 a[160:161], v16 offset:0
    v_mfma_f32_16x16x32_bf16 v[200:203], a[196:199], a[152:155], v[200:203]
    ds_read_b64_tr_b16 a[162:163], v16 offset:4608
    v_mfma_f32_16x16x32_bf16 v[204:207], a[192:195], a[140:143], v[204:207]
    ds_read_b64_tr_b16 a[164:165], v16 offset:9216
    v_mfma_f32_16x16x32_bf16 v[204:207], a[196:199], a[156:159], v[204:207]
    ds_read_b64_tr_b16 a[166:167], v16 offset:13824
    v_mfma_f32_16x16x32_bf16 v[240:243], a[200:203], a[128:131], v[240:243]
    buffer_load_dwordx4 v11, s[16:19], s29 offen lds
    s_add_u32 s29, s29, 64*9216
    v_mfma_f32_16x16x32_bf16 v[240:243], a[204:207], a[144:147], v[240:243]
    ds_read_b64_tr_b16 a[168:169], v16 offset:18432
    v_mfma_f32_16x16x32_bf16 v[244:247], a[200:203], a[132:135], v[244:247]
    v_mfma_f32_16x16x32_bf16 v[244:247], a[204:207], a[148:151], v[244:247]
    ds_read_b64_tr_b16 a[170:171], v16 offset:23040
    v_mfma_f32_16x16x32_bf16 v[248:251], a[200:203], a[136:139], v[248:251]
    v_mfma_f32_16x16x32_bf16 v[248:251], a[204:207], a[152:155], v[248:251]
    ds_read_b64_tr_b16 a[172:173], v16 offset:27648
    v_mfma_f32_16x16x32_bf16 v[252:255], a[200:203], a[140:143], v[252:255]
    v_mfma_f32_16x16x32_bf16 v[252:255], a[204:207], a[156:159], v[252:255]
    s_waitcnt lgkmcnt(3)
    ds_read_b64_tr_b16 a[174:175], v16 offset:32256
    v_mfma_f32_16x16x32_bf16 v[64:67], a[160:163], a[96:99], v[64:67]
    s_mov_b64 exec, 1
    buffer_store_dword v45, v44, s[20:23], s41 offen sc1
    s_mov_b64 exec, -1
    v_mfma_f32_16x16x32_bf16 v[64:67], a[164:167], a[112:115], v[64:67]
    ds_read_b64_tr_b16 a[176:177], v16 offset:32
    s_lshr_b32 s98, s33, 1
    v_mfma_f32_16x16x32_bf16 v[68:71], a[160:163], a[100:103], v[68:71]
    ds_read_b128 a[128:131], v14 offset:0
    s_and_b32 s100, s33, 1
    v_mfma_f32_16x16x32_bf16 v[68:71], a[164:167], a[116:119], v[68:71]
    ds_read_b64_tr_b16 a[178:179], v16 offset:4640
    s_lshl_b32 s100, s100, 3
    v_mfma_f32_16x16x32_bf16 v[72:75], a[160:163], a[104:107], v[72:75]
    ds_read_b128 a[144:147], v15 offset:0
    s_add_u32 m0, s84, 73728
    v_mfma_f32_16x16x32_bf16 v[72:75], a[164:167], a[120:123], v[72:75]
    ds_read_b64_tr_b16 a[180:181], v16 offset:9248
    s_lshr_b32 s101, s34, 2
    v_mfma_f32_16x16x32_bf16 v[76:79], a[160:163], a[108:111], v[76:79]
    buffer_load_dwordx4 v3, s[16:19], s29 offen lds
    s_waitcnt lgkmcnt(1)
    v_mfma_f32_16x16x32_bf16 v[76:79], a[164:167], a[124:127], v[76:79]
    ds_read_b64_tr_b16 a[182:183], v16 offset:13856
    s_add_u32 s99, s93, 1024
    v_mfma_f32_16x16x32_bf16 a[0:3], a[168:171], a[96:99], a[0:3]
    s_add_u32 m0, s31, 0
    s_add_u32 s100, s100, s101
    s_mul_i32 s48, s3, 145
    v_mfma_f32_16x16x32_bf16 a[0:3], a[172:175], a[112:115], a[0:3]
    ds_read_b64_tr_b16 a[184:185], v16 offset:18464
    s_mul_i32 s101, s98, 36
    v_mfma_f32_16x16x32_bf16 a[4:7], a[168:171], a[100:103], a[4:7]
    buffer_load_dwordx4 v12, s[12:15], s99 offen lds
    s_add_u32 m0, s31, 1024
    v_mfma_f32_16x16x32_bf16 a[4:7], a[172:175], a[116:119], a[4:7]
    ds_read_b64_tr_b16 a[186:187], v16 offset:23072
    s_add_u32 s48, s48, s101
    v_mfma_f32_16x16x32_bf16 a[8:11], a[168:171], a[104:107], a[8:11]
    s_mul_i32 s101, s24, 9
    s_add_u32 s48, s48, s101
    s_lshl_b32 s48, s48, 10
    v_mfma_f32_16x16x32_bf16 a[8:11], a[172:175], a[120:123], a[8:11]
    ds_read_b64_tr_b16 a[188:189], v16 offset:27680
    s_add_u32 s48, s48, 29917184
    v_mfma_f32_16x16x32_bf16 a[12:15], a[168:171], a[108:111], a[12:15]
    buffer_load_dwordx4 v13, s[12:15], s99 offen lds
    s_add_u32 m0, s85, 73728
    v_mfma_f32_16x16x32_bf16 a[12:15], a[172:175], a[124:127], a[12:15]
    s_waitcnt lgkmcnt(3)
    ds_read_b64_tr_b16 a[190:191], v16 offset:32288
    v_mfma_f32_16x16x32_bf16 v[80:83], a[176:179], a[96:99], v[80:83]
    s_mul_i32 s50, s100, 128*1152
    s_mul_i32 s101, s3, 256
    s_add_u32 s49, s50, s101
    v_mfma_f32_16x16x32_bf16 v[80:83], a[180:183], a[112:115], v[80:83]
    ds_read_b64_tr_b16 a[192:193], v16 offset:64
    s_lshl_b32 s101, s98, 6
    v_mfma_f32_16x16x32_bf16 v[84:87], a[176:179], a[100:103], v[84:87]
    buffer_load_dwordx4 v4, s[16:19], s29 offen lds
    s_waitcnt vmcnt(15)
    v_mfma_f32_16x16x32_bf16 v[84:87], a[180:183], a[116:119], v[84:87]
    ds_read_b64_tr_b16 a[194:195], v16 offset:4672
    s_add_u32 s49, s49, s101
    v_mfma_f32_16x16x32_bf16 v[88:91], a[176:179], a[104:107], v[88:91]
    ds_read_b128 a[132:135], v14 offset:2048
    s_mul_i32 s101, s24, 32*1152
    v_mfma_f32_16x16x32_bf16 v[88:91], a[180:183], a[120:123], v[88:91]
    ds_read_b64_tr_b16 a[196:197], v16 offset:9280
    s_add_u32 s49, s49, s101
    v_mfma_f32_16x16x32_bf16 v[92:95], a[176:179], a[108:111], v[92:95]
    ds_read_b128 a[148:151], v15 offset:2048
    s_add_u32 m0, s86, 73728
    v_mfma_f32_16x16x32_bf16 v[92:95], a[180:183], a[124:127], v[92:95]
    s_waitcnt lgkmcnt(5)
    ds_read_b64_tr_b16 a[198:199], v16 offset:13888
    v_mfma_f32_16x16x32_bf16 a[16:19], a[184:187], a[96:99], a[16:19]
    buffer_load_dwordx4 v5, s[16:19], s29 offen lds
    s_waitcnt lgkmcnt(1)
    v_mfma_f32_16x16x32_bf16 a[16:19], a[188:191], a[112:115], a[16:19]
    ds_read_b64_tr_b16 a[200:201], v16 offset:18496
    s_add_u32 s99, s94, 1024
    v_mfma_f32_16x16x32_bf16 a[20:23], a[184:187], a[100:103], a[20:23]
    s_add_u32 m0, s31, 2048
    s_mul_i32 s101, s98, 32*1152
    s_add_u32 s50, s50, s101
    v_mfma_f32_16x16x32_bf16 a[20:23], a[188:191], a[116:119], a[20:23]
    ds_read_b64_tr_b16 a[202:203], v16 offset:23104
    s_mul_i32 s101, s3, 32
    v_mfma_f32_16x16x32_bf16 a[24:27], a[184:187], a[104:107], a[24:27]
    buffer_load_dwordx4 v12, s[12:15], s99 offen lds
    s_add_u32 m0, s31, 3072
    v_mfma_f32_16x16x32_bf16 a[24:27], a[188:191], a[120:123], a[24:27]
    ds_read_b64_tr_b16 a[204:205], v16 offset:27712
    s_add_u32 s50, s50, s101
    v_mfma_f32_16x16x32_bf16 a[28:31], a[184:187], a[108:111], a[28:31]
    s_add_u32 s50, s50, 1024
    s_lshl_b32 s51, s100, 10
    s_add_u32 s51, s51, 24772608
    v_mfma_f32_16x16x32_bf16 a[28:31], a[188:191], a[124:127], a[28:31]
    s_waitcnt lgkmcnt(3)
    ds_read_b64_tr_b16 a[206:207], v16 offset:32320
    v_mfma_f32_16x16x32_bf16 v[96:99], a[192:195], a[96:99], v[96:99]
    buffer_load_dwordx4 v13, s[12:15], s99 offen lds
    s_add_u32 m0, s87, 73728
    v_mfma_f32_16x16x32_bf16 v[96:99], a[196:199], a[112:115], v[96:99]
    ds_read_b64_tr_b16 a[160:161], v16 offset:96
    s_lshl_b32 s56, s24, 11
    v_mfma_f32_16x16x32_bf16 v[100:103], a[192:195], a[100:103], v[100:103]
    s_add_u32 s56, s56, 153088
    v_lshrrev_b32 v55, 2, v2
    v_mul_u32_u24 v55, 1152, v55
    v_mfma_f32_16x16x32_bf16 v[100:103], a[196:199], a[116:119], v[100:103]
    ds_read_b64_tr_b16 a[162:163], v16 offset:4704
    v_and_b32 v56, 3, v2
    v_mfma_f32_16x16x32_bf16 v[104:107], a[192:195], a[104:107], v[104:107]
    buffer_load_dwordx4 v6, s[16:19], s29 offen lds
    s_waitcnt vmcnt(15)
    v_mfma_f32_16x16x32_bf16 v[104:107], a[196:199], a[120:123], v[104:107]
    ds_read_b64_tr_b16 a[164:165], v16 offset:9312
    v_lshl_add_u32 v55, v56, 4, v55
    v_mfma_f32_16x16x32_bf16 v[108:111], a[192:195], a[108:111], v[108:111]
    ds_read_b128 a[136:139], v14 offset:4096
    v_lshrrev_b32 v56, 1, v2
    v_mfma_f32_16x16x32_bf16 v[108:111], a[196:199], a[124:127], v[108:111]
    s_waitcnt lgkmcnt(4)
    ds_read_b64_tr_b16 a[166:167], v16 offset:13920
    v_mfma_f32_16x16x32_bf16 a[32:35], a[200:203], a[96:99], a[32:35]
    ds_read_b128 a[152:155], v15 offset:4096
    s_add_u32 m0, s88, 73728
    v_mfma_f32_16x16x32_bf16 a[32:35], a[204:207], a[112:115], a[32:35]
    ds_read_b64_tr_b16 a[168:169], v16 offset:18528
    v_mul_u32_u24 v56, 1152, v56
    v_mfma_f32_16x16x32_bf16 a[36:39], a[200:203], a[100:103], a[36:39]
    buffer_load_dwordx4 v7, s[16:19], s29 offen lds
    s_waitcnt lgkmcnt(1)
    v_mfma_f32_16x16x32_bf16 a[36:39], a[204:207], a[116:119], a[36:39]
    ds_read_b64_tr_b16 a[170:171], v16 offset:23136
    s_add_u32 s99, s95, 1024
    v_mfma_f32_16x16x32_bf16 a[40:43], a[200:203], a[104:107], a[40:43]
    s_add_u32 m0, s31, 4096
    v_and_b32 v57, 1, v2
    v_lshl_add_u32 v56, v57, 4, v56
    v_mfma_f32_16x16x32_bf16 a[40:43], a[204:207], a[120:123], a[40:43]
    ds_read_b64_tr_b16 a[172:173], v16 offset:27744
    s_lshr_b32 s54, s33, 1
    v_mfma_f32_16x16x32_bf16 a[44:47], a[200:203], a[108:111], a[44:47]
    buffer_load_dwordx4 v12, s[12:15], s99 offen lds
    s_add_u32 m0, s31, 5120
    v_mfma_f32_16x16x32_bf16 a[44:47], a[204:207], a[124:127], a[44:47]
    ds_read_b64_tr_b16 a[174:175], v16 offset:32352
    s_and_b32 s100, s33, 1
    v_mfma_f32_16x16x32_bf16 v[112:115], a[160:163], a[96:99], v[112:115]
    s_lshl_b32 s100, s100, 5
    s_add_u32 s100, s100, s34
    s_mul_i32 s100, s100, 152576
    v_mfma_f32_16x16x32_bf16 v[112:115], a[164:167], a[112:115], v[112:115]
    ds_read_b64_tr_b16 a[176:177], v16 offset:128
    s_lshl_b32 s101, s24, 10
    v_mfma_f32_16x16x32_bf16 v[116:119], a[160:163], a[100:103], v[116:119]
    buffer_load_dwordx4 v13, s[12:15], s99 offen lds
    s_add_u32 m0, s89, 73728
    v_mfma_f32_16x16x32_bf16 v[116:119], a[164:167], a[116:119], v[116:119]
    ds_read_b64_tr_b16 a[178:179], v16 offset:4736
    s_add_u32 s100, s100, s101
    v_mfma_f32_16x16x32_bf16 v[120:123], a[160:163], a[104:107], v[120:123]
    s_add_u32 s100, s100, 31457280
    s_lshl_b32 s101, s54, 15
    s_add_u32 s52, s100, s101
    v_mfma_f32_16x16x32_bf16 v[120:123], a[164:167], a[120:123], v[120:123]
    ds_read_b64_tr_b16 a[180:181], v16 offset:9344
    s_add_u32 s53, s100, 131072
    v_mfma_f32_16x16x32_bf16 v[124:127], a[160:163], a[108:111], v[124:127]
    buffer_load_dwordx4 v8, s[16:19], s29 offen lds
    s_waitcnt vmcnt(15)
    v_mfma_f32_16x16x32_bf16 v[124:127], a[164:167], a[124:127], v[124:127]
    s_waitcnt lgkmcnt(3)
    ds_read_b64_tr_b16 a[182:183], v16 offset:13952
    v_mfma_f32_16x16x32_bf16 a[48:51], a[168:171], a[96:99], a[48:51]
    ds_read_b128 a[140:143], v14 offset:6144
    v_mov_b32 v20, -1
    v_mfma_f32_16x16x32_bf16 a[48:51], a[172:175], a[112:115], a[48:51]
    ds_read_b64_tr_b16 a[184:185], v16 offset:18560
    v_mov_b32 v21, -1
    v_mfma_f32_16x16x32_bf16 a[52:55], a[168:171], a[100:103], a[52:55]
    ds_read_b128 a[156:159], v15 offset:6144
    s_add_u32 m0, s90, 73728
    v_mfma_f32_16x16x32_bf16 a[52:55], a[172:175], a[116:119], a[52:55]
    ds_read_b64_tr_b16 a[186:187], v16 offset:23168
    v_mov_b32 v22, -1
    v_mfma_f32_16x16x32_bf16 a[56:59], a[168:171], a[104:107], a[56:59]
    buffer_load_dwordx4 v9, s[16:19], s29 offen lds
    s_waitcnt lgkmcnt(1)
    v_mfma_f32_16x16x32_bf16 a[56:59], a[172:175], a[120:123], a[56:59]
    ds_read_b64_tr_b16 a[188:189], v16 offset:27776
    s_add_u32 s99, s96, 1024
    v_mfma_f32_16x16x32_bf16 a[60:63], a[168:171], a[108:111], a[60:63]
    s_add_u32 m0, s31, 6144
    v_mov_b32 v23, -1
    v_mfma_f32_16x16x32_bf16 a[60:63], a[172:175], a[124:127], a[60:63]
    ds_read_b64_tr_b16 a[190:191], v16 offset:32384
    v_mfma_f32_16x16x32_bf16 v[128:131], a[176:179], a[96:99], v[128:131]
    s_and_b32 s98, s34, 31
    s_lshl_b32 s98, s98, 2
    s_add_u32 s98, s98, s24
    s_lshl_b32 s98, s98, 7
    s_add_u32 s98, s98, 28672
    s_min_u32 s98, s98, L_code_end-L_pf_here-8
    v_mov_b32 v61, s98
    s_mov_b64 exec, 1
    global_load_dword v0, v61, s[60:61]
    s_mov_b64 exec, -1
    v_mfma_f32_16x16x32_bf16 v[128:131], a[180:183], a[112:115], v[128:131]
    ds_read_b64_tr_b16 a[192:193], v16 offset:160
    v_mfma_f32_16x16x32_bf16 v[132:135], a[176:179], a[100:103], v[132:135]
    buffer_load_dwordx4 v12, s[12:15], s99 offen lds
    s_add_u32 m0, s31, 7168
    v_mfma_f32_16x16x32_bf16 v[132:135], a[180:183], a[116:119], v[132:135]
    ds_read_b64_tr_b16 a[194:195], v16 offset:4768
    v_mfma_f32_16x16x32_bf16 v[136:139], a[176:179], a[104:107], v[136:139]
    v_mfma_f32_16x16x32_bf16 v[136:139], a[180:183], a[120:123], v[136:139]
    ds_read_b64_tr_b16 a[196:197], v16 offset:9376
    v_mfma_f32_16x16x32_bf16 v[140:143], a[176:179], a[108:111], v[140:143]
    buffer_load_dwordx4 v13, s[12:15], s99 offen lds
    s_add_u32 m0, s91, 73728
    v_mfma_f32_16x16x32_bf16 v[140:143], a[180:183], a[124:127], v[140:143]
    s_waitcnt lgkmcnt(3)
    ds_read_b64_tr_b16 a[198:199], v16 offset:13984
    v_mfma_f32_16x16x32_bf16 a[64:67], a[184:187], a[96:99], a[64:67]
    v_mfma_f32_16x16x32_bf16 a[64:67], a[188:191], a[112:115], a[64:67]
    ds_read_b64_tr_b16 a[200:201], v16 offset:18592
    v_mfma_f32_16x16x32_bf16 a[68:71], a[184:187], a[100:103], a[68:71]
    buffer_load_dwordx4 v10, s[16:19], s29 offen lds
    s_add_u32 m0, s92, 73728
    v_mfma_f32_16x16x32_bf16 a[68:71], a[188:191], a[116:119], a[68:71]
    ds_read_b64_tr_b16 a[202:203], v16 offset:23200
    v_mfma_f32_16x16x32_bf16 a[72:75], a[184:187], a[104:107], a[72:75]
    v_mfma_f32_16x16x32_bf16 a[72:75], a[188:191], a[120:123], a[72:75]
    ds_read_b64_tr_b16 a[204:205], v16 offset:27808
    v_mfma_f32_16x16x32_bf16 a[76:79], a[184:187], a[108:111], a[76:79]
    buffer_load_dwordx4 v11, s[16:19], s29 offen lds
    s_add_u32 s29, s29, 64*9216
    v_mfma_f32_16x16x32_bf16 a[76:79], a[188:191], a[124:127], a[76:79]
    s_waitcnt lgkmcnt(3)
    ds_read_b64_tr_b16 a[206:207], v16 offset:32416
    v_mfma_f32_16x16x32_bf16 v[144:147], a[192:195], a[96:99], v[144:147]
    v_mfma_f32_16x16x32_bf16 v[144:147], a[196:199], a[112:115], v[144:147]
    ds_read_b64_tr_b16 a[160:161], v16 offset:192
    v_mfma_f32_16x16x32_bf16 v[148:151], a[192:195], a[100:103], v[148:151]
    v_mfma_f32_16x16x32_bf16 v[148:151], a[196:199], a[116:119], v[148:151]
    ds_read_b64_tr_b16 a[162:163], v16 offset:4800
    v_mfma_f32_16x16x32_bf16 v[152:155], a[192:195], a[104:107], v[152:155]
    v_mfma_f32_16x16x32_bf16 v[152:155], a[196:199], a[120:123], v[152:155]
    ds_read_b64_tr_b16 a[164:165], v16 offset:9408
    v_mfma_f32_16x16x32_bf16 v[156:159], a[192:195], a[108:111], v[156:159]
    v_mfma_f32_16x16x32_bf16 v[156:159], a[196:199], a[124:127], v[156:159]
    s_waitcnt lgkmcnt(3)
    ds_read_b64_tr_b16 a[166:167], v16 offset:14016
    v_mfma_f32_16x16x32_bf16 a[80:83], a[200:203], a[96:99], a[80:83]
    v_mfma_f32_16x16x32_bf16 a[80:83], a[204:207], a[112:115], a[80:83]
    ds_read_b64_tr_b16 a[168:169], v16 offset:18624
    v_mfma_f32_16x16x32_bf16 a[84:87], a[200:203], a[100:103], a[84:87]
    v_mfma_f32_16x16x32_bf16 a[84:87], a[204:207], a[116:119], a[84:87]
    ds_read_b64_tr_b16 a[170:171], v16 offset:23232
    v_mfma_f32_16x16x32_bf16 a[88:91], a[200:203], a[104:107], a[88:91]
    v_mfma_f32_16x16x32_bf16 a[88:91], a[204:207], a[120:123], a[88:91]
    ds_read_b64_tr_b16 a[172:173], v16 offset:27840
    v_mfma_f32_16x16x32_bf16 a[92:95], a[200:203], a[108:111], a[92:95]
    v_mfma_f32_16x16x32_bf16 a[92:95], a[204:207], a[124:127], a[92:95]
    s_waitcnt lgkmcnt(3)
    ds_read_b64_tr_b16 a[174:175], v16 offset:32448
    v_mfma_f32_16x16x32_bf16 v[160:163], a[160:163], a[96:99], v[160:163]
    v_mfma_f32_16x16x32_bf16 v[160:163], a[164:167], a[112:115], v[160:163]
    ds_read_b64_tr_b16 a[176:177], v16 offset:224
    v_mfma_f32_16x16x32_bf16 v[164:167], a[160:163], a[100:103], v[164:167]
    v_mfma_f32_16x16x32_bf16 v[164:167], a[164:167], a[116:119], v[164:167]
    ds_read_b64_tr_b16 a[178:179], v16 offset:4832
    v_mfma_f32_16x16x32_bf16 v[168:171], a[160:163], a[104:107], v[168:171]
    v_mfma_f32_16x16x32_bf16 v[168:171], a[164:167], a[120:123], v[168:171]
    ds_read_b64_tr_b16 a[180:181], v16 offset:9440
    v_mfma_f32_16x16x32_bf16 v[172:175], a[160:163], a[108:111], v[172:175]
    v_mfma_f32_16x16x32_bf16 v[172:175], a[164:167], a[124:127], v[172:175]
    s_waitcnt lgkmcnt(3)
    ds_read_b64_tr_b16 a[182:183], v16 offset:14048
    v_mfma_f32_16x16x32_bf16 v[208:211], a[168:171], a[96:99], v[208:211]
    v_mfma_f32_16x16x32_bf16 v[208:211], a[172:175], a[112:115], v[208:211]
    ds_read_b64_tr_b16 a[184:185], v16 offset:18656
    v_mfma_f32_16x16x32_bf16 v[212:215], a[168:171], a[100:103], v[212:215]
    v_mfma_f32_16x16x32_bf16 v[212:215], a[172:175], a[116:119], v[212:215]
    ds_read_b64_tr_b16 a[186:187], v16 offset:23264
    v_mfma_f32_16x16x32_bf16 v[216:219], a[168:171], a[104:107], v[216:219]
    v_mfma_f32_16x16x32_bf16 v[216:219], a[172:175], a[120:123], v[216:219]
    ds_read_b64_tr_b16 a[188:189], v16 offset:27872
    v_mfma_f32_16x16x32_bf16 v[220:223], a[168:171], a[108:111], v[220:223]
    v_mfma_f32_16x16x32_bf16 v[220:223], a[172:175], a[124:127], v[220:223]
    s_waitcnt lgkmcnt(3)
    ds_read_b64_tr_b16 a[190:191], v16 offset:32480
    v_mfma_f32_16x16x32_bf16 v[176:179], a[176:179], a[96:99], v[176:179]
    v_mfma_f32_16x16x32_bf16 v[176:179], a[180:183], a[112:115], v[176:179]
    ds_read_b64_tr_b16 a[192:193], v16 offset:256
    v_mfma_f32_16x16x32_bf16 v[180:183], a[176:179], a[100:103], v[180:183]
    v_mfma_f32_16x16x32_bf16 v[180:183], a[180:183], a[116:119], v[180:183]
    ds_read_b64_tr_b16 a[194:195], v16 offset:4864
    v_mfma_f32_16x16x32_bf16 v[184:187], a[176:179], a[104:107], v[184:187]
    v_mfma_f32_16x16x32_bf16 v[184:187], a[180:183], a[120:123], v[184:187]
    ds_read_b64_tr_b16 a[196:197], v16 offset:9472
    v_mfma_f32_16x16x32_bf16 v[188:191], a[176:179], a[108:111], v[188:191]
    v_mfma_f32_16x16x32_bf16 v[188:191], a[180:183], a[124:127], v[188:191]
    s_waitcnt lgkmcnt(3)
    ds_read_b64_tr_b16 a[198:199], v16 offset:14080
    v_mfma_f32_16x16x32_bf16 v[224:227], a[184:187], a[96:99], v[224:227]
    v_mfma_f32_16x16x32_bf16 v[224:227], a[188:191], a[112:115], v[224:227]
    ds_read_b64_tr_b16 a[200:201], v16 offset:18688
    v_mfma_f32_16x16x32_bf16 v[228:231], a[184:187], a[100:103], v[228:231]
    v_mfma_f32_16x16x32_bf16 v[228:231], a[188:191], a[116:119], v[228:231]
    ds_read_b64_tr_b16 a[202:203], v16 offset:23296
    v_mfma_f32_16x16x32_bf16 v[232:235], a[184:187], a[104:107], v[232:235]
    v_mfma_f32_16x16x32_bf16 v[232:235], a[188:191], a[120:123], v[232:235]
    ds_read_b64_tr_b16 a[204:205], v16 offset:27904
    v_mfma_f32_16x16x32_bf16 v[236:239], a[184:187], a[108:111], v[236:239]
    v_mfma_f32_16x16x32_bf16 v[236:239], a[188:191], a[124:127], v[236:239]
    s_waitcnt lgkmcnt(3)
    ds_read_b64_tr_b16 a[206:207], v16 offset:32512
    v_mfma_f32_16x16x32_bf16 v[192:195], a[192:195], a[96:99], v[192:195]
    v_mfma_f32_16x16x32_bf16 v[192:195], a[196:199], a[112:115], v[192:195]
    v_mfma_f32_16x16x32_bf16 v[196:199], a[192:195], a[100:103], v[196:199]
    v_mfma_f32_16x16x32_bf16 v[196:199], a[196:199], a[116:119], v[196:199]
    s_waitcnt lgkmcnt(0)
    s_waitcnt vmcnt(0)
    s_barrier
    v_mfma_f32_16x16x32_bf16 v[200:203], a[192:195], a[104:107], v[200:203]
    ds_read_b64_tr_b16 a[160:161], v17 offset:0
    v_mfma_f32_16x16x32_bf16 v[200:203], a[196:199], a[120:123], v[200:203]
    ds_read_b64_tr_b16 a[162:163], v17 offset:4608
    v_mfma_f32_16x16x32_bf16 v[204:207], a[192:195], a[108:111], v[204:207]
    ds_read_b64_tr_b16 a[164:165], v17 offset:9216
    v_mfma_f32_16x16x32_bf16 v[204:207], a[196:199], a[124:127], v[204:207]
    ds_read_b64_tr_b16 a[166:167], v17 offset:13824
    v_mfma_f32_16x16x32_bf16 v[240:243], a[200:203], a[96:99], v[240:243]
    ds_read_b64_tr_b16 a[168:169], v18 offset:0
    ds_read_b64_tr_b16 a[170:171], v18 offset:4608
    v_mfma_f32_16x16x32_bf16 v[240:243], a[204:207], a[112:115], v[240:243]
    ds_read_b128 a[96:99], v14 offset:0
    ds_read_b128 a[112:115], v15 offset:0
    v_mfma_f32_16x16x32_bf16 v[244:247], a[200:203], a[100:103], v[244:247]
    ds_read_b64_tr_b16 a[172:173], v18 offset:9216
    ds_read_b64_tr_b16 a[174:175], v18 offset:13824
    v_mfma_f32_16x16x32_bf16 v[244:247], a[204:207], a[116:119], v[244:247]
    ds_read_b128 a[100:103], v14 offset:2048
    ds_read_b128 a[116:119], v15 offset:2048
    v_mfma_f32_16x16x32_bf16 v[248:251], a[200:203], a[104:107], v[248:251]
    ds_read_b64_tr_b16 a[176:177], v17 offset:18432
    ds_read_b64_tr_b16 a[178:179], v17 offset:23040
    v_mfma_f32_16x16x32_bf16 v[248:251], a[204:207], a[120:123], v[248:251]
    ds_read_b128 a[104:107], v14 offset:4096
    ds_read_b128 a[120:123], v15 offset:4096
    v_mfma_f32_16x16x32_bf16 v[252:255], a[200:203], a[108:111], v[252:255]
    ds_read_b64_tr_b16 a[180:181], v17 offset:27648
    ds_read_b64_tr_b16 a[182:183], v17 offset:32256
    v_mfma_f32_16x16x32_bf16 v[252:255], a[204:207], a[124:127], v[252:255]
    ds_read_b128 a[108:111], v14 offset:6144
    ds_read_b128 a[124:127], v15 offset:6144
    s_waitcnt lgkmcnt(0)
    v_mfma_f32_16x16x32_bf16 v[64:67], a[160:163], a[128:131], v[64:67]
    ds_read_b64_tr_b16 a[184:185], v18 offset:18432
    s_sub_u32 s57, s54, 1
    s_and_b32 s57, s57, 3
    v_mfma_f32_16x16x32_bf16 v[64:67], a[164:167], a[144:147], v[64:67]
    ds_read_b64_tr_b16 a[186:187], v18 offset:23040
    s_lshl_b32 s57, s57, 12
    s_add_u32 s55, s52, s57
    v_mfma_f32_16x16x32_bf16 v[64:67], a[168:171], a[96:99], v[64:67]
    ds_read_b64_tr_b16 a[188:189], v18 offset:27648
    buffer_store_dwordx4 v[20:23], v1, s[20:23], s55 offen sc1
    s_add_u32 s55, s55, 16384
    v_mfma_f32_16x16x32_bf16 v[64:67], a[172:175], a[112:115], v[64:67]
    ds_read_b64_tr_b16 a[190:191], v18 offset:32256
    v_mfma_f32_16x16x32_bf16 v[68:71], a[160:163], a[132:135], v[68:71]
    ds_read_b64_tr_b16 a[192:193], v17 offset:32
    v_mfma_f32_16x16x32_bf16 v[68:71], a[164:167], a[148:151], v[68:71]
    ds_read_b64_tr_b16 a[194:195], v17 offset:4640
    v_mfma_f32_16x16x32_bf16 v[68:71], a[168:171], a[100:103], v[68:71]
    ds_read_b64_tr_b16 a[196:197], v17 offset:9248
    v_mfma_f32_16x16x32_bf16 v[68:71], a[172:175], a[116:119], v[68:71]
    ds_read_b64_tr_b16 a[198:199], v17 offset:13856
    v_mfma_f32_16x16x32_bf16 v[72:75], a[160:163], a[136:139], v[72:75]
    v_mfma_f32_16x16x32_bf16 v[72:75], a[164:167], a[152:155], v[72:75]
    ds_read_b64_tr_b16 a[200:201], v18 offset:32
    s_cmp_eq_u32 s24, s54
    s_cbranch_scc0 L_sk_11
    s_add_u32 s57, s57, s53
    buffer_store_dwordx4 v[20:23], v1, s[20:23], s57 offen sc1
L_sk_11:
    v_mfma_f32_16x16x32_bf16 v[72:75], a[168:171], a[104:107], v[72:75]
    v_mfma_f32_16x16x32_bf16 v[72:75], a[172:175], a[120:123], v[72:75]
    ds_read_b64_tr_b16 a[202:203], v18 offset:4640
    buffer_store_dwordx4 v[20:23], v1, s[20:23], s55 offen sc1
    v_mfma_f32_16x16x32_bf16 v[76:79], a[160:163], a[140:143], v[76:79]
    v_mfma_f32_16x16x32_bf16 v[76:79], a[164:167], a[156:159], v[76:79]
    ds_read_b64_tr_b16 a[204:205], v18 offset:9248
    v_mfma_f32_16x16x32_bf16 v[76:79], a[168:171], a[108:111], v[76:79]
    v_mfma_f32_16x16x32_bf16 v[76:79], a[172:175], a[124:127], v[76:79]
    s_waitcnt lgkmcnt(7)
    ds_read_b64_tr_b16 a[206:207], v18 offset:13856
    v_mfma_f32_16x16x32_bf16 a[0:3], a[176:179], a[128:131], a[0:3]
    v_mfma_f32_16x16x32_bf16 a[0:3], a[180:183], a[144:147], a[0:3]
    ds_read_b64_tr_b16 a[160:161], v17 offset:18464
    s_sub_u32 s57, s54, 2
    s_and_b32 s57, s57, 3
    v_mfma_f32_16x16x32_bf16 a[0:3], a[184:187], a[96:99], a[0:3]
    s_lshl_b32 s57, s57, 12
    s_add_u32 s55, s52, s57
    v_mfma_f32_16x16x32_bf16 a[0:3], a[188:191], a[112:115], a[0:3]
    ds_read_b64_tr_b16 a[162:163], v17 offset:23072
    buffer_store_dwordx4 v[20:23], v1, s[20:23], s55 offen sc1
    s_add_u32 s55, s55, 16384
    s_nop 0
    v_pk_mul_f32 v[64:65], v[64:65], s[32:33] op_sel_hi:[1,0]
    v_pk_mul_f32 v[66:67], v[66:67], s[32:33] op_sel_hi:[1,0]
    v_pk_mul_f32 v[68:69], v[68:69], s[32:33] op_sel_hi:[1,0]
    v_pk_mul_f32 v[70:71], v[70:71], s[32:33] op_sel_hi:[1,0]
    v_pk_mul_f32 v[72:73], v[72:73], s[32:33] op_sel_hi:[1,0]
    v_pk_mul_f32 v[74:75], v[74:75], s[32:33] op_sel_hi:[1,0]
    v_pk_mul_f32 v[76:77], v[76:77], s[32:33] op_sel_hi:[1,0]
    v_pk_mul_f32 v[78:79], v[78:79], s[32:33] op_sel_hi:[1,0]
    v_mfma_f32_16x16x32_bf16 a[4:7], a[176:179], a[132:135], a[4:7]
    v_exp_f32 v64, v64
    v_exp_f32 v65, v65
    v_mfma_f32_16x16x32_bf16 a[4:7], a[180:183], a[148:151], a[4:7]
    ds_read_b64_tr_b16 a[164:165], v17 offset:27680
    v_exp_f32 v66, v66
    v_mfma_f32_16x16x32_bf16 a[4:7], a[184:187], a[100:103], a[4:7]
    v_exp_f32 v67, v67
    v_exp_f32 v68, v68
    v_mfma_f32_16x16x32_bf16 a[4:7], a[188:191], a[116:119], a[4:7]
    ds_read_b64_tr_b16 a[166:167], v17 offset:32288
    v_exp_f32 v69, v69
    v_mfma_f32_16x16x32_bf16 a[8:11], a[176:179], a[136:139], a[8:11]
    v_exp_f32 v70, v70
    v_exp_f32 v71, v71
    v_mfma_f32_16x16x32_bf16 a[8:11], a[180:183], a[152:155], a[8:11]
    ds_read_b64_tr_b16 a[168:169], v18 offset:18464
    v_exp_f32 v72, v72
    v_mfma_f32_16x16x32_bf16 a[8:11], a[184:187], a[104:107], a[8:11]
    s_cmp_eq_u32 s24, s54
    s_cbranch_scc0 L_sk_12
    s_add_u32 s57, s57, s53
    buffer_store_dwordx4 v[20:23], v1, s[20:23], s57 offen sc1
L_sk_12:
    v_exp_f32 v73, v73
    v_mfma_f32_16x16x32_bf16 a[8:11], a[188:191], a[120:123], a[8:11]
    ds_read_b64_tr_b16 a[170:171], v18 offset:23072
    v_exp_f32 v74, v74
    v_mfma_f32_16x16x32_bf16 a[12:15], a[176:179], a[140:143], a[12:15]
    buffer_store_dwordx4 v[20:23], v1, s[20:23], s55 offen sc1
    v_exp_f32 v75, v75
    v_mfma_f32_16x16x32_bf16 a[12:15], a[180:183], a[156:159], a[12:15]
    ds_read_b64_tr_b16 a[172:173], v18 offset:27680
    v_exp_f32 v76, v76
    v_mfma_f32_16x16x32_bf16 a[12:15], a[184:187], a[108:111], a[12:15]
    v_exp_f32 v77, v77
    v_exp_f32 v78, v78
    v_mfma_f32_16x16x32_bf16 a[12:15], a[188:191], a[124:127], a[12:15]
    s_waitcnt lgkmcnt(7)
    ds_read_b64_tr_b16 a[174:175], v18 offset:32288
    v_exp_f32 v79, v79
    s_nop 0
    v_pk_add_f32 v[64:65], v[64:65], 1.0 op_sel_hi:[1,0]
    v_pk_add_f32 v[66:67], v[66:67], 1.0 op_sel_hi:[1,0]
    v_pk_add_f32 v[68:69], v[68:69], 1.0 op_sel_hi:[1,0]
    v_pk_add_f32 v[70:71], v[70:71], 1.0 op_sel_hi:[1,0]
    v_pk_add_f32 v[72:73], v[72:73], 1.0 op_sel_hi:[1,0]
    v_pk_add_f32 v[74:75], v[74:75], 1.0 op_sel_hi:[1,0]
    v_pk_add_f32 v[76:77], v[76:77], 1.0 op_sel_hi:[1,0]
    v_pk_add_f32 v[78:79], v[78:79], 1.0 op_sel_hi:[1,0]
    v_mfma_f32_16x16x32_bf16 v[80:83], a[192:195], a[128:131], v[80:83]
    v_rcp_f32 v64, v64
    v_rcp_f32 v65, v65
    v_mfma_f32_16x16x32_bf16 v[80:83], a[196:199], a[144:147], v[80:83]
    ds_read_b64_tr_b16 a[176:177], v17 offset:64
    v_rcp_f32 v66, v66
    v_mfma_f32_16x16x32_bf16 v[80:83], a[200:203], a[96:99], v[80:83]
    s_sub_u32 s57, s54, 3
    s_and_b32 s57, s57, 3
    v_rcp_f32 v67, v67
    v_mfma_f32_16x16x32_bf16 v[80:83], a[204:207], a[112:115], v[80:83]
    ds_read_b64_tr_b16 a[178:179], v17 offset:4672
    s_lshl_b32 s57, s57, 12
    s_add_u32 s55, s52, s57
    v_mfma_f32_16x16x32_bf16 v[84:87], a[192:195], a[132:135], v[84:87]
    buffer_store_dwordx4 v[20:23], v1, s[20:23], s55 offen sc1
    s_add_u32 s55, s55, 16384
    v_rcp_f32 v68, v68
    v_mfma_f32_16x16x32_bf16 v[84:87], a[196:199], a[148:151], v[84:87]
    ds_read_b64_tr_b16 a[180:181], v17 offset:9280
    v_rcp_f32 v69, v69
    v_mfma_f32_16x16x32_bf16 v[84:87], a[200:203], a[100:103], v[84:87]
    v_rcp_f32 v70, v70
    v_rcp_f32 v71, v71
    v_mfma_f32_16x16x32_bf16 v[84:87], a[204:207], a[116:119], v[84:87]
    ds_read_b64_tr_b16 a[182:183], v17 offset:13888
    v_rcp_f32 v72, v72
    v_mfma_f32_16x16x32_bf16 v[88:91], a[192:195], a[136:139], v[88:91]
    v_rcp_f32 v73, v73
    v_rcp_f32 v74, v74
    v_mfma_f32_16x16x32_bf16 v[88:91], a[196:199], a[152:155], v[88:91]
    ds_read_b64_tr_b16 a[184:185], v18 offset:64
    v_rcp_f32 v75, v75
    v_mfma_f32_16x16x32_bf16 v[88:91], a[200:203], a[104:107], v[88:91]
    v_rcp_f32 v76, v76
    v_rcp_f32 v77, v77
    v_mfma_f32_16x16x32_bf16 v[88:91], a[204:207], a[120:123], v[88:91]
    ds_read_b64_tr_b16 a[186:187], v18 offset:4672
    s_cmp_eq_u32 s24, s54
    s_cbranch_scc0 L_sk_13
    s_add_u32 s57, s57, s53
    buffer_store_dwordx4 v[20:23], v1, s[20:23], s57 offen sc1
L_sk_13:
    v_mfma_f32_16x16x32_bf16 v[92:95], a[192:195], a[140:143], v[92:95]
    v_rcp_f32 v78, v78
    v_rcp_f32 v79, v79
    v_mfma_f32_16x16x32_bf16 v[92:95], a[196:199], a[156:159], v[92:95]
    ds_read_b64_tr_b16 a[188:189], v18 offset:9280
    buffer_store_dwordx4 v[20:23], v1, s[20:23], s55 offen sc1
    v_mfma_f32_16x16x32_bf16 v[92:95], a[200:203], a[108:111], v[92:95]
    v_mfma_f32_16x16x32_bf16 v[92:95], a[204:207], a[124:127], v[92:95]
    s_waitcnt lgkmcnt(7)
    ds_read_b64_tr_b16 a[190:191], v18 offset:13888
    v_mfma_f32_16x16x32_bf16 a[16:19], a[160:163], a[128:131], a[16:19]
    v_accvgpr_read_b32 v4, a0
    v_accvgpr_read_b32 v5, a1
    v_accvgpr_read_b32 v6, a2
    v_accvgpr_read_b32 v7, a3
    v_mfma_f32_16x16x32_bf16 a[16:19], a[164:167], a[144:147], a[16:19]
    ds_read_b64_tr_b16 a[192:193], v17 offset:18496
    v_accvgpr_read_b32 v8, a4
    v_accvgpr_read_b32 v9, a5
    v_accvgpr_read_b32 v10, a6
    v_mfma_f32_16x16x32_bf16 a[16:19], a[168:171], a[96:99], a[16:19]
    v_accvgpr_read_b32 v11, a7
    v_accvgpr_read_b32 v12, a8
    v_accvgpr_read_b32 v13, a9
    v_accvgpr_read_b32 v14, a10
    v_mfma_f32_16x16x32_bf16 a[16:19], a[172:175], a[112:115], a[16:19]
    ds_read_b64_tr_b16 a[194:195], v17 offset:23104
    s_add_u32 m0, s56, 0
    v_accvgpr_read_b32 v15, a11
    v_accvgpr_read_b32 v40, a12
    v_mfma_f32_16x16x32_bf16 a[20:23], a[160:163], a[132:135], a[20:23]
    buffer_load_dwordx4 v55, s[12:15], s49 offen lds
    s_add_u32 s49, s49, 16*1152
    v_accvgpr_read_b32 v41, a13
    v_accvgpr_read_b32 v42, a14
    v_mfma_f32_16x16x32_bf16 a[20:23], a[164:167], a[148:151], a[20:23]
    ds_read_b64_tr_b16 a[196:197], v17 offset:27712
    v_accvgpr_read_b32 v43, a15
    s_nop 0
    v_pk_mul_f32 v[64:65], v[64:65], v[4:5]
    v_pk_mul_f32 v[66:67], v[66:67], v[6:7]
    v_pk_mul_f32 v[68:69], v[68:69], v[8:9]
    v_pk_mul_f32 v[70:71], v[70:71], v[10:11]
    v_pk_mul_f32 v[72:73], v[72:73], v[12:13]
    v_pk_mul_f32 v[74:75], v[74:75], v[14:15]
    v_pk_mul_f32 v[76:77], v[76:77], v[40:41]
    v_pk_mul_f32 v[78:79], v[78:79], v[42:43]
    v_pk_mul_f32 v[80:81], v[80:81], s[32:33] op_sel_hi:[1,0]
    v_pk_mul_f32 v[82:83], v[82:83], s[32:33] op_sel_hi:[1,0]
    v_pk_mul_f32 v[84:85], v[84:85], s[32:33] op_sel_hi:[1,0]
    v_pk_mul_f32 v[86:87], v[86:87], s[32:33] op_sel_hi:[1,0]
    v_pk_mul_f32 v[88:89], v[88:89], s[32:33] op_sel_hi:[1,0]
    v_pk_mul_f32 v[90:91], v[90:91], s[32:33] op_sel_hi:[1,0]
    v_pk_mul_f32 v[92:93], v[92:93], s[32:33] op_sel_hi:[1,0]
    v_pk_mul_f32 v[94:95], v[94:95], s[32:33] op_sel_hi:[1,0]
    v_mfma_f32_16x16x32_bf16 a[20:23], a[168:171], a[100:103], a[20:23]
    v_cvt_pk_bf16_f32 v64, v64, v65
    v_cvt_pk_bf16_f32 v65, v66, v67
    v_cvt_pk_bf16_f32 v66, v68, v69
    v_cvt_pk_bf16_f32 v67, v70, v71
    v_mfma_f32_16x16x32_bf16 a[20:23], a[172:175], a[116:119], a[20:23]
    ds_read_b64_tr_b16 a[198:199], v17 offset:32320
    v_cvt_pk_bf16_f32 v72, v72, v73
    v_cvt_pk_bf16_f32 v73, v74, v75
    v_cvt_pk_bf16_f32 v74, v76, v77
    v_mfma_f32_16x16x32_bf16 a[24:27], a[160:163], a[136:139], a[24:27]
    v_cvt_pk_bf16_f32 v75, v78, v79
    v_permlane16_swap_b32 v64, v66
    v_mfma_f32_16x16x32_bf16 a[24:27], a[164:167], a[152:155], a[24:27]
    ds_read_b64_tr_b16 a[200:201], v18 offset:18496
    s_add_u32 m0, s56, 1024
    v_permlane16_swap_b32 v65, v67
    v_mfma_f32_16x16x32_bf16 a[24:27], a[168:171], a[104:107], a[24:27]
    buffer_load_dwordx4 v55, s[12:15], s49 offen lds
    s_add_u32 s49, s49, 16*1152
    v_permlane16_swap_b32 v72, v74
    v_mfma_f32_16x16x32_bf16 a[24:27], a[172:175], a[120:123], a[24:27]
    ds_read_b64_tr_b16 a[202:203], v18 offset:23104
    v_permlane16_swap_b32 v73, v75
    v_mfma_f32_16x16x32_bf16 a[28:31], a[160:163], a[140:143], a[28:31]
    v_exp_f32 v80, v80
    v_exp_f32 v81, v81
    v_mfma_f32_16x16x32_bf16 a[28:31], a[164:167], a[156:159], a[28:31]
    ds_read_b64_tr_b16 a[204:205], v18 offset:27712
    v_exp_f32 v82, v82
    v_mfma_f32_16x16x32_bf16 a[28:31], a[168:171], a[108:111], a[28:31]
    v_exp_f32 v83, v83
    v_mfma_f32_16x16x32_bf16 a[28:31], a[172:175], a[124:127], a[28:31]
    s_waitcnt lgkmcnt(7)
    ds_read_b64_tr_b16 a[206:207], v18 offset:32320
    s_cmp_lg_u32 s24, 3
    s_cbranch_scc1 L_not3
    s_mov_b32 m0, 161280
    s_nop 0
    buffer_load_dwordx4 v56, s[12:15], s50 offen lds
L_not3:
    v_mfma_f32_16x16x32_bf16 v[96:99], a[176:179], a[128:131], v[96:99]
    buffer_store_dwordx4 v[64:67], v19, s[20:23], s37 offen offset:0 sc1
    v_exp_f32 v84, v84
    v_mfma_f32_16x16x32_bf16 v[96:99], a[180:183], a[144:147], v[96:99]
    ds_read_b64_tr_b16 a[160:161], v17 offset:96
    v_exp_f32 v85, v85
    v_mfma_f32_16x16x32_bf16 v[96:99], a[184:187], a[96:99], v[96:99]
    v_exp_f32 v86, v86
    v_exp_f32 v87, v87
    v_mfma_f32_16x16x32_bf16 v[96:99], a[188:191], a[112:115], v[96:99]
    ds_read_b64_tr_b16 a[162:163], v17 offset:4704
    v_exp_f32 v88, v88
    v_mfma_f32_16x16x32_bf16 v[100:103], a[176:179], a[132:135], v[100:103]
    v_exp_f32 v89, v89
    v_mfma_f32_16x16x32_bf16 v[100:103], a[180:183], a[148:151], v[100:103]
    ds_read_b64_tr_b16 a[164:165], v17 offset:9312
    buffer_store_dwordx4 v[72:75], v19, s[20:23], s39 offen offset:0 sc1
    v_mfma_f32_16x16x32_bf16 v[100:103], a[184:187], a[100:103], v[100:103]
    v_exp_f32 v90, v90
    v_exp_f32 v91, v91
    v_mfma_f32_16x16x32_bf16 v[100:103], a[188:191], a[116:119], v[100:103]
    ds_read_b64_tr_b16 a[166:167], v17 offset:13920
    v_exp_f32 v92, v92
    v_mfma_f32_16x16x32_bf16 v[104:107], a[176:179], a[136:139], v[104:107]
    v_exp_f32 v93, v93
    v_exp_f32 v94, v94
    v_mfma_f32_16x16x32_bf16 v[104:107], a[180:183], a[152:155], v[104:107]
    ds_read_b64_tr_b16 a[168:169], v18 offset:96
    v_exp_f32 v95, v95
    s_nop 0
    v_pk_add_f32 v[80:81], v[80:81], 1.0 op_sel_hi:[1,0]
    v_pk_add_f32 v[82:83], v[82:83], 1.0 op_sel_hi:[1,0]
    v_pk_add_f32 v[84:85], v[84:85], 1.0 op_sel_hi:[1,0]
    v_pk_add_f32 v[86:87], v[86:87], 1.0 op_sel_hi:[1,0]
    v_pk_add_f32 v[88:89], v[88:89], 1.0 op_sel_hi:[1,0]
    v_pk_add_f32 v[90:91], v[90:91], 1.0 op_sel_hi:[1,0]
    v_pk_add_f32 v[92:93], v[92:93], 1.0 op_sel_hi:[1,0]
    v_pk_add_f32 v[94:95], v[94:95], 1.0 op_sel_hi:[1,0]
    v_mfma_f32_16x16x32_bf16 v[104:107], a[184:187], a[104:107], v[104:107]
    v_rcp_f32 v80, v80
    v_rcp_f32 v81, v81
    v_mfma_f32_16x16x32_bf16 v[104:107], a[188:191], a[120:123], v[104:107]
    ds_read_b64_tr_b16 a[170:171], v18 offset:4704
    v_rcp_f32 v82, v82
    v_mfma_f32_16x16x32_bf16 v[108:111], a[176:179], a[140:143], v[108:111]
    v_rcp_f32 v83, v83
    v_rcp_f32 v84, v84
    v_mfma_f32_16x16x32_bf16 v[108:111], a[180:183], a[156:159], v[108:111]
    ds_read_b64_tr_b16 a[172:173], v18 offset:9312
    v_rcp_f32 v85, v85
    v_mfma_f32_16x16x32_bf16 v[108:111], a[184:187], a[108:111], v[108:111]
    v_rcp_f32 v86, v86
    v_rcp_f32 v87, v87
    v_mfma_f32_16x16x32_bf16 v[108:111], a[188:191], a[124:127], v[108:111]
    s_waitcnt lgkmcnt(7)
    ds_read_b64_tr_b16 a[174:175], v18 offset:13920
    v_rcp_f32 v88, v88
    v_mfma_f32_16x16x32_bf16 a[32:35], a[192:195], a[128:131], a[32:35]
    v_rcp_f32 v89, v89
    v_rcp_f32 v90, v90
    v_mfma_f32_16x16x32_bf16 a[32:35], a[196:199], a[144:147], a[32:35]
    ds_read_b64_tr_b16 a[176:177], v17 offset:18528
    v_rcp_f32 v91, v91
    v_mfma_f32_16x16x32_bf16 a[32:35], a[200:203], a[96:99], a[32:35]
    v_rcp_f32 v92, v92
    v_rcp_f32 v93, v93
    v_mfma_f32_16x16x32_bf16 a[32:35], a[204:207], a[112:115], a[32:35]
    ds_read_b64_tr_b16 a[178:179], v17 offset:23136
    v_rcp_f32 v94, v94
    v_mfma_f32_16x16x32_bf16 a[36:39], a[192:195], a[132:135], a[36:39]
    v_rcp_f32 v95, v95
    v_accvgpr_read_b32 v4, a16
    v_accvgpr_read_b32 v5, a17
    v_mfma_f32_16x16x32_bf16 a[36:39], a[196:199], a[148:151], a[36:39]
    ds_read_b64_tr_b16 a[180:181], v17 offset:27744
    v_accvgpr_read_b32 v6, a18
    v_accvgpr_read_b32 v7, a19
    v_accvgpr_read_b32 v8, a20
    v_mfma_f32_16x16x32_bf16 a[36:39], a[200:203], a[100:103], a[36:39]
    v_accvgpr_read_b32 v9, a21
    v_accvgpr_read_b32 v10, a22
    v_accvgpr_read_b32 v11, a23
    v_accvgpr_read_b32 v12, a24
    v_mfma_f32_16x16x32_bf16 a[36:39], a[204:207], a[116:119], a[36:39]
    ds_read_b64_tr_b16 a[182:183], v17 offset:32352
    v_accvgpr_read_b32 v13, a25
    v_accvgpr_read_b32 v14, a26
    v_accvgpr_read_b32 v15, a27
    v_mfma_f32_16x16x32_bf16 a[40:43], a[192:195], a[136:139], a[40:43]
    v_accvgpr_read_b32 v40, a28
    v_accvgpr_read_b32 v41, a29
    v_accvgpr_read_b32 v42, a30
    v_accvgpr_read_b32 v43, a31
    s_nop 0
    v_pk_mul_f32 v[80:81], v[80:81], v[4:5]
    v_pk_mul_f32 v[82:83], v[82:83], v[6:7]
    v_pk_mul_f32 v[84:85], v[84:85], v[8:9]
    v_pk_mul_f32 v[86:87], v[86:87], v[10:11]
    v_pk_mul_f32 v[88:89], v[88:89], v[12:13]
    v_pk_mul_f32 v[90:91], v[90:91], v[14:15]
    v_pk_mul_f32 v[92:93], v[92:93], v[40:41]
    v_pk_mul_f32 v[94:95], v[94:95], v[42:43]
    v_pk_mul_f32 v[96:97], v[96:97], s[32:33] op_sel_hi:[1,0]
    v_pk_mul_f32 v[98:99], v[98:99], s[32:33] op_sel_hi:[1,0]
    v_pk_mul_f32 v[100:101], v[100:101], s[32:33] op_sel_hi:[1,0]
    v_pk_mul_f32 v[102:103], v[102:103], s[32:33] op_sel_hi:[1,0]
    v_pk_mul_f32 v[104:105], v[104:105], s[32:33] op_sel_hi:[1,0]
    v_pk_mul_f32 v[106:107], v[106:107], s[32:33] op_sel_hi:[1,0]
    v_pk_mul_f32 v[108:109], v[108:109], s[32:33] op_sel_hi:[1,0]
    v_pk_mul_f32 v[110:111], v[110:111], s[32:33] op_sel_hi:[1,0]
    v_mfma_f32_16x16x32_bf16 a[40:43], a[196:199], a[152:155], a[40:43]
    ds_read_b64_tr_b16 a[184:185], v18 offset:18528
    v_cvt_pk_bf16_f32 v80, v80, v81
    v_cvt_pk_bf16_f32 v81, v82, v83
    v_cvt_pk_bf16_f32 v82, v84, v85
    v_mfma_f32_16x16x32_bf16 a[40:43], a[200:203], a[104:107], a[40:43]
    v_cvt_pk_bf16_f32 v83, v86, v87
    v_cvt_pk_bf16_f32 v88, v88, v89
    v_cvt_pk_bf16_f32 v89, v90, v91
    v_cvt_pk_bf16_f32 v90, v92, v93
    v_mfma_f32_16x16x32_bf16 a[40:43], a[204:207], a[120:123], a[40:43]
    ds_read_b64_tr_b16 a[186:187], v18 offset:23136
    v_cvt_pk_bf16_f32 v91, v94, v95
    v_permlane16_swap_b32 v80, v82
    v_mfma_f32_16x16x32_bf16 a[44:47], a[192:195], a[140:143], a[44:47]
    v_permlane16_swap_b32 v81, v83
    v_permlane16_swap_b32 v88, v90
    v_mfma_f32_16x16x32_bf16 a[44:47], a[196:199], a[156:159], a[44:47]
    ds_read_b64_tr_b16 a[188:189], v18 offset:27744
    v_permlane16_swap_b32 v89, v91
    v_mfma_f32_16x16x32_bf16 a[44:47], a[200:203], a[108:111], a[44:47]
    v_exp_f32 v96, v96
    v_exp_f32 v97, v97
    v_mfma_f32_16x16x32_bf16 a[44:47], a[204:207], a[124:127], a[44:47]
    s_waitcnt lgkmcnt(7)
    ds_read_b64_tr_b16 a[190:191], v18 offset:32352
    v_exp_f32 v98, v98
    v_mfma_f32_16x16x32_bf16 v[112:115], a[160:163], a[128:131], v[112:115]
    v_exp_f32 v99, v99
    v_mfma_f32_16x16x32_bf16 v[112:115], a[164:167], a[144:147], v[112:115]
    ds_read_b64_tr_b16 a[192:193], v17 offset:128
    buffer_store_dwordx4 v[80:83], v19, s[20:23], s37 offen offset:512 sc1
    v_mfma_f32_16x16x32_bf16 v[112:115], a[168:171], a[96:99], v[112:115]
    v_exp_f32 v100, v100
    v_exp_f32 v101, v101
    v_mfma_f32_16x16x32_bf16 v[112:115], a[172:175], a[112:115], v[112:115]
    ds_read_b64_tr_b16 a[194:195], v17 offset:4736
    v_exp_f32 v102, v102
    v_mfma_f32_16x16x32_bf16 v[116:119], a[160:163], a[132:135], v[116:119]
    v_exp_f32 v103, v103
    v_exp_f32 v104, v104
    v_mfma_f32_16x16x32_bf16 v[116:119], a[164:167], a[148:151], v[116:119]
    ds_read_b64_tr_b16 a[196:197], v17 offset:9344
    v_exp_f32 v105, v105
    v_mfma_f32_16x16x32_bf16 v[116:119], a[168:171], a[100:103], v[116:119]
    buffer_store_dwordx4 v[88:91], v19, s[20:23], s39 offen offset:512 sc1
    v_exp_f32 v106, v106
    v_mfma_f32_16x16x32_bf16 v[116:119], a[172:175], a[116:119], v[116:119]
    ds_read_b64_tr_b16 a[198:199], v17 offset:13952
    v_exp_f32 v107, v107
    v_mfma_f32_16x16x32_bf16 v[120:123], a[160:163], a[136:139], v[120:123]
    v_exp_f32 v108, v108
    v_exp_f32 v109, v109
    v_mfma_f32_16x16x32_bf16 v[120:123], a[164:167], a[152:155], v[120:123]
    ds_read_b64_tr_b16 a[200:201], v18 offset:128
    v_exp_f32 v110, v110
    v_mfma_f32_16x16x32_bf16 v[120:123], a[168:171], a[104:107], v[120:123]
    v_exp_f32 v111, v111
    s_nop 0
    v_pk_add_f32 v[96:97], v[96:97], 1.0 op_sel_hi:[1,0]
    v_pk_add_f32 v[98:99], v[98:99], 1.0 op_sel_hi:[1,0]
    v_pk_add_f32 v[100:101], v[100:101], 1.0 op_sel_hi:[1,0]
    v_pk_add_f32 v[102:103], v[102:103], 1.0 op_sel_hi:[1,0]
    v_pk_add_f32 v[104:105], v[104:105], 1.0 op_sel_hi:[1,0]
    v_pk_add_f32 v[106:107], v[106:107], 1.0 op_sel_hi:[1,0]
    v_pk_add_f32 v[108:109], v[108:109], 1.0 op_sel_hi:[1,0]
    v_pk_add_f32 v[110:111], v[110:111], 1.0 op_sel_hi:[1,0]
    v_mfma_f32_16x16x32_bf16 v[120:123], a[172:175], a[120:123], v[120:123]
    ds_read_b64_tr_b16 a[202:203], v18 offset:4736
    v_rcp_f32 v96, v96
    v_mfma_f32_16x16x32_bf16 v[124:127], a[160:163], a[140:143], v[124:127]
    v_rcp_f32 v97, v97
    v_rcp_f32 v98, v98
    v_mfma_f32_16x16x32_bf16 v[124:127], a[164:167], a[156:159], v[124:127]
    ds_read_b64_tr_b16 a[204:205], v18 offset:9344
    v_rcp_f32 v99, v99
    v_mfma_f32_16x16x32_bf16 v[124:127], a[168:171], a[108:111], v[124:127]
    v_rcp_f32 v100, v100
    v_rcp_f32 v101, v101
    v_mfma_f32_16x16x32_bf16 v[124:127], a[172:175], a[124:127], v[124:127]
    s_waitcnt lgkmcnt(7)
    ds_read_b64_tr_b16 a[206:207], v18 offset:13952
    v_rcp_f32 v102, v102
    v_mfma_f32_16x16x32_bf16 a[48:51], a[176:179], a[128:131], a[48:51]
    v_rcp_f32 v103, v103
    v_rcp_f32 v104, v104
    v_mfma_f32_16x16x32_bf16 a[48:51], a[180:183], a[144:147], a[48:51]
    ds_read_b64_tr_b16 a[160:161], v17 offset:18560
    v_rcp_f32 v105, v105
    v_mfma_f32_16x16x32_bf16 a[48:51], a[184:187], a[96:99], a[48:51]
    v_rcp_f32 v106, v106
    v_rcp_f32 v107, v107
    v_mfma_f32_16x16x32_bf16 a[48:51], a[188:191], a[112:115], a[48:51]
    ds_read_b64_tr_b16 a[162:163], v17 offset:23168
    v_rcp_f32 v108, v108
    v_mfma_f32_16x16x32_bf16 a[52:55], a[176:179], a[132:135], a[52:55]
    v_rcp_f32 v109, v109
    v_rcp_f32 v110, v110
    v_mfma_f32_16x16x32_bf16 a[52:55], a[180:183], a[148:151], a[52:55]
    ds_read_b64_tr_b16 a[164:165], v17 offset:27776
    v_rcp_f32 v111, v111
    v_accvgpr_read_b32 v4, a32
    v_mfma_f32_16x16x32_bf16 a[52:55], a[184:187], a[100:103], a[52:55]
    v_accvgpr_read_b32 v5, a33
    v_accvgpr_read_b32 v6, a34
    v_accvgpr_read_b32 v7, a35
    v_accvgpr_read_b32 v8, a36
    v_mfma_f32_16x16x32_bf16 a[52:55], a[188:191], a[116:119], a[52:55]
    ds_read_b64_tr_b16 a[166:167], v17 offset:32384
    v_accvgpr_read_b32 v9, a37
    v_accvgpr_read_b32 v10, a38
    v_accvgpr_read_b32 v11, a39
    v_mfma_f32_16x16x32_bf16 a[56:59], a[176:179], a[136:139], a[56:59]
    v_accvgpr_read_b32 v12, a40
    v_accvgpr_read_b32 v13, a41
    v_accvgpr_read_b32 v14, a42
    v_accvgpr_read_b32 v15, a43
    v_mfma_f32_16x16x32_bf16 a[56:59], a[180:183], a[152:155], a[56:59]
    ds_read_b64_tr_b16 a[168:169], v18 offset:18560
    v_accvgpr_read_b32 v40, a44
    v_accvgpr_read_b32 v41, a45
    v_accvgpr_read_b32 v42, a46
    v_mfma_f32_16x16x32_bf16 a[56:59], a[184:187], a[104:107], a[56:59]
    v_accvgpr_read_b32 v43, a47
    s_nop 0
    v_pk_mul_f32 v[96:97], v[96:97], v[4:5]
    v_pk_mul_f32 v[98:99], v[98:99], v[6:7]
    v_pk_mul_f32 v[100:101], v[100:101], v[8:9]
    v_pk_mul_f32 v[102:103], v[102:103], v[10:11]
    v_pk_mul_f32 v[104:105], v[104:105], v[12:13]
    v_pk_mul_f32 v[106:107], v[106:107], v[14:15]
    v_pk_mul_f32 v[108:109], v[108:109], v[40:41]
    v_pk_mul_f32 v[110:111], v[110:111], v[42:43]
    v_pk_mul_f32 v[112:113], v[112:113], s[32:33] op_sel_hi:[1,0]
    v_pk_mul_f32 v[114:115], v[114:115], s[32:33] op_sel_hi:[1,0]
    v_pk_mul_f32 v[116:117], v[116:117], s[32:33] op_sel_hi:[1,0]
    v_pk_mul_f32 v[118:119], v[118:119], s[32:33] op_sel_hi:[1,0]
    v_pk_mul_f32 v[120:121], v[120:121], s[32:33] op_sel_hi:[1,0]
    v_pk_mul_f32 v[122:123], v[122:123], s[32:33] op_sel_hi:[1,0]
    v_pk_mul_f32 v[124:125], v[124:125], s[32:33] op_sel_hi:[1,0]
    v_pk_mul_f32 v[126:127], v[126:127], s[32:33] op_sel_hi:[1,0]
    v_mfma_f32_16x16x32_bf16 a[56:59], a[188:191], a[120:123], a[56:59]
    ds_read_b64_tr_b16 a[170:171], v18 offset:23168
    v_cvt_pk_bf16_f32 v96, v96, v97
    v_cvt_pk_bf16_f32 v97, v98, v99
    v_cvt_pk_bf16_f32 v98, v100, v101
    v_mfma_f32_16x16x32_bf16 a[60:63], a[176:179], a[140:143], a[60:63]
    v_cvt_pk_bf16_f32 v99, v102, v103
    v_cvt_pk_bf16_f32 v104, v104, v105
    v_cvt_pk_bf16_f32 v105, v106, v107
    v_cvt_pk_bf16_f32 v106, v108, v109
    v_mfma_f32_16x16x32_bf16 a[60:63], a[180:183], a[156:159], a[60:63]
    ds_read_b64_tr_b16 a[172:173], v18 offset:27776
    v_cvt_pk_bf16_f32 v107, v110, v111
    v_permlane16_swap_b32 v96, v98
    v_mfma_f32_16x16x32_bf16 a[60:63], a[184:187], a[108:111], a[60:63]
    v_permlane16_swap_b32 v97, v99
    v_permlane16_swap_b32 v104, v106
    v_mfma_f32_16x16x32_bf16 a[60:63], a[188:191], a[124:127], a[60:63]
    s_waitcnt lgkmcnt(7)
    ds_read_b64_tr_b16 a[174:175], v18 offset:32384
    v_permlane16_swap_b32 v105, v107
    v_mfma_f32_16x16x32_bf16 v[128:131], a[192:195], a[128:131], v[128:131]
    buffer_load_dwordx4 v[36:39], v50, s[20:23], s42 offen offset:0 sc1
    v_exp_f32 v112, v112
    v_mfma_f32_16x16x32_bf16 v[128:131], a[196:199], a[144:147], v[128:131]
    ds_read_b64_tr_b16 a[176:177], v17 offset:160
    v_exp_f32 v113, v113
    v_mfma_f32_16x16x32_bf16 v[128:131], a[200:203], a[96:99], v[128:131]
    v_exp_f32 v114, v114
    v_exp_f32 v115, v115
    v_mfma_f32_16x16x32_bf16 v[128:131], a[204:207], a[112:115], v[128:131]
    ds_read_b64_tr_b16 a[178:179], v17 offset:4768
    buffer_store_dwordx4 v[96:99], v19, s[20:23], s37 offen offset:1024 sc1
    v_mfma_f32_16x16x32_bf16 v[132:135], a[192:195], a[132:135], v[132:135]
    v_exp_f32 v116, v116
    v_exp_f32 v117, v117
    v_mfma_f32_16x16x32_bf16 v[132:135], a[196:199], a[148:151], v[132:135]
    ds_read_b64_tr_b16 a[180:181], v17 offset:9376
    v_exp_f32 v118, v118
    v_mfma_f32_16x16x32_bf16 v[132:135], a[200:203], a[100:103], v[132:135]
    v_exp_f32 v119, v119
    v_exp_f32 v120, v120
    v_mfma_f32_16x16x32_bf16 v[132:135], a[204:207], a[116:119], v[132:135]
    ds_read_b64_tr_b16 a[182:183], v17 offset:13984
    v_exp_f32 v121, v121
    v_mfma_f32_16x16x32_bf16 v[136:139], a[192:195], a[136:139], v[136:139]
    buffer_store_dwordx4 v[104:107], v19, s[20:23], s39 offen offset:1024 sc1
    v_exp_f32 v122, v122
    v_mfma_f32_16x16x32_bf16 v[136:139], a[196:199], a[152:155], v[136:139]
    ds_read_b64_tr_b16 a[184:185], v18 offset:160
    v_exp_f32 v123, v123
    v_mfma_f32_16x16x32_bf16 v[136:139], a[200:203], a[104:107], v[136:139]
    v_exp_f32 v124, v124
    v_exp_f32 v125, v125
    v_mfma_f32_16x16x32_bf16 v[136:139], a[204:207], a[120:123], v[136:139]
    ds_read_b64_tr_b16 a[186:187], v18 offset:4768
    v_exp_f32 v126, v126
    v_mfma_f32_16x16x32_bf16 v[140:143], a[192:195], a[140:143], v[140:143]
    v_exp_f32 v127, v127
    s_nop 0
    v_pk_add_f32 v[112:113], v[112:113], 1.0 op_sel_hi:[1,0]
    v_pk_add_f32 v[114:115], v[114:115], 1.0 op_sel_hi:[1,0]
    v_pk_add_f32 v[116:117], v[116:117], 1.0 op_sel_hi:[1,0]
    v_pk_add_f32 v[118:119], v[118:119], 1.0 op_sel_hi:[1,0]
    v_pk_add_f32 v[120:121], v[120:121], 1.0 op_sel_hi:[1,0]
    v_pk_add_f32 v[122:123], v[122:123], 1.0 op_sel_hi:[1,0]
    v_pk_add_f32 v[124:125], v[124:125], 1.0 op_sel_hi:[1,0]
    v_pk_add_f32 v[126:127], v[126:127], 1.0 op_sel_hi:[1,0]
    v_mfma_f32_16x16x32_bf16 v[140:143], a[196:199], a[156:159], v[140:143]
    ds_read_b64_tr_b16 a[188:189], v18 offset:9376
    v_rcp_f32 v112, v112
    v_mfma_f32_16x16x32_bf16 v[140:143], a[200:203], a[108:111], v[140:143]
    v_rcp_f32 v113, v113
    v_rcp_f32 v114, v114
    v_mfma_f32_16x16x32_bf16 v[140:143], a[204:207], a[124:127], v[140:143]
    s_waitcnt lgkmcnt(7)
    ds_read_b64_tr_b16 a[190:191], v18 offset:13984
    v_rcp_f32 v115, v115
    v_mfma_f32_16x16x32_bf16 a[64:67], a[160:163], a[128:131], a[64:67]
    v_rcp_f32 v116, v116
    v_rcp_f32 v117, v117
    v_mfma_f32_16x16x32_bf16 a[64:67], a[164:167], a[144:147], a[64:67]
    ds_read_b64_tr_b16 a[192:193], v17 offset:18592
    v_rcp_f32 v118, v118
    v_mfma_f32_16x16x32_bf16 a[64:67], a[168:171], a[96:99], a[64:67]
    v_rcp_f32 v119, v119
    v_rcp_f32 v120, v120
    v_mfma_f32_16x16x32_bf16 a[64:67], a[172:175], a[112:115], a[64:67]
    ds_read_b64_tr_b16 a[194:195], v17 offset:23200
    v_rcp_f32 v121, v121
    v_mfma_f32_16x16x32_bf16 a[68:71], a[160:163], a[132:135], a[68:71]
    v_rcp_f32 v122, v122
    v_rcp_f32 v123, v123
    v_mfma_f32_16x16x32_bf16 a[68:71], a[164:167], a[148:151], a[68:71]
    ds_read_b64_tr_b16 a[196:197], v17 offset:27808
    v_rcp_f32 v124, v124
    v_mfma_f32_16x16x32_bf16 a[68:71], a[168:171], a[100:103], a[68:71]
    v_rcp_f32 v125, v125
    v_rcp_f32 v126, v126
    v_mfma_f32_16x16x32_bf16 a[68:71], a[172:175], a[116:119], a[68:71]
    ds_read_b64_tr_b16 a[198:199], v17 offset:32416
    v_rcp_f32 v127, v127
    v_accvgpr_read_b32 v4, a48
    v_mfma_f32_16x16x32_bf16 a[72:75], a[160:163], a[136:139], a[72:75]
    v_accvgpr_read_b32 v5, a49
    v_accvgpr_read_b32 v6, a50
    v_accvgpr_read_b32 v7, a51
    v_accvgpr_read_b32 v8, a52
    v_mfma_f32_16x16x32_bf16 a[72:75], a[164:167], a[152:155], a[72:75]
    ds_read_b64_tr_b16 a[200:201], v18 offset:18592
    v_accvgpr_read_b32 v9, a53
    v_accvgpr_read_b32 v10, a54
    v_accvgpr_read_b32 v11, a55
    v_mfma_f32_16x16x32_bf16 a[72:75], a[168:171], a[104:107], a[72:75]
    v_accvgpr_read_b32 v12, a56
    v_accvgpr_read_b32 v13, a57
    v_accvgpr_read_b32 v14, a58
    v_accvgpr_read_b32 v15, a59
    v_mfma_f32_16x16x32_bf16 a[72:75], a[172:175], a[120:123], a[72:75]
    ds_read_b64_tr_b16 a[202:203], v18 offset:23200
    v_accvgpr_read_b32 v40, a60
    v_accvgpr_read_b32 v41, a61
    v_accvgpr_read_b32 v42, a62
    v_mfma_f32_16x16x32_bf16 a[76:79], a[160:163], a[140:143], a[76:79]
    v_accvgpr_read_b32 v43, a63
    s_nop 0
    v_pk_mul_f32 v[112:113], v[112:113], v[4:5]
    v_pk_mul_f32 v[114:115], v[114:115], v[6:7]
    v_pk_mul_f32 v[116:117], v[116:117], v[8:9]
    v_pk_mul_f32 v[118:119], v[118:119], v[10:11]
    v_pk_mul_f32 v[120:121], v[120:121], v[12:13]
    v_pk_mul_f32 v[122:123], v[122:123], v[14:15]
    v_pk_mul_f32 v[124:125], v[124:125], v[40:41]
    v_pk_mul_f32 v[126:127], v[126:127], v[42:43]
    v_pk_mul_f32 v[128:129], v[128:129], s[32:33] op_sel_hi:[1,0]
    v_pk_mul_f32 v[130:131], v[130:131], s[32:33] op_sel_hi:[1,0]
    v_pk_mul_f32 v[132:133], v[132:133], s[32:33] op_sel_hi:[1,0]
    v_pk_mul_f32 v[134:135], v[134:135], s[32:33] op_sel_hi:[1,0]
    v_pk_mul_f32 v[136:137], v[136:137], s[32:33] op_sel_hi:[1,0]
    v_pk_mul_f32 v[138:139], v[138:139], s[32:33] op_sel_hi:[1,0]
    v_pk_mul_f32 v[140:141], v[140:141], s[32:33] op_sel_hi:[1,0]
    v_pk_mul_f32 v[142:143], v[142:143], s[32:33] op_sel_hi:[1,0]
    v_mfma_f32_16x16x32_bf16 a[76:79], a[164:167], a[156:159], a[76:79]
    ds_read_b64_tr_b16 a[204:205], v18 offset:27808
    v_cvt_pk_bf16_f32 v112, v112, v113
    v_cvt_pk_bf16_f32 v113, v114, v115
    v_cvt_pk_bf16_f32 v114, v116, v117
    v_mfma_f32_16x16x32_bf16 a[76:79], a[168:171], a[108:111], a[76:79]
    v_cvt_pk_bf16_f32 v115, v118, v119
    v_cvt_pk_bf16_f32 v120, v120, v121
    v_cvt_pk_bf16_f32 v121, v122, v123
    v_cvt_pk_bf16_f32 v122, v124, v125
    v_mfma_f32_16x16x32_bf16 a[76:79], a[172:175], a[124:127], a[76:79]
    s_waitcnt lgkmcnt(7)
    ds_read_b64_tr_b16 a[206:207], v18 offset:32416
    v_cvt_pk_bf16_f32 v123, v126, v127
    v_mfma_f32_16x16x32_bf16 v[144:147], a[176:179], a[128:131], v[144:147]
    v_permlane16_swap_b32 v112, v114
    v_permlane16_swap_b32 v113, v115
    v_mfma_f32_16x16x32_bf16 v[144:147], a[180:183], a[144:147], v[144:147]
    ds_read_b64_tr_b16 a[160:161], v17 offset:192
    v_permlane16_swap_b32 v120, v122
    v_mfma_f32_16x16x32_bf16 v[144:147], a[184:187], a[96:99], v[144:147]
    v_permlane16_swap_b32 v121, v123
    v_exp_f32 v128, v128
    v_mfma_f32_16x16x32_bf16 v[144:147], a[188:191], a[112:115], v[144:147]
    ds_read_b64_tr_b16 a[162:163], v17 offset:4800
    v_exp_f32 v129, v129
    v_mfma_f32_16x16x32_bf16 v[148:151], a[176:179], a[132:135], v[148:151]
    v_exp_f32 v130, v130
    v_exp_f32 v131, v131
    v_mfma_f32_16x16x32_bf16 v[148:151], a[180:183], a[148:151], v[148:151]
    ds_read_b64_tr_b16 a[164:165], v17 offset:9408
    buffer_store_dwordx4 v[112:115], v19, s[20:23], s37 offen offset:1536 sc1
    v_mfma_f32_16x16x32_bf16 v[148:151], a[184:187], a[100:103], v[148:151]
    v_exp_f32 v132, v132
    v_exp_f32 v133, v133
    v_mfma_f32_16x16x32_bf16 v[148:151], a[188:191], a[116:119], v[148:151]
    ds_read_b64_tr_b16 a[166:167], v17 offset:14016
    v_exp_f32 v134, v134
    v_mfma_f32_16x16x32_bf16 v[152:155], a[176:179], a[136:139], v[152:155]
    v_exp_f32 v135, v135
    v_exp_f32 v136, v136
    v_mfma_f32_16x16x32_bf16 v[152:155], a[180:183], a[152:155], v[152:155]
    ds_read_b64_tr_b16 a[168:169], v18 offset:192
    v_exp_f32 v137, v137
    v_mfma_f32_16x16x32_bf16 v[152:155], a[184:187], a[104:107], v[152:155]
    buffer_store_dwordx4 v[120:123], v19, s[20:23], s39 offen offset:1536 sc1
    v_exp_f32 v138, v138
    v_mfma_f32_16x16x32_bf16 v[152:155], a[188:191], a[120:123], v[152:155]
    ds_read_b64_tr_b16 a[170:171], v18 offset:4800
    v_exp_f32 v139, v139
    v_mfma_f32_16x16x32_bf16 v[156:159], a[176:179], a[140:143], v[156:159]
    v_exp_f32 v140, v140
    v_exp_f32 v141, v141
    v_mfma_f32_16x16x32_bf16 v[156:159], a[180:183], a[156:159], v[156:159]
    ds_read_b64_tr_b16 a[172:173], v18 offset:9408
    v_exp_f32 v142, v142
    v_mfma_f32_16x16x32_bf16 v[156:159], a[184:187], a[108:111], v[156:159]
    v_exp_f32 v143, v143
    s_nop 0
    v_pk_add_f32 v[128:129], v[128:129], 1.0 op_sel_hi:[1,0]
    v_pk_add_f32 v[130:131], v[130:131], 1.0 op_sel_hi:[1,0]
    v_pk_add_f32 v[132:133], v[132:133], 1.0 op_sel_hi:[1,0]
    v_pk_add_f32 v[134:135], v[134:135], 1.0 op_sel_hi:[1,0]
    v_pk_add_f32 v[136:137], v[136:137], 1.0 op_sel_hi:[1,0]
    v_pk_add_f32 v[138:139], v[138:139], 1.0 op_sel_hi:[1,0]
    v_pk_add_f32 v[140:141], v[140:141], 1.0 op_sel_hi:[1,0]
    v_pk_add_f32 v[142:143], v[142:143], 1.0 op_sel_hi:[1,0]
    v_mfma_f32_16x16x32_bf16 v[156:159], a[188:191], a[124:127], v[156:159]
    s_waitcnt lgkmcnt(7)
    ds_read_b64_tr_b16 a[174:175], v18 offset:14016
    v_rcp_f32 v128, v128
    v_mfma_f32_16x16x32_bf16 a[80:83], a[192:195], a[128:131], a[80:83]
    s_waitcnt vmcnt(4)
    v_and_b32 v36, v36, v37
    v_and_b32 v38, v38, v39
    v_and_b32 v36, v36, v38
    v_cmp_ne_u32 vcc, s36, v36
    s_nop 1
    s_cmp_eq_u64 vcc, 0
    s_cbranch_scc0 L_spin_sf
L_back_sf:
    s_barrier
    v_mfma_f32_16x16x32_bf16 a[80:83], a[196:199], a[144:147], a[80:83]
    ds_read_b64_tr_b16 a[176:177], v17 offset:18624
    buffer_load_dwordx4 v[20:23], v54, s[20:23], s43 offen sc1
    s_add_u32 s43, s43, 591872
    v_mfma_f32_16x16x32_bf16 a[80:83], a[200:203], a[96:99], a[80:83]
    v_rcp_f32 v129, v129
    v_rcp_f32 v130, v130
    v_mfma_f32_16x16x32_bf16 a[80:83], a[204:207], a[112:115], a[80:83]
    ds_read_b64_tr_b16 a[178:179], v17 offset:23232
    v_rcp_f32 v131, v131
    v_mfma_f32_16x16x32_bf16 a[84:87], a[192:195], a[132:135], a[84:87]
    v_rcp_f32 v132, v132
    v_rcp_f32 v133, v133
    v_mfma_f32_16x16x32_bf16 a[84:87], a[196:199], a[148:151], a[84:87]
    ds_read_b64_tr_b16 a[180:181], v17 offset:27840
    v_rcp_f32 v134, v134
    v_mfma_f32_16x16x32_bf16 a[84:87], a[200:203], a[100:103], a[84:87]
    buffer_load_dwordx4 v[24:27], v54, s[20:23], s43 offen sc1
    s_add_u32 s43, s43, 591872
    v_rcp_f32 v135, v135
    v_mfma_f32_16x16x32_bf16 a[84:87], a[204:207], a[116:119], a[84:87]
    ds_read_b64_tr_b16 a[182:183], v17 offset:32448
    v_rcp_f32 v136, v136
    v_mfma_f32_16x16x32_bf16 a[88:91], a[192:195], a[136:139], a[88:91]
    v_rcp_f32 v137, v137
    v_rcp_f32 v138, v138
    v_mfma_f32_16x16x32_bf16 a[88:91], a[196:199], a[152:155], a[88:91]
    ds_read_b64_tr_b16 a[184:185], v18 offset:18624
    v_rcp_f32 v139, v139
    v_mfma_f32_16x16x32_bf16 a[88:91], a[200:203], a[104:107], a[88:91]
    v_rcp_f32 v140, v140
    v_rcp_f32 v141, v141
    v_mfma_f32_16x16x32_bf16 a[88:91], a[204:207], a[120:123], a[88:91]
    ds_read_b64_tr_b16 a[186:187], v18 offset:23232
    buffer_load_dwordx4 v[28:31], v54, s[20:23], s43 offen sc1
    s_add_u32 s43, s43, 591872
    v_mfma_f32_16x16x32_bf16 a[92:95], a[192:195], a[140:143], a[92:95]
    v_rcp_f32 v142, v142
    v_rcp_f32 v143, v143
    v_mfma_f32_16x16x32_bf16 a[92:95], a[196:199], a[156:159], a[92:95]
    ds_read_b64_tr_b16 a[188:189], v18 offset:27840
    v_accvgpr_read_b32 v4, a64
    v_accvgpr_read_b32 v5, a65
    v_accvgpr_read_b32 v6, a66
    v_mfma_f32_16x16x32_bf16 a[92:95], a[200:203], a[108:111], a[92:95]
    v_accvgpr_read_b32 v7, a67
    v_accvgpr_read_b32 v8, a68
    v_accvgpr_read_b32 v9, a69
    v_accvgpr_read_b32 v10, a70
    v_mfma_f32_16x16x32_bf16 a[92:95], a[204:207], a[124:127], a[92:95]
    s_waitcnt lgkmcnt(7)
    ds_read_b64_tr_b16 a[190:191], v18 offset:32448
    v_accvgpr_read_b32 v11, a71
    v_accvgpr_read_b32 v12, a72
    v_mfma_f32_16x16x32_bf16 v[160:163], a[160:163], a[128:131], v[160:163]
    buffer_load_dwordx4 v[32:35], v54, s[20:23], s43 offen sc1
    s_add_u32 s43, s43, 591872
    v_accvgpr_read_b32 v13, a73
    v_accvgpr_read_b32 v14, a74
    v_mfma_f32_16x16x32_bf16 v[160:163], a[164:167], a[144:147], v[160:163]
    ds_read_b64_tr_b16 a[192:193], v17 offset:224
    v_accvgpr_read_b32 v15, a75
    v_accvgpr_read_b32 v40, a76
    v_accvgpr_read_b32 v41, a77
    v_mfma_f32_16x16x32_bf16 v[160:163], a[168:171], a[96:99], v[160:163]
    v_accvgpr_read_b32 v42, a78
    v_accvgpr_read_b32 v43, a79
    s_nop 0
    v_pk_mul_f32 v[128:129], v[128:129], v[4:5]
    v_pk_mul_f32 v[130:131], v[130:131], v[6:7]
    v_pk_mul_f32 v[132:133], v[132:133], v[8:9]
    v_pk_mul_f32 v[134:135], v[134:135], v[10:11]
    v_pk_mul_f32 v[136:137], v[136:137], v[12:13]
    v_pk_mul_f32 v[138:139], v[138:139], v[14:15]
    v_pk_mul_f32 v[140:141], v[140:141], v[40:41]
    v_pk_mul_f32 v[142:143], v[142:143], v[42:43]
    v_pk_mul_f32 v[144:145], v[144:145], s[32:33] op_sel_hi:[1,0]
    v_pk_mul_f32 v[146:147], v[146:147], s[32:33] op_sel_hi:[1,0]
    v_pk_mul_f32 v[148:149], v[148:149], s[32:33] op_sel_hi:[1,0]
    v_pk_mul_f32 v[150:151], v[150:151], s[32:33] op_sel_hi:[1,0]
    v_pk_mul_f32 v[152:153], v[152:153], s[32:33] op_sel_hi:[1,0]
    v_pk_mul_f32 v[154:155], v[154:155], s[32:33] op_sel_hi:[1,0]
    v_pk_mul_f32 v[156:157], v[156:157], s[32:33] op_sel_hi:[1,0]
    v_pk_mul_f32 v[158:159], v[158:159], s[32:33] op_sel_hi:[1,0]
    v_mfma_f32_16x16x32_bf16 v[160:163], a[172:175], a[112:115], v[160:163]
    ds_read_b64_tr_b16 a[194:195], v17 offset:4832
    v_cvt_pk_bf16_f32 v128, v128, v129
    v_cvt_pk_bf16_f32 v129, v130, v131
    v_cvt_pk_bf16_f32 v130, v132, v133
    v_mfma_f32_16x16x32_bf16 v[164:167], a[160:163], a[132:135], v[164:167]
    v_cvt_pk_bf16_f32 v131, v134, v135
    v_cvt_pk_bf16_f32 v136, v136, v137
    v_cvt_pk_bf16_f32 v137, v138, v139
    v_cvt_pk_bf16_f32 v138, v140, v141
    v_mfma_f32_16x16x32_bf16 v[164:167], a[164:167], a[148:151], v[164:167]
    ds_read_b64_tr_b16 a[196:197], v17 offset:9440
    s_add_u32 m0, s30, 0
    v_cvt_pk_bf16_f32 v139, v142, v143
    v_mfma_f32_16x16x32_bf16 v[164:167], a[168:171], a[100:103], v[164:167]
    buffer_load_dwordx4 v1, s[20:23], s48 offen offset:0 sc1 lds
    v_permlane16_swap_b32 v128, v130
    v_mfma_f32_16x16x32_bf16 v[164:167], a[172:175], a[116:119], v[164:167]
    ds_read_b64_tr_b16 a[198:199], v17 offset:14048
    v_permlane16_swap_b32 v129, v131
    v_mfma_f32_16x16x32_bf16 v[168:171], a[160:163], a[136:139], v[168:171]
    v_permlane16_swap_b32 v136, v138
    v_permlane16_swap_b32 v137, v139
    v_mfma_f32_16x16x32_bf16 v[168:171], a[164:167], a[152:155], v[168:171]
    ds_read_b64_tr_b16 a[200:201], v18 offset:224
    v_exp_f32 v144, v144
    v_mfma_f32_16x16x32_bf16 v[168:171], a[168:171], a[104:107], v[168:171]
    buffer_load_dwordx4 v1, s[20:23], s48 offen offset:1024 sc1 lds
    v_exp_f32 v145, v145
    v_mfma_f32_16x16x32_bf16 v[168:171], a[172:175], a[120:123], v[168:171]
    ds_read_b64_tr_b16 a[202:203], v18 offset:4832
    v_exp_f32 v146, v146
    v_mfma_f32_16x16x32_bf16 v[172:175], a[160:163], a[140:143], v[172:175]
    v_exp_f32 v147, v147
    v_mfma_f32_16x16x32_bf16 v[172:175], a[164:167], a[156:159], v[172:175]
    ds_read_b64_tr_b16 a[204:205], v18 offset:9440
    buffer_store_dwordx4 v[128:131], v19, s[20:23], s37 offen offset:2048 sc1
    v_mfma_f32_16x16x32_bf16 v[172:175], a[168:171], a[108:111], v[172:175]
    v_exp_f32 v148, v148
    v_exp_f32 v149, v149
    v_mfma_f32_16x16x32_bf16 v[172:175], a[172:175], a[124:127], v[172:175]
    s_waitcnt lgkmcnt(7)
    ds_read_b64_tr_b16 a[206:207], v18 offset:14048
    v_exp_f32 v150, v150
    v_mfma_f32_16x16x32_bf16 v[208:211], a[176:179], a[128:131], v[208:211]
    buffer_load_dwordx4 v1, s[20:23], s48 offen offset:2048 sc1 lds
    v_exp_f32 v151, v151
    v_mfma_f32_16x16x32_bf16 v[208:211], a[180:183], a[144:147], v[208:211]
    ds_read_b64_tr_b16 a[160:161], v17 offset:18656
    v_exp_f32 v152, v152
    v_mfma_f32_16x16x32_bf16 v[208:211], a[184:187], a[96:99], v[208:211]
    v_exp_f32 v153, v153
    v_mfma_f32_16x16x32_bf16 v[208:211], a[188:191], a[112:115], v[208:211]
    ds_read_b64_tr_b16 a[162:163], v17 offset:23264
    buffer_store_dwordx4 v[136:139], v19, s[20:23], s39 offen offset:2048 sc1
    v_mfma_f32_16x16x32_bf16 v[212:215], a[176:179], a[132:135], v[212:215]
    v_exp_f32 v154, v154
    v_exp_f32 v155, v155
    v_mfma_f32_16x16x32_bf16 v[212:215], a[180:183], a[148:151], v[212:215]
    ds_read_b64_tr_b16 a[164:165], v17 offset:27872
    v_exp_f32 v156, v156
    v_mfma_f32_16x16x32_bf16 v[212:215], a[184:187], a[100:103], v[212:215]
    buffer_load_dwordx4 v1, s[20:23], s48 offen offset:3072 sc1 lds
    v_exp_f32 v157, v157
    v_mfma_f32_16x16x32_bf16 v[212:215], a[188:191], a[116:119], v[212:215]
    ds_read_b64_tr_b16 a[166:167], v17 offset:32480
    v_exp_f32 v158, v158
    v_mfma_f32_16x16x32_bf16 v[216:219], a[176:179], a[136:139], v[216:219]
    v_exp_f32 v159, v159
    s_nop 0
    v_pk_add_f32 v[144:145], v[144:145], 1.0 op_sel_hi:[1,0]
    v_pk_add_f32 v[146:147], v[146:147], 1.0 op_sel_hi:[1,0]
    v_pk_add_f32 v[148:149], v[148:149], 1.0 op_sel_hi:[1,0]
    v_pk_add_f32 v[150:151], v[150:151], 1.0 op_sel_hi:[1,0]
    v_pk_add_f32 v[152:153], v[152:153], 1.0 op_sel_hi:[1,0]
    v_pk_add_f32 v[154:155], v[154:155], 1.0 op_sel_hi:[1,0]
    v_pk_add_f32 v[156:157], v[156:157], 1.0 op_sel_hi:[1,0]
    v_pk_add_f32 v[158:159], v[158:159], 1.0 op_sel_hi:[1,0]
    v_mfma_f32_16x16x32_bf16 v[216:219], a[180:183], a[152:155], v[216:219]
    ds_read_b64_tr_b16 a[168:169], v18 offset:18656
    v_rcp_f32 v144, v144
    v_mfma_f32_16x16x32_bf16 v[216:219], a[184:187], a[104:107], v[216:219]
    s_add_u32 s48, s48, 4096
    s_add_u32 m0, s30, 4096
    v_rcp_f32 v145, v145
    v_mfma_f32_16x16x32_bf16 v[216:219], a[188:191], a[120:123], v[216:219]
    ds_read_b64_tr_b16 a[170:171], v18 offset:23264
    buffer_load_dwordx4 v1, s[20:23], s48 offen offset:0 sc1 lds
    v_mfma_f32_16x16x32_bf16 v[220:223], a[176:179], a[140:143], v[220:223]
    v_rcp_f32 v146, v146
    v_rcp_f32 v147, v147
    v_mfma_f32_16x16x32_bf16 v[220:223], a[180:183], a[156:159], v[220:223]
    ds_read_b64_tr_b16 a[172:173], v18 offset:27872
    v_rcp_f32 v148, v148
    v_mfma_f32_16x16x32_bf16 v[220:223], a[184:187], a[108:111], v[220:223]
    v_rcp_f32 v149, v149
    v_rcp_f32 v150, v150
    v_mfma_f32_16x16x32_bf16 v[220:223], a[188:191], a[124:127], v[220:223]
    s_waitcnt lgkmcnt(7)
    ds_read_b64_tr_b16 a[174:175], v18 offset:32480
    buffer_load_dwordx4 v1, s[20:23], s48 offen offset:1024 sc1 lds
    v_mfma_f32_16x16x32_bf16 v[176:179], a[192:195], a[128:131], v[176:179]
    v_rcp_f32 v151, v151
    v_rcp_f32 v152, v152
    v_mfma_f32_16x16x32_bf16 v[176:179], a[196:199], a[144:147], v[176:179]
    ds_read_b64_tr_b16 a[176:177], v17 offset:256
    v_rcp_f32 v153, v153
    v_mfma_f32_16x16x32_bf16 v[176:179], a[200:203], a[96:99], v[176:179]
    v_rcp_f32 v154, v154
    v_rcp_f32 v155, v155
    v_mfma_f32_16x16x32_bf16 v[176:179], a[204:207], a[112:115], v[176:179]
    ds_read_b64_tr_b16 a[178:179], v17 offset:4864
    buffer_load_dwordx4 v1, s[20:23], s48 offen offset:2048 sc1 lds
    v_mfma_f32_16x16x32_bf16 v[180:183], a[192:195], a[132:135], v[180:183]
    v_rcp_f32 v156, v156
    v_rcp_f32 v157, v157
    v_mfma_f32_16x16x32_bf16 v[180:183], a[196:199], a[148:151], v[180:183]
    ds_read_b64_tr_b16 a[180:181], v17 offset:9472
    v_rcp_f32 v158, v158
    v_mfma_f32_16x16x32_bf16 v[180:183], a[200:203], a[100:103], v[180:183]
    v_rcp_f32 v159, v159
    v_accvgpr_read_b32 v4, a80
    v_accvgpr_read_b32 v5, a81
    v_mfma_f32_16x16x32_bf16 v[180:183], a[204:207], a[116:119], v[180:183]
    ds_read_b64_tr_b16 a[182:183], v17 offset:14080
    buffer_load_dwordx4 v1, s[20:23], s48 offen offset:3072 sc1 lds
    v_accvgpr_read_b32 v6, a82
    v_mfma_f32_16x16x32_bf16 v[184:187], a[192:195], a[136:139], v[184:187]
    v_accvgpr_read_b32 v7, a83
    v_accvgpr_read_b32 v8, a84
    v_accvgpr_read_b32 v9, a85
    v_accvgpr_read_b32 v10, a86
    v_mfma_f32_16x16x32_bf16 v[184:187], a[196:199], a[152:155], v[184:187]
    ds_read_b64_tr_b16 a[184:185], v18 offset:256
    v_accvgpr_read_b32 v11, a87
    v_accvgpr_read_b32 v12, a88
    v_accvgpr_read_b32 v13, a89
    v_mfma_f32_16x16x32_bf16 v[184:187], a[200:203], a[104:107], v[184:187]
    v_accvgpr_read_b32 v14, a90
    v_accvgpr_read_b32 v15, a91
    v_accvgpr_read_b32 v40, a92
    v_accvgpr_read_b32 v41, a93
    v_mfma_f32_16x16x32_bf16 v[184:187], a[204:207], a[120:123], v[184:187]
    ds_read_b64_tr_b16 a[186:187], v18 offset:4864
    s_add_u32 s48, s48, 4096
    s_add_u32 m0, s30, 8192
    v_accvgpr_read_b32 v42, a94
    v_mfma_f32_16x16x32_bf16 v[188:191], a[192:195], a[140:143], v[188:191]
    buffer_load_dwordx4 v1, s[20:23], s48 offen offset:0 sc1 lds
    v_accvgpr_read_b32 v43, a95
    s_nop 0
    v_pk_mul_f32 v[144:145], v[144:145], v[4:5]
    v_pk_mul_f32 v[146:147], v[146:147], v[6:7]
    v_pk_mul_f32 v[148:149], v[148:149], v[8:9]
    v_pk_mul_f32 v[150:151], v[150:151], v[10:11]
    v_pk_mul_f32 v[152:153], v[152:153], v[12:13]
    v_pk_mul_f32 v[154:155], v[154:155], v[14:15]
    v_pk_mul_f32 v[156:157], v[156:157], v[40:41]
    v_pk_mul_f32 v[158:159], v[158:159], v[42:43]
    v_pk_mul_f32 v[160:161], v[160:161], s[32:33] op_sel_hi:[1,0]
    v_pk_mul_f32 v[162:163], v[162:163], s[32:33] op_sel_hi:[1,0]
    v_pk_mul_f32 v[164:165], v[164:165], s[32:33] op_sel_hi:[1,0]
    v_pk_mul_f32 v[166:167], v[166:167], s[32:33] op_sel_hi:[1,0]
    v_pk_mul_f32 v[168:169], v[168:169], s[32:33] op_sel_hi:[1,0]
    v_pk_mul_f32 v[170:171], v[170:171], s[32:33] op_sel_hi:[1,0]
    v_pk_mul_f32 v[172:173], v[172:173], s[32:33] op_sel_hi:[1,0]
    v_pk_mul_f32 v[174:175], v[174:175], s[32:33] op_sel_hi:[1,0]
    v_mfma_f32_16x16x32_bf16 v[188:191], a[196:199], a[156:159], v[188:191]
    ds_read_b64_tr_b16 a[188:189], v18 offset:9472
    v_cvt_pk_bf16_f32 v144, v144, v145
    v_cvt_pk_bf16_f32 v145, v146, v147
    v_cvt_pk_bf16_f32 v146, v148, v149
    v_mfma_f32_16x16x32_bf16 v[188:191], a[200:203], a[108:111], v[188:191]
    v_cvt_pk_bf16_f32 v147, v150, v151
    v_cvt_pk_bf16_f32 v152, v152, v153
    v_cvt_pk_bf16_f32 v153, v154, v155
    v_cvt_pk_bf16_f32 v154, v156, v157
    v_mfma_f32_16x16x32_bf16 v[188:191], a[204:207], a[124:127], v[188:191]
    s_waitcnt lgkmcnt(7)
    ds_read_b64_tr_b16 a[190:191], v18 offset:14080
    v_cvt_pk_bf16_f32 v155, v158, v159
    v_mfma_f32_16x16x32_bf16 v[224:227], a[160:163], a[128:131], v[224:227]
    s_cmp_lg_u32 s24, 3
    s_cbranch_scc1 L_not3b
    s_mov_b32 m0, 162304
    s_nop 0
    buffer_load_dwordx4 v1, s[20:23], s51 offen sc1 lds
L_not3b:
    s_and_b32 s98, s34, 31
    s_lshl_b32 s98, s98, 2
    s_add_u32 s98, s98, s24
    s_lshl_b32 s98, s98, 7
    s_add_u32 s98, s98, 40960
    s_min_u32 s98, s98, L_code_end-L_pf_here-8
    v_mov_b32 v58, s98
    s_mov_b64 exec, 1
    global_load_dword v0, v58, s[60:61]
    s_mov_b64 exec, -1
    v_mfma_f32_16x16x32_bf16 v[224:227], a[164:167], a[144:147], v[224:227]
    ds_read_b64_tr_b16 a[192:193], v17 offset:18688
    v_permlane16_swap_b32 v144, v146
    v_mfma_f32_16x16x32_bf16 v[224:227], a[168:171], a[96:99], v[224:227]
    v_permlane16_swap_b32 v145, v147
    v_permlane16_swap_b32 v152, v154
    v_mfma_f32_16x16x32_bf16 v[224:227], a[172:175], a[112:115], v[224:227]
    ds_read_b64_tr_b16 a[194:195], v17 offset:23296
    v_permlane16_swap_b32 v153, v155
    v_mfma_f32_16x16x32_bf16 v[228:231], a[160:163], a[132:135], v[228:231]
    v_exp_f32 v160, v160
    v_exp_f32 v161, v161
    v_mfma_f32_16x16x32_bf16 v[228:231], a[164:167], a[148:151], v[228:231]
    ds_read_b64_tr_b16 a[196:197], v17 offset:27904
    v_exp_f32 v162, v162
    v_mfma_f32_16x16x32_bf16 v[228:231], a[168:171], a[100:103], v[228:231]
    v_exp_f32 v163, v163
    v_mfma_f32_16x16x32_bf16 v[228:231], a[172:175], a[116:119], v[228:231]
    ds_read_b64_tr_b16 a[198:199], v17 offset:32512
    s_waitcnt vmcnt(7)
    s_mov_b64 exec, 1
    buffer_store_dword v45, v44, s[20:23], s27 offen sc1
    s_mov_b64 exec, -1
    v_mfma_f32_16x16x32_bf16 v[232:235], a[160:163], a[136:139], v[232:235]
    buffer_store_dwordx4 v[144:147], v19, s[20:23], s37 offen offset:2560 sc1
    v_exp_f32 v164, v164
    v_mfma_f32_16x16x32_bf16 v[232:235], a[164:167], a[152:155], v[232:235]
    ds_read_b64_tr_b16 a[200:201], v18 offset:18688
    v_exp_f32 v165, v165
    v_mfma_f32_16x16x32_bf16 v[232:235], a[168:171], a[104:107], v[232:235]
    v_exp_f32 v166, v166
    v_exp_f32 v167, v167
    v_mfma_f32_16x16x32_bf16 v[232:235], a[172:175], a[120:123], v[232:235]
    ds_read_b64_tr_b16 a[202:203], v18 offset:23296
    v_exp_f32 v168, v168
    v_mfma_f32_16x16x32_bf16 v[236:239], a[160:163], a[140:143], v[236:239]
    v_exp_f32 v169, v169
    v_mfma_f32_16x16x32_bf16 v[236:239], a[164:167], a[156:159], v[236:239]
    ds_read_b64_tr_b16 a[204:205], v18 offset:27904
    buffer_store_dwordx4 v[152:155], v19, s[20:23], s39 offen offset:2560 sc1
    v_mfma_f32_16x16x32_bf16 v[236:239], a[168:171], a[108:111], v[236:239]
    v_exp_f32 v170, v170
    v_exp_f32 v171, v171
    v_mfma_f32_16x16x32_bf16 v[236:239], a[172:175], a[124:127], v[236:239]
    s_waitcnt lgkmcnt(7)
    ds_read_b64_tr_b16 a[206:207], v18 offset:32512
    v_exp_f32 v172, v172
    v_mfma_f32_16x16x32_bf16 v[192:195], a[176:179], a[128:131], v[192:195]
    v_exp_f32 v173, v173
    v_exp_f32 v174, v174
    v_mfma_f32_16x16x32_bf16 v[192:195], a[180:183], a[144:147], v[192:195]
    v_exp_f32 v175, v175
    s_nop 0
    v_pk_add_f32 v[160:161], v[160:161], 1.0 op_sel_hi:[1,0]
    v_pk_add_f32 v[162:163], v[162:163], 1.0 op_sel_hi:[1,0]
    v_pk_add_f32 v[164:165], v[164:165], 1.0 op_sel_hi:[1,0]
    v_pk_add_f32 v[166:167], v[166:167], 1.0 op_sel_hi:[1,0]
    v_pk_add_f32 v[168:169], v[168:169], 1.0 op_sel_hi:[1,0]
    v_pk_add_f32 v[170:171], v[170:171], 1.0 op_sel_hi:[1,0]
    v_pk_add_f32 v[172:173], v[172:173], 1.0 op_sel_hi:[1,0]
    v_pk_add_f32 v[174:175], v[174:175], 1.0 op_sel_hi:[1,0]
    v_mfma_f32_16x16x32_bf16 v[192:195], a[184:187], a[96:99], v[192:195]
    v_rcp_f32 v160, v160
    v_rcp_f32 v161, v161
    v_mfma_f32_16x16x32_bf16 v[192:195], a[188:191], a[112:115], v[192:195]
    v_rcp_f32 v162, v162
    v_rcp_f32 v163, v163
    v_mfma_f32_16x16x32_bf16 v[196:199], a[176:179], a[132:135], v[196:199]
    v_rcp_f32 v164, v164
    v_rcp_f32 v165, v165
    v_mfma_f32_16x16x32_bf16 v[196:199], a[180:183], a[148:151], v[196:199]
    v_rcp_f32 v166, v166
    v_rcp_f32 v167, v167
    v_mfma_f32_16x16x32_bf16 v[196:199], a[184:187], a[100:103], v[196:199]
    v_rcp_f32 v168, v168
    v_rcp_f32 v169, v169
    v_mfma_f32_16x16x32_bf16 v[196:199], a[188:191], a[116:119], v[196:199]
    v_rcp_f32 v170, v170
    v_rcp_f32 v171, v171
    v_mfma_f32_16x16x32_bf16 v[200:203], a[176:179], a[136:139], v[200:203]
    v_rcp_f32 v172, v172
    v_rcp_f32 v173, v173
    v_mfma_f32_16x16x32_bf16 v[200:203], a[180:183], a[152:155], v[200:203]
    v_rcp_f32 v174, v174
    v_rcp_f32 v175, v175
    s_nop 0
    v_pk_mul_f32 v[160:161], v[160:161], v[208:209]
    v_pk_mul_f32 v[162:163], v[162:163], v[210:211]
    v_pk_mul_f32 v[164:165], v[164:165], v[212:213]
    v_pk_mul_f32 v[166:167], v[166:167], v[214:215]
    v_pk_mul_f32 v[168:169], v[168:169], v[216:217]
    v_pk_mul_f32 v[170:171], v[170:171], v[218:219]
    v_pk_mul_f32 v[172:173], v[172:173], v[220:221]
    v_pk_mul_f32 v[174:175], v[174:175], v[222:223]
    v_pk_mul_f32 v[176:177], v[176:177], s[32:33] op_sel_hi:[1,0]
    v_pk_mul_f32 v[178:179], v[178:179], s[32:33] op_sel_hi:[1,0]
    v_pk_mul_f32 v[180:181], v[180:181], s[32:33] op_sel_hi:[1,0]
    v_pk_mul_f32 v[182:183], v[182:183], s[32:33] op_sel_hi:[1,0]
    v_pk_mul_f32 v[184:185], v[184:185], s[32:33] op_sel_hi:[1,0]
    v_pk_mul_f32 v[186:187], v[186:187], s[32:33] op_sel_hi:[1,0]
    v_pk_mul_f32 v[188:189], v[188:189], s[32:33] op_sel_hi:[1,0]
    v_pk_mul_f32 v[190:191], v[190:191], s[32:33] op_sel_hi:[1,0]
    v_mfma_f32_16x16x32_bf16 v[200:203], a[184:187], a[104:107], v[200:203]
    v_cvt_pk_bf16_f32 v160, v160, v161
    v_cvt_pk_bf16_f32 v161, v162, v163
    v_cvt_pk_bf16_f32 v162, v164, v165
    v_cvt_pk_bf16_f32 v163, v166, v167
    v_mfma_f32_16x16x32_bf16 v[200:203], a[188:191], a[120:123], v[200:203]
    v_cvt_pk_bf16_f32 v168, v168, v169
    v_cvt_pk_bf16_f32 v169, v170, v171
    v_cvt_pk_bf16_f32 v170, v172, v173
    v_cvt_pk_bf16_f32 v171, v174, v175
    v_mfma_f32_16x16x32_bf16 v[204:207], a[176:179], a[140:143], v[204:207]
    v_permlane16_swap_b32 v160, v162
    v_permlane16_swap_b32 v161, v163
    v_mfma_f32_16x16x32_bf16 v[204:207], a[180:183], a[156:159], v[204:207]
    v_permlane16_swap_b32 v168, v170
    v_permlane16_swap_b32 v169, v171
    v_mfma_f32_16x16x32_bf16 v[204:207], a[184:187], a[108:111], v[204:207]
    v_exp_f32 v176, v176
    v_exp_f32 v177, v177
    v_mfma_f32_16x16x32_bf16 v[204:207], a[188:191], a[124:127], v[204:207]
    s_waitcnt lgkmcnt(0)
    v_exp_f32 v178, v178
    v_exp_f32 v179, v179
    v_mfma_f32_16x16x32_bf16 v[240:243], a[192:195], a[128:131], v[240:243]
    buffer_store_dwordx4 v[160:163], v19, s[20:23], s37 offen offset:3072 sc1
    v_exp_f32 v180, v180
    v_mfma_f32_16x16x32_bf16 v[240:243], a[196:199], a[144:147], v[240:243]
    v_exp_f32 v181, v181
    v_exp_f32 v182, v182
    v_mfma_f32_16x16x32_bf16 v[240:243], a[200:203], a[96:99], v[240:243]
    v_exp_f32 v183, v183
    v_exp_f32 v184, v184
    v_mfma_f32_16x16x32_bf16 v[240:243], a[204:207], a[112:115], v[240:243]
    v_exp_f32 v185, v185
    v_mfma_f32_16x16x32_bf16 v[244:247], a[192:195], a[132:135], v[244:247]
    buffer_store_dwordx4 v[168:171], v19, s[20:23], s39 offen offset:3072 sc1
    v_exp_f32 v186, v186
    v_mfma_f32_16x16x32_bf16 v[244:247], a[196:199], a[148:151], v[244:247]
    v_exp_f32 v187, v187
    v_exp_f32 v188, v188
    v_mfma_f32_16x16x32_bf16 v[244:247], a[200:203], a[100:103], v[244:247]
    v_exp_f32 v189, v189
    v_exp_f32 v190, v190
    v_mfma_f32_16x16x32_bf16 v[244:247], a[204:207], a[116:119], v[244:247]
    v_exp_f32 v191, v191
    s_nop 0
    v_pk_add_f32 v[176:177], v[176:177], 1.0 op_sel_hi:[1,0]
    v_pk_add_f32 v[178:179], v[178:179], 1.0 op_sel_hi:[1,0]
    v_pk_add_f32 v[180:181], v[180:181], 1.0 op_sel_hi:[1,0]
    v_pk_add_f32 v[182:183], v[182:183], 1.0 op_sel_hi:[1,0]
    v_pk_add_f32 v[184:185], v[184:185], 1.0 op_sel_hi:[1,0]
    v_pk_add_f32 v[186:187], v[186:187], 1.0 op_sel_hi:[1,0]
    v_pk_add_f32 v[188:189], v[188:189], 1.0 op_sel_hi:[1,0]
    v_pk_add_f32 v[190:191], v[190:191], 1.0 op_sel_hi:[1,0]
    v_mfma_f32_16x16x32_bf16 v[248:251], a[192:195], a[136:139], v[248:251]
    v_rcp_f32 v176, v176
    v_rcp_f32 v177, v177
    v_mfma_f32_16x16x32_bf16 v[248:251], a[196:199], a[152:155], v[248:251]
    v_rcp_f32 v178, v178
    v_rcp_f32 v179, v179
    v_mfma_f32_16x16x32_bf16 v[248:251], a[200:203], a[104:107], v[248:251]
    v_rcp_f32 v180, v180
    v_rcp_f32 v181, v181
    v_mfma_f32_16x16x32_bf16 v[248:251], a[204:207], a[120:123], v[248:251]
    v_rcp_f32 v182, v182
    v_rcp_f32 v183, v183
    v_mfma_f32_16x16x32_bf16 v[252:255], a[192:195], a[140:143], v[252:255]
    v_rcp_f32 v184, v184
    v_rcp_f32 v185, v185
    v_mfma_f32_16x16x32_bf16 v[252:255], a[196:199], a[156:159], v[252:255]
    v_rcp_f32 v186, v186
    v_rcp_f32 v187, v187
    v_mfma_f32_16x16x32_bf16 v[252:255], a[200:203], a[108:111], v[252:255]
    v_rcp_f32 v188, v188
    v_rcp_f32 v189, v189
    v_mfma_f32_16x16x32_bf16 v[252:255], a[204:207], a[124:127], v[252:255]
    v_rcp_f32 v190, v190
    v_rcp_f32 v191, v191
    s_nop 0
    v_pk_mul_f32 v[176:177], v[176:177], v[224:225]
    v_pk_mul_f32 v[178:179], v[178:179], v[226:227]
    v_pk_mul_f32 v[180:181], v[180:181], v[228:229]
    v_pk_mul_f32 v[182:183], v[182:183], v[230:231]
    v_pk_mul_f32 v[184:185], v[184:185], v[232:233]
    v_pk_mul_f32 v[186:187], v[186:187], v[234:235]
    v_pk_mul_f32 v[188:189], v[188:189], v[236:237]
    v_pk_mul_f32 v[190:191], v[190:191], v[238:239]
    v_pk_mul_f32 v[192:193], v[192:193], s[32:33] op_sel_hi:[1,0]
    v_pk_mul_f32 v[194:195], v[194:195], s[32:33] op_sel_hi:[1,0]
    v_pk_mul_f32 v[196:197], v[196:197], s[32:33] op_sel_hi:[1,0]
    v_pk_mul_f32 v[198:199], v[198:199], s[32:33] op_sel_hi:[1,0]
    v_pk_mul_f32 v[200:201], v[200:201], s[32:33] op_sel_hi:[1,0]
    v_pk_mul_f32 v[202:203], v[202:203], s[32:33] op_sel_hi:[1,0]
    v_pk_mul_f32 v[204:205], v[204:205], s[32:33] op_sel_hi:[1,0]
    v_pk_mul_f32 v[206:207], v[206:207], s[32:33] op_sel_hi:[1,0]
    s_load_dwordx2 s[6:7], s[0:1], 40
    s_load_dwordx2 s[10:11], s[0:1], 0
    s_load_dwordx2 s[18:19], s[0:1], 88
    s_nop 4
    v_cvt_pk_bf16_f32 v176, v176, v177
    v_cvt_pk_bf16_f32 v177, v178, v179
    v_cvt_pk_bf16_f32 v178, v180, v181
    v_cvt_pk_bf16_f32 v179, v182, v183
    v_cvt_pk_bf16_f32 v184, v184, v185
    v_cvt_pk_bf16_f32 v185, v186, v187
    v_cvt_pk_bf16_f32 v186, v188, v189
    v_cvt_pk_bf16_f32 v187, v190, v191
    v_permlane16_swap_b32 v176, v178
    v_permlane16_swap_b32 v177, v179
    v_permlane16_swap_b32 v184, v186
    v_permlane16_swap_b32 v185, v187
    v_exp_f32 v192, v192
    v_exp_f32 v193, v193
    v_exp_f32 v194, v194
    v_exp_f32 v195, v195
    buffer_store_dwordx4 v[176:179], v19, s[20:23], s37 offen offset:3584 sc1
    v_exp_f32 v196, v196
    v_exp_f32 v197, v197
    v_exp_f32 v198, v198
    v_exp_f32 v199, v199
    v_exp_f32 v200, v200
    v_exp_f32 v201, v201
    buffer_store_dwordx4 v[184:187], v19, s[20:23], s39 offen offset:3584 sc1
    v_exp_f32 v202, v202
    v_exp_f32 v203, v203
    v_exp_f32 v204, v204
    v_exp_f32 v205, v205
    v_exp_f32 v206, v206
    v_exp_f32 v207, v207
    s_nop 0
    v_pk_add_f32 v[192:193], v[192:193], 1.0 op_sel_hi:[1,0]
    v_pk_add_f32 v[194:195], v[194:195], 1.0 op_sel_hi:[1,0]
    v_pk_add_f32 v[196:197], v[196:197], 1.0 op_sel_hi:[1,0]
    v_pk_add_f32 v[198:199], v[198:199], 1.0 op_sel_hi:[1,0]
    v_pk_add_f32 v[200:201], v[200:201], 1.0 op_sel_hi:[1,0]
    v_pk_add_f32 v[202:203], v[202:203], 1.0 op_sel_hi:[1,0]
    v_pk_add_f32 v[204:205], v[204:205], 1.0 op_sel_hi:[1,0]
    v_pk_add_f32 v[206:207], v[206:207], 1.0 op_sel_hi:[1,0]
    v_rcp_f32 v192, v192
    v_rcp_f32 v193, v193
    v_rcp_f32 v194, v194
    v_rcp_f32 v195, v195
    v_rcp_f32 v196, v196
    v_rcp_f32 v197, v197
    v_rcp_f32 v198, v198
    v_rcp_f32 v199, v199
    v_rcp_f32 v200, v200
    v_rcp_f32 v201, v201
    v_rcp_f32 v202, v202
    v_rcp_f32 v203, v203
    v_rcp_f32 v204, v204
    v_rcp_f32 v205, v205
    v_rcp_f32 v206, v206
    v_rcp_f32 v207, v207
    s_nop 0
    v_pk_mul_f32 v[192:193], v[192:193], v[240:241]
    v_pk_mul_f32 v[194:195], v[194:195], v[242:243]
    v_pk_mul_f32 v[196:197], v[196:197], v[244:245]
    v_pk_mul_f32 v[198:199], v[198:199], v[246:247]
    v_pk_mul_f32 v[200:201], v[200:201], v[248:249]
    v_pk_mul_f32 v[202:203], v[202:203], v[250:251]
    v_pk_mul_f32 v[204:205], v[204:205], v[252:253]
    v_pk_mul_f32 v[206:207], v[206:207], v[254:255]
    v_cvt_pk_bf16_f32 v192, v192, v193
    v_cvt_pk_bf16_f32 v193, v194, v195
    v_cvt_pk_bf16_f32 v194, v196, v197
    v_cvt_pk_bf16_f32 v195, v198, v199
    v_cvt_pk_bf16_f32 v200, v200, v201
    v_cvt_pk_bf16_f32 v201, v202, v203
    v_cvt_pk_bf16_f32 v202, v204, v205
    v_cvt_pk_bf16_f32 v203, v206, v207
    v_permlane16_swap_b32 v192, v194
    v_permlane16_swap_b32 v193, v195
    v_permlane16_swap_b32 v200, v202
    v_permlane16_swap_b32 v201, v203
    buffer_store_dwordx4 v[192:195], v19, s[20:23], s38 offen offset:0 sc1
    buffer_store_dwordx4 v[200:203], v19, s[20:23], s40 offen offset:0 sc1
    s_waitcnt lgkmcnt(0)
    s_barrier
L_phaseB:
    s_mov_b32 s14, s18
    s_mov_b32 s15, s19
    s_mov_b32 s40, s26
    s_mov_b32 s42, s25
    s_add_u32 s62, s27, 16384
    v_mov_b32 v3, v1
    s_lshr_b32 s36, s33, 1
    s_and_b32 s38, s33, 1
    s_lshl_b32 s38, s38, 5
    s_and_b32 s35, s34, 3
    s_add_u32 s34, s34, s38
    s_lshr_b32 s37, s34, 2
    s_lshl_b32 s38, s37, 1
    s_lshr_b32 s39, s24, 1
    s_add_u32 s38, s38, s39
    s_lshl_b32 s38, s38, 9
    s_lshl_b32 s39, s36, 7
    s_add_u32 s63, s38, s39
    s_add_u32 s63, s63, 24864768
    s_lshl_b32 s37, s37, 3
    s_lshl_b32 s38, s24, 1
    s_add_u32 s37, s37, s38
    s_mul_i32 s26, s37, 148480
    s_mul_i32 s38, s36, 36*1024
    s_add_u32 s26, s26, s38
    s_mul_i32 s27, s35, 1160
    s_mul_i32 s39, s36, 36
    s_add_u32 s27, s27, s39
    s_mul_i32 s39, s24, 9
    s_add_u32 s27, s27, s39
    s_lshl_b32 s27, s27, 10
    s_add_u32 s27, s27, 25165824
    s_add_u32 s60, s63, 16384
    s_add_u32 s59, s63, 32768
    s_cmp_lt_u32 s40, 576
    s_cbranch_scc1 L_conv
    buffer_load_dword v5, v51, s[20:23], s63 offen sc1
    s_waitcnt vmcnt(5)
    s_mov_b64 exec, 1
    buffer_store_dword v45, v44, s[20:23], s62 offen sc1
    s_mov_b64 exec, -1
    s_add_u32 s62, s62, 16384
    s_cmp_lg_u32 s24, 3
    s_cbranch_scc1 L_nw1
    s_lshl_b32 s58, s34, 7
    s_add_u32 s58, s58, 24848384
    s_lshl_b32 s57, s36, 2
    s_add_u32 s57, s57, s58
    s_mov_b64 exec, 1
    buffer_store_dword v45, v44, s[20:23], s57 offen sc1
    s_mov_b64 exec, -1
    s_add_u32 s29, s36, 1
    s_and_b32 s29, s29, 3
    s_lshl_b32 s29, s29, 1
    s_add_u32 s29, s29, 0
    s_mul_i32 s29, s29, 148480
    s_add_u32 s29, s29, s27
    s_sub_u32 s29, s29, 27*1024
    s_mov_b32 m0, 36864
    s_nop 0
    buffer_load_dwordx4 v3, s[20:23], s29 offen offset:0 sc1 lds
    buffer_load_dwordx4 v3, s[20:23], s29 offen offset:1024 sc1 lds
    buffer_load_dwordx4 v3, s[20:23], s29 offen offset:2048 sc1 lds
    buffer_load_dwordx4 v3, s[20:23], s29 offen offset:3072 sc1 lds
    s_add_u32 s29, s29, 4096
    s_mov_b32 m0, 40960
    s_nop 0
    buffer_load_dwordx4 v3, s[20:23], s29 offen offset:0 sc1 lds
    buffer_load_dwordx4 v3, s[20:23], s29 offen offset:1024 sc1 lds
    buffer_load_dwordx4 v3, s[20:23], s29 offen offset:2048 sc1 lds
    buffer_load_dwordx4 v3, s[20:23], s29 offen offset:3072 sc1 lds
    s_add_u32 s29, s29, 4096
    s_mov_b32 m0, 45056
    s_nop 0
    buffer_load_dwordx4 v3, s[20:23], s29 offen offset:0 sc1 lds
    buffer_load_dwordx4 v3, s[20:23], s29 offen offset:1024 sc1 lds
    buffer_load_dwordx4 v3, s[20:23], s29 offen offset:2048 sc1 lds
    buffer_load_dwordx4 v3, s[20:23], s29 offen offset:3072 sc1 lds
    s_add_u32 s29, s29, 4096
    s_mov_b32 m0, 49152
    s_nop 0
    buffer_load_dwordx4 v3, s[20:23], s29 offen offset:0 sc1 lds
    buffer_load_dwordx4 v3, s[20:23], s29 offen offset:1024 sc1 lds
    buffer_load_dwordx4 v3, s[20:23], s29 offen offset:2048 sc1 lds
    buffer_load_dwordx4 v3, s[20:23], s29 offen offset:3072 sc1 lds
    s_add_u32 s29, s29, 4096
    s_mov_b32 m0, 53248
    s_nop 0
    buffer_load_dwordx4 v3, s[20:23], s29 offen offset:0 sc1 lds
    buffer_load_dwordx4 v3, s[20:23], s29 offen offset:1024 sc1 lds
    buffer_load_dwordx4 v3, s[20:23], s29 offen offset:2048 sc1 lds
    buffer_load_dwordx4 v3, s[20:23], s29 offen offset:3072 sc1 lds
    s_add_u32 s29, s29, 4096
    s_mov_b32 m0, 57344
    s_nop 0
    buffer_load_dwordx4 v3, s[20:23], s29 offen offset:0 sc1 lds
    buffer_load_dwordx4 v3, s[20:23], s29 offen offset:1024 sc1 lds
    buffer_load_dwordx4 v3, s[20:23], s29 offen offset:2048 sc1 lds
    buffer_load_dwordx4 v3, s[20:23], s29 offen offset:3072 sc1 lds
    s_waitcnt vmcnt(26)
    s_mov_b64 exec, 1
    buffer_store_dword v45, v44, s[20:23], s62 offen sc1
    s_mov_b64 exec, -1
    s_add_u32 s29, s29, 4096
    s_mov_b32 m0, 61440
    s_nop 0
    buffer_load_dwordx4 v3, s[20:23], s29 offen offset:0 sc1 lds
    buffer_load_dwordx4 v3, s[20:23], s29 offen offset:1024 sc1 lds
    buffer_load_dwordx4 v3, s[20:23], s29 offen offset:2048 sc1 lds
    buffer_load_dwordx4 v3, s[20:23], s29 offen offset:3072 sc1 lds
    s_add_u32 s29, s29, 4096
    s_mov_b32 m0, 65536
    s_nop 0
    buffer_load_dwordx4 v3, s[20:23], s29 offen offset:0 sc1 lds
    buffer_load_dwordx4 v3, s[20:23], s29 offen offset:1024 sc1 lds
    buffer_load_dwordx4 v3, s[20:23], s29 offen offset:2048 sc1 lds
    buffer_load_dwordx4 v3, s[20:23], s29 offen offset:3072 sc1 lds
    s_add_u32 s29, s29, 4096
    s_mov_b32 m0, 69632
    s_nop 0
    buffer_load_dwordx4 v3, s[20:23], s29 offen offset:0 sc1 lds
    buffer_load_dwordx4 v3, s[20:23], s29 offen offset:1024 sc1 lds
    buffer_load_dwordx4 v3, s[20:23], s29 offen offset:2048 sc1 lds
    buffer_load_dwordx4 v3, s[20:23], s29 offen offset:3072 sc1 lds
    s_branch L_nw2
L_nw1:
    s_waitcnt vmcnt(0)
    s_mov_b64 exec, 1
    buffer_store_dword v45, v44, s[20:23], s62 offen sc1
    s_mov_b64 exec, -1
L_nw2:
    v_cmp_ne_u32 vcc, 1, v5
    s_nop 1
    s_cmp_eq_u64 vcc, 0
    s_cbranch_scc0 L_spin_n1
L_back_n1:
    s_add_u32 s61, s26, 0
    buffer_load_dwordx4 a[0:3], v3, s[20:23], s61 offen offset:0 sc1
    s_waitcnt vmcnt(16)
    buffer_load_dwordx4 a[4:7], v59, s[20:23], s61 offen offset:0 sc1
    s_waitcnt vmcnt(16)
    buffer_load_dwordx4 a[8:11], v3, s[20:23], s61 offen offset:1024 sc1
    s_waitcnt vmcnt(16)
    buffer_load_dwordx4 a[12:15], v59, s[20:23], s61 offen offset:1024 sc1
    s_waitcnt vmcnt(16)
    s_add_u32 s61, s26, 4096
    buffer_load_dwordx4 a[40:43], v3, s[20:23], s61 offen offset:1024 sc1
    s_waitcnt vmcnt(16)
    buffer_load_dwordx4 a[44:47], v59, s[20:23], s61 offen offset:1024 sc1
    s_waitcnt vmcnt(16)
    buffer_load_dwordx4 a[48:51], v3, s[20:23], s61 offen offset:2048 sc1
    s_waitcnt vmcnt(16)
    buffer_load_dwordx4 a[52:55], v59, s[20:23], s61 offen offset:2048 sc1
    s_waitcnt vmcnt(16)
    s_add_u32 s61, s26, 8192
    buffer_load_dwordx4 a[72:75], v3, s[20:23], s61 offen offset:1024 sc1
    s_waitcnt vmcnt(16)
    buffer_load_dwordx4 a[76:79], v59, s[20:23], s61 offen offset:1024 sc1
    s_waitcnt vmcnt(16)
    buffer_load_dwordx4 a[80:83], v3, s[20:23], s61 offen offset:2048 sc1
    s_waitcnt vmcnt(16)
    buffer_load_dwordx4 a[84:87], v59, s[20:23], s61 offen offset:2048 sc1
    s_waitcnt vmcnt(16)
    s_add_u32 s61, s26, 12288
    buffer_load_dwordx4 a[112:115], v3, s[20:23], s61 offen offset:2048 sc1
    s_waitcnt vmcnt(16)
    buffer_load_dwordx4 a[116:119], v59, s[20:23], s61 offen offset:2048 sc1
    s_waitcnt vmcnt(16)
    buffer_load_dwordx4 a[120:123], v3, s[20:23], s61 offen offset:3072 sc1
    s_waitcnt vmcnt(16)
    buffer_load_dwordx4 a[124:127], v59, s[20:23], s61 offen offset:3072 sc1
    s_waitcnt vmcnt(16)
    s_add_u32 s61, s26, 16384
    buffer_load_dwordx4 a[144:147], v3, s[20:23], s61 offen offset:2048 sc1
    s_waitcnt vmcnt(16)
    buffer_load_dwordx4 a[148:151], v59, s[20:23], s61 offen offset:2048 sc1
    s_waitcnt vmcnt(16)
    buffer_load_dwordx4 a[152:155], v3, s[20:23], s61 offen offset:3072 sc1
    s_waitcnt vmcnt(16)
    buffer_load_dword v5, v51, s[20:23], s60 offen sc1
    s_waitcnt vmcnt(16)
    buffer_load_dwordx4 a[156:159], v59, s[20:23], s61 offen offset:3072 sc1
    s_waitcnt vmcnt(16)
    s_add_u32 s61, s26, 20480
    buffer_load_dwordx4 a[184:187], v3, s[20:23], s61 offen offset:3072 sc1
    s_waitcnt vmcnt(16)
    buffer_load_dwordx4 a[188:191], v59, s[20:23], s61 offen offset:3072 sc1
    s_waitcnt vmcnt(16)
    s_add_u32 s61, s26, 24576
    buffer_load_dwordx4 a[192:195], v3, s[20:23], s61 offen offset:0 sc1
    s_waitcnt vmcnt(16)
    buffer_load_dwordx4 a[196:199], v59, s[20:23], s61 offen offset:0 sc1
    s_waitcnt vmcnt(16)
    buffer_load_dwordx4 a[216:219], v3, s[20:23], s61 offen offset:3072 sc1
    s_waitcnt vmcnt(16)
    buffer_load_dwordx4 a[220:223], v59, s[20:23], s61 offen offset:3072 sc1
    s_waitcnt vmcnt(16)
    s_add_u32 s61, s26, 28672
    buffer_load_dwordx4 a[224:227], v3, s[20:23], s61 offen offset:0 sc1
    s_waitcnt vmcnt(16)
    buffer_load_dwordx4 a[228:231], v59, s[20:23], s61 offen offset:0 sc1
    s_waitcnt vmcnt(16)
    s_add_u32 s61, s26, 32768
    buffer_load_dwordx4 v[224:227], v3, s[20:23], s61 offen offset:0 sc1
    s_waitcnt vmcnt(16)
    buffer_load_dwordx4 v[228:231], v59, s[20:23], s61 offen offset:0 sc1
    s_waitcnt vmcnt(16)
    buffer_load_dwordx4 v[232:235], v3, s[20:23], s61 offen offset:1024 sc1
    s_waitcnt vmcnt(16)
    buffer_load_dwordx4 v[236:239], v59, s[20:23], s61 offen offset:1024 sc1
    s_waitcnt vmcnt(16)
    s_waitcnt vmcnt(13)
    v_cmp_ne_u32 vcc, 1, v5
    s_nop 1
    s_cmp_eq_u64 vcc, 0
    s_cbranch_scc0 L_spin_n2
L_back_n2:
    s_add_u32 s61, s26, 0
    buffer_load_dwordx4 a[16:19], v3, s[20:23], s61 offen offset:2048 sc1
    s_waitcnt vmcnt(16)
    buffer_load_dwordx4 a[20:23], v59, s[20:23], s61 offen offset:2048 sc1
    s_waitcnt vmcnt(16)
    s_add_u32 s61, s26, 4096
    buffer_load_dwordx4 a[56:59], v3, s[20:23], s61 offen offset:3072 sc1
    s_waitcnt vmcnt(16)
    buffer_load_dwordx4 a[60:63], v59, s[20:23], s61 offen offset:3072 sc1
    s_waitcnt vmcnt(16)
    s_add_u32 s61, s26, 8192
    buffer_load_dwordx4 a[88:91], v3, s[20:23], s61 offen offset:3072 sc1
    s_waitcnt vmcnt(16)
    buffer_load_dword v5, v51, s[20:23], s59 offen sc1
    s_waitcnt vmcnt(16)
    buffer_load_dwordx4 a[92:95], v59, s[20:23], s61 offen offset:3072 sc1
    s_waitcnt vmcnt(16)
    s_add_u32 s61, s26, 16384
    buffer_load_dwordx4 a[128:131], v3, s[20:23], s61 offen offset:0 sc1
    s_waitcnt vmcnt(16)
    buffer_load_dwordx4 a[132:135], v59, s[20:23], s61 offen offset:0 sc1
    s_waitcnt vmcnt(16)
    s_add_u32 s61, s26, 20480
    buffer_load_dwordx4 a[160:163], v3, s[20:23], s61 offen offset:0 sc1
    s_waitcnt vmcnt(16)
    buffer_load_dwordx4 a[164:167], v59, s[20:23], s61 offen offset:0 sc1
    s_waitcnt vmcnt(16)
    s_add_u32 s61, s26, 24576
    buffer_load_dwordx4 a[200:203], v3, s[20:23], s61 offen offset:1024 sc1
    s_waitcnt vmcnt(16)
    buffer_load_dwordx4 a[204:207], v59, s[20:23], s61 offen offset:1024 sc1
    s_waitcnt vmcnt(16)
    s_add_u32 s61, s26, 28672
    buffer_load_dwordx4 a[232:235], v3, s[20:23], s61 offen offset:1024 sc1
    s_waitcnt vmcnt(16)
    buffer_load_dwordx4 a[236:239], v59, s[20:23], s61 offen offset:1024 sc1
    s_waitcnt vmcnt(16)
    s_add_u32 s61, s26, 32768
    buffer_load_dwordx4 v[240:243], v3, s[20:23], s61 offen offset:2048 sc1
    s_waitcnt vmcnt(16)
    buffer_load_dwordx4 v[244:247], v59, s[20:23], s61 offen offset:2048 sc1
    s_waitcnt vmcnt(16)
    s_waitcnt vmcnt(11)
    v_cmp_ne_u32 vcc, 1, v5
    s_nop 1
    s_cmp_eq_u64 vcc, 0
    s_cbranch_scc0 L_spin_n3
L_back_n3:
    s_add_u32 s61, s26, 0
    buffer_load_dwordx4 a[24:27], v3, s[20:23], s61 offen offset:3072 sc1
    s_waitcnt vmcnt(16)
    buffer_load_dwordx4 a[28:31], v59, s[20:23], s61 offen offset:3072 sc1
    s_waitcnt vmcnt(16)
    s_add_u32 s61, s26, 4096
    buffer_load_dwordx4 a[32:35], v3, s[20:23], s61 offen offset:0 sc1
    s_waitcnt vmcnt(16)
    buffer_load_dwordx4 a[36:39], v59, s[20:23], s61 offen offset:0 sc1
    s_waitcnt vmcnt(16)
    s_add_u32 s61, s26, 8192
    buffer_load_dwordx4 a[64:67], v3, s[20:23], s61 offen offset:0 sc1
    s_waitcnt vmcnt(16)
    buffer_load_dwordx4 a[68:71], v59, s[20:23], s61 offen offset:0 sc1
    s_waitcnt vmcnt(16)
    s_add_u32 s61, s26, 12288
    buffer_load_dwordx4 a[96:99], v3, s[20:23], s61 offen offset:0 sc1
    s_waitcnt vmcnt(16)
    buffer_load_dwordx4 a[100:103], v59, s[20:23], s61 offen offset:0 sc1
    s_waitcnt vmcnt(16)
    buffer_load_dwordx4 a[104:107], v3, s[20:23], s61 offen offset:1024 sc1
    s_waitcnt vmcnt(16)
    buffer_load_dwordx4 a[108:111], v59, s[20:23], s61 offen offset:1024 sc1
    s_waitcnt vmcnt(16)
    s_add_u32 s61, s26, 16384
    buffer_load_dwordx4 a[136:139], v3, s[20:23], s61 offen offset:1024 sc1
    s_waitcnt vmcnt(16)
    buffer_load_dwordx4 a[140:143], v59, s[20:23], s61 offen offset:1024 sc1
    s_waitcnt vmcnt(16)
    s_add_u32 s61, s26, 20480
    buffer_load_dwordx4 a[168:171], v3, s[20:23], s61 offen offset:1024 sc1
    s_waitcnt vmcnt(16)
    buffer_load_dwordx4 a[172:175], v59, s[20:23], s61 offen offset:1024 sc1
    s_waitcnt vmcnt(16)
    buffer_load_dwordx4 a[176:179], v3, s[20:23], s61 offen offset:2048 sc1
    s_waitcnt vmcnt(16)
    buffer_load_dwordx4 a[180:183], v59, s[20:23], s61 offen offset:2048 sc1
    s_waitcnt vmcnt(16)
    s_add_u32 s61, s26, 24576
    buffer_load_dwordx4 a[208:211], v3, s[20:23], s61 offen offset:2048 sc1
    s_waitcnt vmcnt(16)
    buffer_load_dwordx4 a[212:215], v59, s[20:23], s61 offen offset:2048 sc1
    s_waitcnt vmcnt(16)
    s_add_u32 s61, s26, 28672
    buffer_load_dwordx4 a[240:243], v3, s[20:23], s61 offen offset:2048 sc1
    s_waitcnt vmcnt(16)
    buffer_load_dwordx4 a[244:247], v59, s[20:23], s61 offen offset:2048 sc1
    s_waitcnt vmcnt(16)
    buffer_load_dwordx4 a[248:251], v3, s[20:23], s61 offen offset:3072 sc1
    s_waitcnt vmcnt(16)
    buffer_load_dwordx4 a[252:255], v59, s[20:23], s61 offen offset:3072 sc1
    s_waitcnt vmcnt(16)
    s_add_u32 s61, s26, 32768
    buffer_load_dwordx4 v[248:251], v3, s[20:23], s61 offen offset:3072 sc1
    s_waitcnt vmcnt(16)
    buffer_load_dwordx4 v[252:255], v59, s[20:23], s61 offen offset:3072 sc1
    s_waitcnt vmcnt(16)
    s_cmp_lg_u32 s24, 3
    s_cbranch_scc1 L_nrdy
    buffer_load_dwordx4 v[4:7], v44, s[20:23], s58 offen sc1
    s_waitcnt vmcnt(0)
    v_and_b32 v4, v4, v5
    v_and_b32 v6, v6, v7
    v_and_b32 v4, v4, v6
    s_nop 0
    v_readfirstlane_b32 s57, v4
    s_nop 0
    s_cmp_eq_u32 s57, 1
    s_cbranch_scc0 L_spin_rd
L_back_rd:
L_nrdy:
    s_waitcnt vmcnt(0)
    s_branch L_join
L_conv:
    buffer_load_dword v5, v51, s[20:23], s63 offen sc1
    s_lshr_b32 s43, s40, 1
    s_lshl_b32 s43, s43, 2
    s_load_dword s56, s[6:7], s43
    ds_write_b64 v60, v[52:53] offset:16640
    ds_write_b128 v46, v[20:23] offset:17152
    ds_write_b128 v46, v[24:27] offset:18176
    ds_write_b128 v46, v[28:31] offset:19200
    ds_write_b128 v46, v[32:35] offset:20224
    v_accvgpr_read_b32 v64, a240
    v_accvgpr_read_b32 v65, a241
    v_accvgpr_read_b32 v66, a242
    v_accvgpr_read_b32 v67, a243
    v_accvgpr_read_b32 v72, a244
    v_accvgpr_read_b32 v73, a245
    v_accvgpr_read_b32 v74, a246
    v_accvgpr_read_b32 v75, a247
    v_accvgpr_read_b32 v80, a248
    v_accvgpr_read_b32 v81, a249
    v_accvgpr_read_b32 v82, a250
    v_accvgpr_read_b32 v83, a251
    v_accvgpr_read_b32 v88, a252
    v_accvgpr_read_b32 v89, a253
    v_accvgpr_read_b32 v90, a254
    v_accvgpr_read_b32 v91, a255
    v_mov_b32 v92, 0
    v_mov_b32 v93, 0
    v_mov_b32 v96, 0
    v_mov_b32 v97, 0
    v_mov_b32 v98, 0
    v_mov_b32 v99, 0
    v_mov_b32_dpp v68, v72 wave_rol:1 row_mask:0xf bank_mask:0xf
    v_mov_b32_dpp v69, v73 wave_rol:1 row_mask:0xf bank_mask:0xf
    v_mov_b32_dpp v76, v80 wave_rol:1 row_mask:0xf bank_mask:0xf
    v_mov_b32_dpp v77, v81 wave_rol:1 row_mask:0xf bank_mask:0xf
    v_mov_b32_dpp v84, v88 wave_rol:1 row_mask:0xf bank_mask:0xf
    v_mov_b32_dpp v85, v89 wave_rol:1 row_mask:0xf bank_mask:0xf
    v_mov_b32_dpp v100, v64 wave_shr:1 row_mask:0xf bank_mask:0xf bound_ctrl:0
    v_mov_b32_dpp v101, v65 wave_shr:1 row_mask:0xf bank_mask:0xf bound_ctrl:0
    v_mov_b32_dpp v68, v64 wave_shl:1 row_mask:0xf bank_mask:0xf
    v_mov_b32_dpp v69, v65 wave_shl:1 row_mask:0xf bank_mask:0xf
    v_mov_b32_dpp v76, v72 wave_shl:1 row_mask:0xf bank_mask:0xf
    v_mov_b32_dpp v77, v73 wave_shl:1 row_mask:0xf bank_mask:0xf
    v_mov_b32_dpp v84, v80 wave_shl:1 row_mask:0xf bank_mask:0xf
    v_mov_b32_dpp v85, v81 wave_shl:1 row_mask:0xf bank_mask:0xf
    v_mov_b32_dpp v92, v88 wave_shl:1 row_mask:0xf bank_mask:0xf
    v_mov_b32_dpp v93, v89 wave_shl:1 row_mask:0xf bank_mask:0xf
    v_mov_b32 v116, v65
    v_mov_b32 v117, v66
    v_mov_b32 v118, v67
    v_mov_b32 v119, v68
    v_alignbit_b32 v112, v65, v64, 16
    v_alignbit_b32 v113, v66, v65, 16
    v_alignbit_b32 v114, v67, v66, 16
    v_alignbit_b32 v115, v68, v67, 16
    v_alignbit_b32 v120, v66, v65, 16
    v_alignbit_b32 v121, v67, v66, 16
    v_alignbit_b32 v122, v68, v67, 16
    v_alignbit_b32 v123, v69, v68, 16
    ds_write_b128 v46, v[66:69] offset:12512
    ds_write_b128 v46, v[116:119] offset:4192
    ds_write_b128 v46, v[112:115] offset:32
    ds_write_b128 v46, v[120:123] offset:8352
    v_mov_b32 v128, v73
    v_mov_b32 v129, v74
    v_mov_b32 v130, v75
    v_mov_b32 v131, v76
    v_alignbit_b32 v124, v73, v72, 16
    v_alignbit_b32 v125, v74, v73, 16
    v_alignbit_b32 v126, v75, v74, 16
    v_alignbit_b32 v127, v76, v75, 16
    v_alignbit_b32 v132, v74, v73, 16
    v_alignbit_b32 v133, v75, v74, 16
    v_alignbit_b32 v134, v76, v75, 16
    v_alignbit_b32 v135, v77, v76, 16
    ds_write_b128 v46, v[74:77] offset:13536
    ds_write_b128 v46, v[128:131] offset:5216
    ds_write_b128 v46, v[124:127] offset:1056
    ds_write_b128 v46, v[132:135] offset:9376
    s_waitcnt vmcnt(5)
    s_mov_b64 exec, 1
    buffer_store_dword v45, v44, s[20:23], s62 offen sc1
    s_mov_b64 exec, -1
    s_add_u32 s62, s62, 16384
    v_mov_b32 v140, v81
    v_mov_b32 v141, v82
    v_mov_b32 v142, v83
    v_mov_b32 v143, v84
    v_alignbit_b32 v136, v81, v80, 16
    v_alignbit_b32 v137, v82, v81, 16
    v_alignbit_b32 v138, v83, v82, 16
    v_alignbit_b32 v139, v84, v83, 16
    v_alignbit_b32 v144, v82, v81, 16
    v_alignbit_b32 v145, v83, v82, 16
    v_alignbit_b32 v146, v84, v83, 16
    v_alignbit_b32 v147, v85, v84, 16
    ds_write_b128 v46, v[82:85] offset:14560
    ds_write_b128 v46, v[140:143] offset:6240
    ds_write_b128 v46, v[136:139] offset:2080
    ds_write_b128 v46, v[144:147] offset:10400
    v_mov_b32 v152, v89
    v_mov_b32 v153, v90
    v_mov_b32 v154, v91
    v_mov_b32 v155, v92
    v_alignbit_b32 v148, v89, v88, 16
    v_alignbit_b32 v149, v90, v89, 16
    v_alignbit_b32 v150, v91, v90, 16
    v_alignbit_b32 v151, v92, v91, 16
    v_alignbit_b32 v156, v90, v89, 16
    v_alignbit_b32 v157, v91, v90, 16
    v_alignbit_b32 v158, v92, v91, 16
    v_alignbit_b32 v159, v93, v92, 16
    ds_write_b128 v46, v[90:93] offset:15584
    ds_write_b128 v46, v[152:155] offset:7264
    ds_write_b128 v46, v[148:151] offset:3104
    ds_write_b128 v46, v[156:159] offset:11424
    v_mov_b32 v164, v97
    v_mov_b32 v165, v98
    v_mov_b32 v166, v99
    v_mov_b32 v167, v100
    v_alignbit_b32 v160, v97, v96, 16
    v_alignbit_b32 v161, v98, v97, 16
    v_alignbit_b32 v162, v99, v98, 16
    v_alignbit_b32 v163, v100, v99, 16
    v_alignbit_b32 v168, v98, v97, 16
    v_alignbit_b32 v169, v99, v98, 16
    v_alignbit_b32 v170, v100, v99, 16
    v_alignbit_b32 v171, v101, v100, 16
    s_mov_b64 exec, 3
    ds_write_b128 v46, v[98:101] offset:12480
    ds_write_b128 v46, v[164:167] offset:4160
    ds_write_b128 v46, v[160:163] offset:0
    ds_write_b128 v46, v[168:171] offset:8320
    s_mov_b64 exec, -1
    s_waitcnt lgkmcnt(0)
    ds_read_b64 v[64:65], v47 offset:0
    ds_read_b64 v[66:67], v47 offset:8
    ds_read_b128 v[96:99], v48 offset:448
    ds_read_b64 v[68:69], v47 offset:512
    ds_read_b64 v[70:71], v47 offset:520
    ds_read_b128 v[100:103], v48 offset:960
    ds_read_b64 v[72:73], v47 offset:1024
    ds_read_b64 v[74:75], v47 offset:1032
    ds_read_b128 v[104:107], v48 offset:1472
    ds_read_b64 v[76:77], v47 offset:1536
    ds_read_b64 v[78:79], v47 offset:1544
    ds_read_b128 v[108:111], v48 offset:1984
    ds_read_b64 v[80:81], v47 offset:2048
    ds_read_b64 v[82:83], v47 offset:2056
    ds_read_b128 v[112:115], v48 offset:2496
    ds_read_b64 v[84:85], v47 offset:2560
    ds_read_b64 v[86:87], v47 offset:2568
    ds_read_b128 v[116:119], v48 offset:3008
    ds_read_b64 v[88:89], v47 offset:3072
    ds_read_b64 v[90:91], v47 offset:3080
    ds_read_b128 v[120:123], v48 offset:3520
    ds_read_b64 v[92:93], v47 offset:3584
    ds_read_b64 v[94:95], v47 offset:3592
    ds_read_b128 v[124:127], v48 offset:4032
    s_waitcnt lgkmcnt(15)
    v_mfma_f32_16x16x32_bf16 v[128:131], v[64:67], v[96:99], 0
    ds_read_b64 v[160:161], v47 offset:64
    v_mfma_f32_16x16x32_bf16 v[132:135], v[64:67], v[100:103], 0
    ds_read_b64 v[162:163], v47 offset:72
    v_mfma_f32_16x16x32_bf16 v[132:135], v[68:71], v[96:99], v[132:135]
    ds_read_b128 v[192:195], v48 offset:384
    v_mfma_f32_16x16x32_bf16 v[136:139], v[68:71], v[100:103], 0
    v_mfma_f32_16x16x32_bf16 v[136:139], v[64:67], v[104:107], v[136:139]
    ds_read_b64 v[164:165], v47 offset:576
    v_mfma_f32_16x16x32_bf16 v[140:143], v[68:71], v[104:107], 0
    ds_read_b64 v[166:167], v47 offset:584
    v_mfma_f32_16x16x32_bf16 v[136:139], v[72:75], v[96:99], v[136:139]
    ds_read_b128 v[196:199], v48 offset:896
    v_mfma_f32_16x16x32_bf16 v[140:143], v[72:75], v[100:103], v[140:143]
    v_mfma_f32_16x16x32_bf16 v[144:147], v[72:75], v[104:107], 0
    ds_read_b64 v[168:169], v47 offset:1088
    s_waitcnt lgkmcnt(15)
    v_mfma_f32_16x16x32_bf16 v[140:143], v[64:67], v[108:111], v[140:143]
    ds_read_b64 v[170:171], v47 offset:1096
    v_mfma_f32_16x16x32_bf16 v[144:147], v[68:71], v[108:111], v[144:147]
    ds_read_b128 v[200:203], v48 offset:1408
    v_mfma_f32_16x16x32_bf16 v[148:151], v[72:75], v[108:111], 0
    v_mfma_f32_16x16x32_bf16 v[140:143], v[76:79], v[96:99], v[140:143]
    ds_read_b64 v[172:173], v47 offset:1600
    v_mfma_f32_16x16x32_bf16 v[144:147], v[76:79], v[100:103], v[144:147]
    ds_read_b64 v[174:175], v47 offset:1608
    v_mfma_f32_16x16x32_bf16 v[148:151], v[76:79], v[104:107], v[148:151]
    ds_read_b128 v[204:207], v48 offset:1920
    v_mfma_f32_16x16x32_bf16 v[152:155], v[76:79], v[108:111], 0
    s_waitcnt vmcnt(1)
    s_mov_b64 exec, 1
    buffer_store_dword v45, v44, s[20:23], s62 offen sc1
    s_mov_b64 exec, -1
    v_cmp_ne_u32 vcc, 1, v5
    s_nop 1
    s_cmp_eq_u64 vcc, 0
    s_cbranch_scc0 L_spin_c1
L_back_c1:
    s_add_u32 s61, s26, 0
    v_mfma_f32_16x16x32_bf16 v[144:147], v[64:67], v[112:115], v[144:147]
    ds_read_b64 v[176:177], v47 offset:2112
    v_mfma_f32_16x16x32_bf16 v[148:151], v[68:71], v[112:115], v[148:151]
    ds_read_b64 v[178:179], v47 offset:2120
    v_mfma_f32_16x16x32_bf16 v[152:155], v[72:75], v[112:115], v[152:155]
    ds_read_b128 v[208:211], v48 offset:2432
    v_mfma_f32_16x16x32_bf16 v[156:159], v[76:79], v[112:115], 0
    buffer_load_dwordx4 a[0:3], v3, s[20:23], s61 offen offset:0 sc1
    v_mfma_f32_16x16x32_bf16 v[144:147], v[80:83], v[96:99], v[144:147]
    ds_read_b64 v[180:181], v47 offset:2624
    v_mfma_f32_16x16x32_bf16 v[148:151], v[80:83], v[100:103], v[148:151]
    ds_read_b64 v[182:183], v47 offset:2632
    v_mfma_f32_16x16x32_bf16 v[152:155], v[80:83], v[104:107], v[152:155]
    ds_read_b128 v[212:215], v48 offset:2944
    v_mfma_f32_16x16x32_bf16 v[156:159], v[80:83], v[108:111], v[156:159]
    buffer_load_dwordx4 a[4:7], v59, s[20:23], s61 offen offset:0 sc1
    s_waitcnt lgkmcnt(15)
    v_mfma_f32_16x16x32_bf16 v[148:151], v[64:67], v[116:119], v[148:151]
    ds_read_b64 v[184:185], v47 offset:3136
    v_mfma_f32_16x16x32_bf16 v[152:155], v[68:71], v[116:119], v[152:155]
    ds_read_b64 v[186:187], v47 offset:3144
    v_mfma_f32_16x16x32_bf16 v[156:159], v[72:75], v[116:119], v[156:159]
    ds_read_b128 v[216:219], v48 offset:3456
    v_mfma_f32_16x16x32_bf16 v[148:151], v[84:87], v[96:99], v[148:151]
    buffer_load_dwordx4 a[8:11], v3, s[20:23], s61 offen offset:1024 sc1
    v_mfma_f32_16x16x32_bf16 v[152:155], v[84:87], v[100:103], v[152:155]
    ds_read_b64 v[188:189], v47 offset:3648
    v_mfma_f32_16x16x32_bf16 v[156:159], v[84:87], v[104:107], v[156:159]
    ds_read_b64 v[190:191], v47 offset:3656
    v_mfma_f32_16x16x32_bf16 v[152:155], v[64:67], v[120:123], v[152:155]
    ds_read_b128 v[220:223], v48 offset:3968
    v_mfma_f32_16x16x32_bf16 v[156:159], v[68:71], v[120:123], v[156:159]
    buffer_load_dwordx4 a[12:15], v59, s[20:23], s61 offen offset:1024 sc1
    s_add_u32 s61, s26, 4096
    v_mfma_f32_16x16x32_bf16 v[152:155], v[88:91], v[96:99], v[152:155]
    v_mfma_f32_16x16x32_bf16 v[156:159], v[88:91], v[100:103], v[156:159]
    v_mfma_f32_16x16x32_bf16 v[156:159], v[64:67], v[124:127], v[156:159]
    v_mfma_f32_16x16x32_bf16 v[156:159], v[92:95], v[96:99], v[156:159]
    buffer_load_dwordx4 a[40:43], v3, s[20:23], s61 offen offset:1024 sc1
    v_mfma_f32_16x16x32_bf16 v[128:131], v[160:163], v[192:195], v[128:131]
    ds_read_b64 v[64:65], v47 offset:128
    s_waitcnt lgkmcnt(15)
    v_mfma_f32_16x16x32_bf16 v[132:135], v[160:163], v[196:199], v[132:135]
    ds_read_b64 v[66:67], v47 offset:136
    v_mfma_f32_16x16x32_bf16 v[132:135], v[164:167], v[192:195], v[132:135]
    ds_read_b128 v[96:99], v48 offset:320
    v_mfma_f32_16x16x32_bf16 v[136:139], v[164:167], v[196:199], v[136:139]
    buffer_load_dwordx4 a[44:47], v59, s[20:23], s61 offen offset:1024 sc1
    v_mfma_f32_16x16x32_bf16 v[136:139], v[160:163], v[200:203], v[136:139]
    ds_read_b64 v[68:69], v47 offset:640
    v_mfma_f32_16x16x32_bf16 v[140:143], v[164:167], v[200:203], v[140:143]
    ds_read_b64 v[70:71], v47 offset:648
    v_mfma_f32_16x16x32_bf16 v[136:139], v[168:171], v[192:195], v[136:139]
    ds_read_b128 v[100:103], v48 offset:832
    v_mfma_f32_16x16x32_bf16 v[140:143], v[168:171], v[196:199], v[140:143]
    buffer_load_dwordx4 a[48:51], v3, s[20:23], s61 offen offset:2048 sc1
    v_mfma_f32_16x16x32_bf16 v[144:147], v[168:171], v[200:203], v[144:147]
    ds_read_b64 v[72:73], v47 offset:1152
    s_waitcnt lgkmcnt(15)
    v_mfma_f32_16x16x32_bf16 v[140:143], v[160:163], v[204:207], v[140:143]
    ds_read_b64 v[74:75], v47 offset:1160
    v_mfma_f32_16x16x32_bf16 v[144:147], v[164:167], v[204:207], v[144:147]
    ds_read_b128 v[104:107], v48 offset:1344
    v_mfma_f32_16x16x32_bf16 v[148:151], v[168:171], v[204:207], v[148:151]
    buffer_load_dwordx4 a[52:55], v59, s[20:23], s61 offen offset:2048 sc1
    s_add_u32 s61, s26, 8192
    v_mfma_f32_16x16x32_bf16 v[140:143], v[172:175], v[192:195], v[140:143]
    ds_read_b64 v[76:77], v47 offset:1664
    v_mfma_f32_16x16x32_bf16 v[144:147], v[172:175], v[196:199], v[144:147]
    ds_read_b64 v[78:79], v47 offset:1672
    v_mfma_f32_16x16x32_bf16 v[148:151], v[172:175], v[200:203], v[148:151]
    ds_read_b128 v[108:111], v48 offset:1856
    v_mfma_f32_16x16x32_bf16 v[152:155], v[172:175], v[204:207], v[152:155]
    buffer_load_dwordx4 a[72:75], v3, s[20:23], s61 offen offset:1024 sc1
    v_mfma_f32_16x16x32_bf16 v[144:147], v[160:163], v[208:211], v[144:147]
    ds_read_b64 v[80:81], v47 offset:2176
    v_mfma_f32_16x16x32_bf16 v[148:151], v[164:167], v[208:211], v[148:151]
    ds_read_b64 v[82:83], v47 offset:2184
    v_mfma_f32_16x16x32_bf16 v[152:155], v[168:171], v[208:211], v[152:155]
    ds_read_b128 v[112:115], v48 offset:2368
    v_mfma_f32_16x16x32_bf16 v[156:159], v[172:175], v[208:211], v[156:159]
    buffer_load_dwordx4 a[76:79], v59, s[20:23], s61 offen offset:1024 sc1
    v_mfma_f32_16x16x32_bf16 v[144:147], v[176:179], v[192:195], v[144:147]
    ds_read_b64 v[84:85], v47 offset:2688
    v_mfma_f32_16x16x32_bf16 v[148:151], v[176:179], v[196:199], v[148:151]
    ds_read_b64 v[86:87], v47 offset:2696
    v_mfma_f32_16x16x32_bf16 v[152:155], v[176:179], v[200:203], v[152:155]
    ds_read_b128 v[116:119], v48 offset:2880
    v_mfma_f32_16x16x32_bf16 v[156:159], v[176:179], v[204:207], v[156:159]
    buffer_load_dwordx4 a[80:83], v3, s[20:23], s61 offen offset:2048 sc1
    s_waitcnt lgkmcnt(15)
    v_mfma_f32_16x16x32_bf16 v[148:151], v[160:163], v[212:215], v[148:151]
    ds_read_b64 v[88:89], v47 offset:3200
    v_mfma_f32_16x16x32_bf16 v[152:155], v[164:167], v[212:215], v[152:155]
    ds_read_b64 v[90:91], v47 offset:3208
    v_mfma_f32_16x16x32_bf16 v[156:159], v[168:171], v[212:215], v[156:159]
    ds_read_b128 v[120:123], v48 offset:3392
    v_mfma_f32_16x16x32_bf16 v[148:151], v[180:183], v[192:195], v[148:151]
    buffer_load_dwordx4 a[84:87], v59, s[20:23], s61 offen offset:2048 sc1
    s_add_u32 s61, s26, 12288
    v_mfma_f32_16x16x32_bf16 v[152:155], v[180:183], v[196:199], v[152:155]
    ds_read_b64 v[92:93], v47 offset:3712
    v_mfma_f32_16x16x32_bf16 v[156:159], v[180:183], v[200:203], v[156:159]
    ds_read_b64 v[94:95], v47 offset:3720
    v_mfma_f32_16x16x32_bf16 v[152:155], v[160:163], v[216:219], v[152:155]
    ds_read_b128 v[124:127], v48 offset:3904
    v_mfma_f32_16x16x32_bf16 v[156:159], v[164:167], v[216:219], v[156:159]
    buffer_load_dwordx4 a[112:115], v3, s[20:23], s61 offen offset:2048 sc1
    v_mfma_f32_16x16x32_bf16 v[152:155], v[184:187], v[192:195], v[152:155]
    v_mfma_f32_16x16x32_bf16 v[156:159], v[184:187], v[196:199], v[156:159]
    v_mfma_f32_16x16x32_bf16 v[156:159], v[160:163], v[220:223], v[156:159]
    v_mfma_f32_16x16x32_bf16 v[156:159], v[188:191], v[192:195], v[156:159]
    buffer_load_dwordx4 a[116:119], v59, s[20:23], s61 offen offset:2048 sc1
    v_mfma_f32_16x16x32_bf16 v[128:131], v[64:67], v[96:99], v[128:131]
    ds_read_b64 v[160:161], v47 offset:192
    s_waitcnt lgkmcnt(15)
    v_mfma_f32_16x16x32_bf16 v[132:135], v[64:67], v[100:103], v[132:135]
    ds_read_b64 v[162:163], v47 offset:200
    v_mfma_f32_16x16x32_bf16 v[132:135], v[68:71], v[96:99], v[132:135]
    ds_read_b128 v[192:195], v48 offset:256
    v_mfma_f32_16x16x32_bf16 v[136:139], v[68:71], v[100:103], v[136:139]
    buffer_load_dwordx4 a[120:123], v3, s[20:23], s61 offen offset:3072 sc1
    v_mfma_f32_16x16x32_bf16 v[136:139], v[64:67], v[104:107], v[136:139]
    ds_read_b64 v[164:165], v47 offset:704
    v_mfma_f32_16x16x32_bf16 v[140:143], v[68:71], v[104:107], v[140:143]
    ds_read_b64 v[166:167], v47 offset:712
    v_mfma_f32_16x16x32_bf16 v[136:139], v[72:75], v[96:99], v[136:139]
    ds_read_b128 v[196:199], v48 offset:768
    v_mfma_f32_16x16x32_bf16 v[140:143], v[72:75], v[100:103], v[140:143]
    buffer_load_dwordx4 a[124:127], v59, s[20:23], s61 offen offset:3072 sc1
    s_add_u32 s61, s26, 16384
    v_mfma_f32_16x16x32_bf16 v[144:147], v[72:75], v[104:107], v[144:147]
    ds_read_b64 v[168:169], v47 offset:1216
    s_waitcnt lgkmcnt(15)
    v_mfma_f32_16x16x32_bf16 v[140:143], v[64:67], v[108:111], v[140:143]
    ds_read_b64 v[170:171], v47 offset:1224
    v_mfma_f32_16x16x32_bf16 v[144:147], v[68:71], v[108:111], v[144:147]
    ds_read_b128 v[200:203], v48 offset:1280
    v_mfma_f32_16x16x32_bf16 v[148:151], v[72:75], v[108:111], v[148:151]
    buffer_load_dwordx4 a[144:147], v3, s[20:23], s61 offen offset:2048 sc1
    v_mfma_f32_16x16x32_bf16 v[140:143], v[76:79], v[96:99], v[140:143]
    ds_read_b64 v[172:173], v47 offset:1728
    v_mfma_f32_16x16x32_bf16 v[144:147], v[76:79], v[100:103], v[144:147]
    ds_read_b64 v[174:175], v47 offset:1736
    v_mfma_f32_16x16x32_bf16 v[148:151], v[76:79], v[104:107], v[148:151]
    ds_read_b128 v[204:207], v48 offset:1792
    v_mfma_f32_16x16x32_bf16 v[152:155], v[76:79], v[108:111], v[152:155]
    buffer_load_dwordx4 a[148:151], v59, s[20:23], s61 offen offset:2048 sc1
    v_mfma_f32_16x16x32_bf16 v[144:147], v[64:67], v[112:115], v[144:147]
    ds_read_b64 v[176:177], v47 offset:2240
    v_mfma_f32_16x16x32_bf16 v[148:151], v[68:71], v[112:115], v[148:151]
    ds_read_b64 v[178:179], v47 offset:2248
    v_mfma_f32_16x16x32_bf16 v[152:155], v[72:75], v[112:115], v[152:155]
    ds_read_b128 v[208:211], v48 offset:2304
    v_mfma_f32_16x16x32_bf16 v[156:159], v[76:79], v[112:115], v[156:159]
    buffer_load_dwordx4 a[152:155], v3, s[20:23], s61 offen offset:3072 sc1
    v_mfma_f32_16x16x32_bf16 v[144:147], v[80:83], v[96:99], v[144:147]
    ds_read_b64 v[180:181], v47 offset:2752
    v_mfma_f32_16x16x32_bf16 v[148:151], v[80:83], v[100:103], v[148:151]
    ds_read_b64 v[182:183], v47 offset:2760
    v_mfma_f32_16x16x32_bf16 v[152:155], v[80:83], v[104:107], v[152:155]
    ds_read_b128 v[212:215], v48 offset:2816
    v_mfma_f32_16x16x32_bf16 v[156:159], v[80:83], v[108:111], v[156:159]
    buffer_load_dwordx4 a[156:159], v59, s[20:23], s61 offen offset:3072 sc1
    s_add_u32 s61, s26, 20480
    s_waitcnt lgkmcnt(15)
    v_mfma_f32_16x16x32_bf16 v[148:151], v[64:67], v[116:119], v[148:151]
    ds_read_b64 v[184:185], v47 offset:3264
    v_mfma_f32_16x16x32_bf16 v[152:155], v[68:71], v[116:119], v[152:155]
    ds_read_b64 v[186:187], v47 offset:3272
    v_mfma_f32_16x16x32_bf16 v[156:159], v[72:75], v[116:119], v[156:159]
    ds_read_b128 v[216:219], v48 offset:3328
    v_mfma_f32_16x16x32_bf16 v[148:151], v[84:87], v[96:99], v[148:151]
    buffer_load_dword v5, v51, s[20:23], s60 offen sc1
    buffer_load_dwordx4 a[184:187], v3, s[20:23], s61 offen offset:3072 sc1
    v_mfma_f32_16x16x32_bf16 v[152:155], v[84:87], v[100:103], v[152:155]
    ds_read_b64 v[188:189], v47 offset:3776
    v_mfma_f32_16x16x32_bf16 v[156:159], v[84:87], v[104:107], v[156:159]
    ds_read_b64 v[190:191], v47 offset:3784
    v_mfma_f32_16x16x32_bf16 v[152:155], v[64:67], v[120:123], v[152:155]
    ds_read_b128 v[220:223], v48 offset:3840
    v_mfma_f32_16x16x32_bf16 v[156:159], v[68:71], v[120:123], v[156:159]
    buffer_load_dwordx4 a[188:191], v59, s[20:23], s61 offen offset:3072 sc1
    s_add_u32 s61, s26, 24576
    v_mfma_f32_16x16x32_bf16 v[152:155], v[88:91], v[96:99], v[152:155]
    v_mfma_f32_16x16x32_bf16 v[156:159], v[88:91], v[100:103], v[156:159]
    v_mfma_f32_16x16x32_bf16 v[156:159], v[64:67], v[124:127], v[156:159]
    v_mfma_f32_16x16x32_bf16 v[156:159], v[92:95], v[96:99], v[156:159]
    buffer_load_dwordx4 a[192:195], v3, s[20:23], s61 offen offset:0 sc1
    v_mfma_f32_16x16x32_bf16 v[128:131], v[160:163], v[192:195], v[128:131]
    ds_read_b64 v[64:65], v47 offset:256
    s_waitcnt lgkmcnt(15)
    v_mfma_f32_16x16x32_bf16 v[132:135], v[160:163], v[196:199], v[132:135]
    ds_read_b64 v[66:67], v47 offset:264
    v_mfma_f32_16x16x32_bf16 v[132:135], v[164:167], v[192:195], v[132:135]
    ds_read_b128 v[96:99], v48 offset:192
    v_mfma_f32_16x16x32_bf16 v[136:139], v[164:167], v[196:199], v[136:139]
    buffer_load_dwordx4 a[196:199], v59, s[20:23], s61 offen offset:0 sc1
    v_mfma_f32_16x16x32_bf16 v[136:139], v[160:163], v[200:203], v[136:139]
    ds_read_b64 v[68:69], v47 offset:768
    v_mfma_f32_16x16x32_bf16 v[140:143], v[164:167], v[200:203], v[140:143]
    ds_read_b64 v[70:71], v47 offset:776
    v_mfma_f32_16x16x32_bf16 v[136:139], v[168:171], v[192:195], v[136:139]
    ds_read_b128 v[100:103], v48 offset:704
    v_mfma_f32_16x16x32_bf16 v[140:143], v[168:171], v[196:199], v[140:143]
    buffer_load_dwordx4 a[216:219], v3, s[20:23], s61 offen offset:3072 sc1
    v_mfma_f32_16x16x32_bf16 v[144:147], v[168:171], v[200:203], v[144:147]
    ds_read_b64 v[72:73], v47 offset:1280
    s_waitcnt lgkmcnt(15)
    v_mfma_f32_16x16x32_bf16 v[140:143], v[160:163], v[204:207], v[140:143]
    ds_read_b64 v[74:75], v47 offset:1288
    v_mfma_f32_16x16x32_bf16 v[144:147], v[164:167], v[204:207], v[144:147]
    ds_read_b128 v[104:107], v48 offset:1216
    v_mfma_f32_16x16x32_bf16 v[148:151], v[168:171], v[204:207], v[148:151]
    buffer_load_dwordx4 a[220:223], v59, s[20:23], s61 offen offset:3072 sc1
    s_add_u32 s61, s26, 28672
    v_mfma_f32_16x16x32_bf16 v[140:143], v[172:175], v[192:195], v[140:143]
    ds_read_b64 v[76:77], v47 offset:1792
    v_mfma_f32_16x16x32_bf16 v[144:147], v[172:175], v[196:199], v[144:147]
    ds_read_b64 v[78:79], v47 offset:1800
    v_mfma_f32_16x16x32_bf16 v[148:151], v[172:175], v[200:203], v[148:151]
    ds_read_b128 v[108:111], v48 offset:1728
    v_mfma_f32_16x16x32_bf16 v[152:155], v[172:175], v[204:207], v[152:155]
    buffer_load_dwordx4 a[224:227], v3, s[20:23], s61 offen offset:0 sc1
    v_mfma_f32_16x16x32_bf16 v[144:147], v[160:163], v[208:211], v[144:147]
    ds_read_b64 v[80:81], v47 offset:2304
    v_mfma_f32_16x16x32_bf16 v[148:151], v[164:167], v[208:211], v[148:151]
    ds_read_b64 v[82:83], v47 offset:2312
    v_mfma_f32_16x16x32_bf16 v[152:155], v[168:171], v[208:211], v[152:155]
    ds_read_b128 v[112:115], v48 offset:2240
    v_mfma_f32_16x16x32_bf16 v[156:159], v[172:175], v[208:211], v[156:159]
    buffer_load_dwordx4 a[228:231], v59, s[20:23], s61 offen offset:0 sc1
    s_add_u32 s61, s26, 32768
    v_mfma_f32_16x16x32_bf16 v[144:147], v[176:179], v[192:195], v[144:147]
    ds_read_b64 v[84:85], v47 offset:2816
    v_mfma_f32_16x16x32_bf16 v[148:151], v[176:179], v[196:199], v[148:151]
    ds_read_b64 v[86:87], v47 offset:2824
    v_mfma_f32_16x16x32_bf16 v[152:155], v[176:179], v[200:203], v[152:155]
    ds_read_b128 v[116:119], v48 offset:2752
    v_mfma_f32_16x16x32_bf16 v[156:159], v[176:179], v[204:207], v[156:159]
    buffer_load_dwordx4 v[224:227], v3, s[20:23], s61 offen offset:0 sc1
    s_waitcnt lgkmcnt(15)
    v_mfma_f32_16x16x32_bf16 v[148:151], v[160:163], v[212:215], v[148:151]
    ds_read_b64 v[88:89], v47 offset:3328
    v_mfma_f32_16x16x32_bf16 v[152:155], v[164:167], v[212:215], v[152:155]
    ds_read_b64 v[90:91], v47 offset:3336
    v_mfma_f32_16x16x32_bf16 v[156:159], v[168:171], v[212:215], v[156:159]
    ds_read_b128 v[120:123], v48 offset:3264
    v_mfma_f32_16x16x32_bf16 v[148:151], v[180:183], v[192:195], v[148:151]
    buffer_load_dwordx4 v[228:231], v59, s[20:23], s61 offen offset:0 sc1
    v_mfma_f32_16x16x32_bf16 v[152:155], v[180:183], v[196:199], v[152:155]
    ds_read_b64 v[92:93], v47 offset:3840
    v_mfma_f32_16x16x32_bf16 v[156:159], v[180:183], v[200:203], v[156:159]
    ds_read_b64 v[94:95], v47 offset:3848
    v_mfma_f32_16x16x32_bf16 v[152:155], v[160:163], v[216:219], v[152:155]
    ds_read_b128 v[124:127], v48 offset:3776
    v_mfma_f32_16x16x32_bf16 v[156:159], v[164:167], v[216:219], v[156:159]
    buffer_load_dwordx4 v[232:235], v3, s[20:23], s61 offen offset:1024 sc1
    v_mfma_f32_16x16x32_bf16 v[152:155], v[184:187], v[192:195], v[152:155]
    v_mfma_f32_16x16x32_bf16 v[156:159], v[184:187], v[196:199], v[156:159]
    v_mfma_f32_16x16x32_bf16 v[156:159], v[160:163], v[220:223], v[156:159]
    v_mfma_f32_16x16x32_bf16 v[156:159], v[188:191], v[192:195], v[156:159]
    buffer_load_dwordx4 v[236:239], v59, s[20:23], s61 offen offset:1024 sc1
    s_waitcnt vmcnt(12)
    v_cmp_ne_u32 vcc, 1, v5
    s_nop 1
    s_cmp_eq_u64 vcc, 0
    s_cbranch_scc0 L_spin_c2
L_back_c2:
    v_mfma_f32_16x16x32_bf16 v[128:131], v[64:67], v[96:99], v[128:131]
    ds_read_b64 v[160:161], v47 offset:320
    s_add_u32 s61, s26, 0
    s_waitcnt lgkmcnt(15)
    v_mfma_f32_16x16x32_bf16 v[132:135], v[64:67], v[100:103], v[132:135]
    ds_read_b64 v[162:163], v47 offset:328
    v_mfma_f32_16x16x32_bf16 v[132:135], v[68:71], v[96:99], v[132:135]
    ds_read_b128 v[192:195], v48 offset:128
    v_mfma_f32_16x16x32_bf16 v[136:139], v[68:71], v[100:103], v[136:139]
    buffer_load_dwordx4 a[16:19], v3, s[20:23], s61 offen offset:2048 sc1
    v_mfma_f32_16x16x32_bf16 v[136:139], v[64:67], v[104:107], v[136:139]
    ds_read_b64 v[164:165], v47 offset:832
    v_mfma_f32_16x16x32_bf16 v[140:143], v[68:71], v[104:107], v[140:143]
    ds_read_b64 v[166:167], v47 offset:840
    v_mfma_f32_16x16x32_bf16 v[136:139], v[72:75], v[96:99], v[136:139]
    ds_read_b128 v[196:199], v48 offset:640
    v_mfma_f32_16x16x32_bf16 v[140:143], v[72:75], v[100:103], v[140:143]
    buffer_load_dwordx4 a[20:23], v59, s[20:23], s61 offen offset:2048 sc1
    s_add_u32 s61, s26, 4096
    v_mfma_f32_16x16x32_bf16 v[144:147], v[72:75], v[104:107], v[144:147]
    ds_read_b64 v[168:169], v47 offset:1344
    s_waitcnt lgkmcnt(15)
    v_mfma_f32_16x16x32_bf16 v[140:143], v[64:67], v[108:111], v[140:143]
    ds_read_b64 v[170:171], v47 offset:1352
    v_mfma_f32_16x16x32_bf16 v[144:147], v[68:71], v[108:111], v[144:147]
    ds_read_b128 v[200:203], v48 offset:1152
    v_mfma_f32_16x16x32_bf16 v[148:151], v[72:75], v[108:111], v[148:151]
    buffer_load_dwordx4 a[56:59], v3, s[20:23], s61 offen offset:3072 sc1
    v_mfma_f32_16x16x32_bf16 v[140:143], v[76:79], v[96:99], v[140:143]
    ds_read_b64 v[172:173], v47 offset:1856
    v_mfma_f32_16x16x32_bf16 v[144:147], v[76:79], v[100:103], v[144:147]
    ds_read_b64 v[174:175], v47 offset:1864
    v_mfma_f32_16x16x32_bf16 v[148:151], v[76:79], v[104:107], v[148:151]
    ds_read_b128 v[204:207], v48 offset:1664
    v_mfma_f32_16x16x32_bf16 v[152:155], v[76:79], v[108:111], v[152:155]
    buffer_load_dwordx4 a[60:63], v59, s[20:23], s61 offen offset:3072 sc1
    s_add_u32 s61, s26, 8192
    v_mfma_f32_16x16x32_bf16 v[144:147], v[64:67], v[112:115], v[144:147]
    ds_read_b64 v[176:177], v47 offset:2368
    v_mfma_f32_16x16x32_bf16 v[148:151], v[68:71], v[112:115], v[148:151]
    ds_read_b64 v[178:179], v47 offset:2376
    v_mfma_f32_16x16x32_bf16 v[152:155], v[72:75], v[112:115], v[152:155]
    ds_read_b128 v[208:211], v48 offset:2176
    v_mfma_f32_16x16x32_bf16 v[156:159], v[76:79], v[112:115], v[156:159]
    buffer_load_dwordx4 a[88:91], v3, s[20:23], s61 offen offset:3072 sc1
    v_mfma_f32_16x16x32_bf16 v[144:147], v[80:83], v[96:99], v[144:147]
    ds_read_b64 v[180:181], v47 offset:2880
    v_mfma_f32_16x16x32_bf16 v[148:151], v[80:83], v[100:103], v[148:151]
    ds_read_b64 v[182:183], v47 offset:2888
    v_mfma_f32_16x16x32_bf16 v[152:155], v[80:83], v[104:107], v[152:155]
    ds_read_b128 v[212:215], v48 offset:2688
    v_mfma_f32_16x16x32_bf16 v[156:159], v[80:83], v[108:111], v[156:159]
    buffer_load_dwordx4 a[92:95], v59, s[20:23], s61 offen offset:3072 sc1
    s_add_u32 s61, s26, 16384
    s_waitcnt lgkmcnt(15)
    v_mfma_f32_16x16x32_bf16 v[148:151], v[64:67], v[116:119], v[148:151]
    ds_read_b64 v[184:185], v47 offset:3392
    v_mfma_f32_16x16x32_bf16 v[152:155], v[68:71], v[116:119], v[152:155]
    ds_read_b64 v[186:187], v47 offset:3400
    v_mfma_f32_16x16x32_bf16 v[156:159], v[72:75], v[116:119], v[156:159]
    ds_read_b128 v[216:219], v48 offset:3200
    v_mfma_f32_16x16x32_bf16 v[148:151], v[84:87], v[96:99], v[148:151]
    buffer_load_dword v5, v51, s[20:23], s59 offen sc1
    buffer_load_dwordx4 a[128:131], v3, s[20:23], s61 offen offset:0 sc1
    v_mfma_f32_16x16x32_bf16 v[152:155], v[84:87], v[100:103], v[152:155]
    ds_read_b64 v[188:189], v47 offset:3904
    v_mfma_f32_16x16x32_bf16 v[156:159], v[84:87], v[104:107], v[156:159]
    ds_read_b64 v[190:191], v47 offset:3912
    v_mfma_f32_16x16x32_bf16 v[152:155], v[64:67], v[120:123], v[152:155]
    ds_read_b128 v[220:223], v48 offset:3712
    v_mfma_f32_16x16x32_bf16 v[156:159], v[68:71], v[120:123], v[156:159]
    buffer_load_dwordx4 a[132:135], v59, s[20:23], s61 offen offset:0 sc1
    s_add_u32 s61, s26, 20480
    v_mfma_f32_16x16x32_bf16 v[152:155], v[88:91], v[96:99], v[152:155]
    v_mfma_f32_16x16x32_bf16 v[156:159], v[88:91], v[100:103], v[156:159]
    v_mfma_f32_16x16x32_bf16 v[156:159], v[64:67], v[124:127], v[156:159]
    v_mfma_f32_16x16x32_bf16 v[156:159], v[92:95], v[96:99], v[156:159]
    buffer_load_dwordx4 a[160:163], v3, s[20:23], s61 offen offset:0 sc1
    v_mfma_f32_16x16x32_bf16 v[128:131], v[160:163], v[192:195], v[128:131]
    ds_read_b64 v[64:65], v47 offset:384
    s_waitcnt lgkmcnt(15)
    v_mfma_f32_16x16x32_bf16 v[132:135], v[160:163], v[196:199], v[132:135]
    ds_read_b64 v[66:67], v47 offset:392
    v_mfma_f32_16x16x32_bf16 v[132:135], v[164:167], v[192:195], v[132:135]
    ds_read_b128 v[96:99], v48 offset:64
    v_mfma_f32_16x16x32_bf16 v[136:139], v[164:167], v[196:199], v[136:139]
    buffer_load_dwordx4 a[164:167], v59, s[20:23], s61 offen offset:0 sc1
    s_add_u32 s61, s26, 24576
    v_mfma_f32_16x16x32_bf16 v[136:139], v[160:163], v[200:203], v[136:139]
    ds_read_b64 v[68:69], v47 offset:896
    v_mfma_f32_16x16x32_bf16 v[140:143], v[164:167], v[200:203], v[140:143]
    ds_read_b64 v[70:71], v47 offset:904
    v_mfma_f32_16x16x32_bf16 v[136:139], v[168:171], v[192:195], v[136:139]
    ds_read_b128 v[100:103], v48 offset:576
    v_mfma_f32_16x16x32_bf16 v[140:143], v[168:171], v[196:199], v[140:143]
    buffer_load_dwordx4 a[200:203], v3, s[20:23], s61 offen offset:1024 sc1
    v_mfma_f32_16x16x32_bf16 v[144:147], v[168:171], v[200:203], v[144:147]
    ds_read_b64 v[72:73], v47 offset:1408
    s_waitcnt lgkmcnt(15)
    v_mfma_f32_16x16x32_bf16 v[140:143], v[160:163], v[204:207], v[140:143]
    ds_read_b64 v[74:75], v47 offset:1416
    v_mfma_f32_16x16x32_bf16 v[144:147], v[164:167], v[204:207], v[144:147]
    ds_read_b128 v[104:107], v48 offset:1088
    v_mfma_f32_16x16x32_bf16 v[148:151], v[168:171], v[204:207], v[148:151]
    buffer_load_dwordx4 a[204:207], v59, s[20:23], s61 offen offset:1024 sc1
    s_add_u32 s61, s26, 28672
    v_mfma_f32_16x16x32_bf16 v[140:143], v[172:175], v[192:195], v[140:143]
    ds_read_b64 v[76:77], v47 offset:1920
    v_mfma_f32_16x16x32_bf16 v[144:147], v[172:175], v[196:199], v[144:147]
    ds_read_b64 v[78:79], v47 offset:1928
    v_mfma_f32_16x16x32_bf16 v[148:151], v[172:175], v[200:203], v[148:151]
    ds_read_b128 v[108:111], v48 offset:1600
    v_mfma_f32_16x16x32_bf16 v[152:155], v[172:175], v[204:207], v[152:155]
    buffer_load_dwordx4 a[232:235], v3, s[20:23], s61 offen offset:1024 sc1
    v_mfma_f32_16x16x32_bf16 v[144:147], v[160:163], v[208:211], v[144:147]
    ds_read_b64 v[80:81], v47 offset:2432
    v_mfma_f32_16x16x32_bf16 v[148:151], v[164:167], v[208:211], v[148:151]
    ds_read_b64 v[82:83], v47 offset:2440
    v_mfma_f32_16x16x32_bf16 v[152:155], v[168:171], v[208:211], v[152:155]
    ds_read_b128 v[112:115], v48 offset:2112
    v_mfma_f32_16x16x32_bf16 v[156:159], v[172:175], v[208:211], v[156:159]
    buffer_load_dwordx4 a[236:239], v59, s[20:23], s61 offen offset:1024 sc1
    s_add_u32 s61, s26, 32768
    v_mfma_f32_16x16x32_bf16 v[144:147], v[176:179], v[192:195], v[144:147]
    ds_read_b64 v[84:85], v47 offset:2944
    v_mfma_f32_16x16x32_bf16 v[148:151], v[176:179], v[196:199], v[148:151]
    ds_read_b64 v[86:87], v47 offset:2952
    v_mfma_f32_16x16x32_bf16 v[152:155], v[176:179], v[200:203], v[152:155]
    ds_read_b128 v[116:119], v48 offset:2624
    v_mfma_f32_16x16x32_bf16 v[156:159], v[176:179], v[204:207], v[156:159]
    buffer_load_dwordx4 v[240:243], v3, s[20:23], s61 offen offset:2048 sc1
    s_waitcnt lgkmcnt(15)
    v_mfma_f32_16x16x32_bf16 v[148:151], v[160:163], v[212:215], v[148:151]
    ds_read_b64 v[88:89], v47 offset:3456
    v_mfma_f32_16x16x32_bf16 v[152:155], v[164:167], v[212:215], v[152:155]
    ds_read_b64 v[90:91], v47 offset:3464
    v_mfma_f32_16x16x32_bf16 v[156:159], v[168:171], v[212:215], v[156:159]
    ds_read_b128 v[120:123], v48 offset:3136
    v_mfma_f32_16x16x32_bf16 v[148:151], v[180:183], v[192:195], v[148:151]
    buffer_load_dwordx4 v[244:247], v59, s[20:23], s61 offen offset:2048 sc1
    v_mfma_f32_16x16x32_bf16 v[152:155], v[180:183], v[196:199], v[152:155]
    ds_read_b64 v[92:93], v47 offset:3968
    v_mfma_f32_16x16x32_bf16 v[156:159], v[180:183], v[200:203], v[156:159]
    ds_read_b64 v[94:95], v47 offset:3976
    v_mfma_f32_16x16x32_bf16 v[152:155], v[160:163], v[216:219], v[152:155]
    ds_read_b128 v[124:127], v48 offset:3648
    v_mfma_f32_16x16x32_bf16 v[156:159], v[164:167], v[216:219], v[156:159]
    v_mfma_f32_16x16x32_bf16 v[152:155], v[184:187], v[192:195], v[152:155]
    v_mfma_f32_16x16x32_bf16 v[156:159], v[184:187], v[196:199], v[156:159]
    v_mfma_f32_16x16x32_bf16 v[156:159], v[160:163], v[220:223], v[156:159]
    v_mfma_f32_16x16x32_bf16 v[156:159], v[188:191], v[192:195], v[156:159]
    s_waitcnt vmcnt(10)
    v_cmp_ne_u32 vcc, 1, v5
    s_nop 1
    s_cmp_eq_u64 vcc, 0
    s_cbranch_scc0 L_spin_c3
L_back_c3:
    v_mfma_f32_16x16x32_bf16 v[128:131], v[64:67], v[96:99], v[128:131]
    ds_read_b64 v[160:161], v47 offset:448
    s_add_u32 s61, s26, 0
    s_waitcnt lgkmcnt(15)
    v_mfma_f32_16x16x32_bf16 v[132:135], v[64:67], v[100:103], v[132:135]
    ds_read_b64 v[162:163], v47 offset:456
    v_mfma_f32_16x16x32_bf16 v[132:135], v[68:71], v[96:99], v[132:135]
    buffer_load_dwordx4 a[24:27], v3, s[20:23], s61 offen offset:3072 sc1
    v_mfma_f32_16x16x32_bf16 v[136:139], v[68:71], v[100:103], v[136:139]
    ds_read_b128 v[192:195], v48 offset:0
    v_mfma_f32_16x16x32_bf16 v[136:139], v[64:67], v[104:107], v[136:139]
    ds_read_b64 v[164:165], v47 offset:960
    v_mfma_f32_16x16x32_bf16 v[140:143], v[68:71], v[104:107], v[140:143]
    buffer_load_dwordx4 a[28:31], v59, s[20:23], s61 offen offset:3072 sc1
    s_add_u32 s61, s26, 4096
    v_mfma_f32_16x16x32_bf16 v[136:139], v[72:75], v[96:99], v[136:139]
    ds_read_b64 v[166:167], v47 offset:968
    v_mfma_f32_16x16x32_bf16 v[140:143], v[72:75], v[100:103], v[140:143]
    ds_read_b128 v[196:199], v48 offset:512
    v_mfma_f32_16x16x32_bf16 v[144:147], v[72:75], v[104:107], v[144:147]
    buffer_load_dwordx4 a[32:35], v3, s[20:23], s61 offen offset:0 sc1
    s_waitcnt lgkmcnt(15)
    v_mfma_f32_16x16x32_bf16 v[140:143], v[64:67], v[108:111], v[140:143]
    ds_read_b64 v[168:169], v47 offset:1472
    v_mfma_f32_16x16x32_bf16 v[144:147], v[68:71], v[108:111], v[144:147]
    ds_read_b64 v[170:171], v47 offset:1480
    v_mfma_f32_16x16x32_bf16 v[148:151], v[72:75], v[108:111], v[148:151]
    buffer_load_dwordx4 a[36:39], v59, s[20:23], s61 offen offset:0 sc1
    s_add_u32 s61, s26, 8192
    v_mfma_f32_16x16x32_bf16 v[140:143], v[76:79], v[96:99], v[140:143]
    ds_read_b128 v[200:203], v48 offset:1024
    v_mfma_f32_16x16x32_bf16 v[144:147], v[76:79], v[100:103], v[144:147]
    ds_read_b64 v[172:173], v47 offset:1984
    v_mfma_f32_16x16x32_bf16 v[148:151], v[76:79], v[104:107], v[148:151]
    buffer_load_dwordx4 a[64:67], v3, s[20:23], s61 offen offset:0 sc1
    v_mfma_f32_16x16x32_bf16 v[152:155], v[76:79], v[108:111], v[152:155]
    ds_read_b64 v[174:175], v47 offset:1992
    v_mfma_f32_16x16x32_bf16 v[144:147], v[64:67], v[112:115], v[144:147]
    ds_read_b128 v[204:207], v48 offset:1536
    v_mfma_f32_16x16x32_bf16 v[148:151], v[68:71], v[112:115], v[148:151]
    buffer_load_dwordx4 a[68:71], v59, s[20:23], s61 offen offset:0 sc1
    s_add_u32 s61, s26, 12288
    v_mfma_f32_16x16x32_bf16 v[152:155], v[72:75], v[112:115], v[152:155]
    ds_read_b64 v[176:177], v47 offset:2496
    v_mfma_f32_16x16x32_bf16 v[156:159], v[76:79], v[112:115], v[156:159]
    ds_read_b64 v[178:179], v47 offset:2504
    v_mfma_f32_16x16x32_bf16 v[144:147], v[80:83], v[96:99], v[144:147]
    buffer_load_dwordx4 a[96:99], v3, s[20:23], s61 offen offset:0 sc1
    v_mfma_f32_16x16x32_bf16 v[148:151], v[80:83], v[100:103], v[148:151]
    ds_read_b128 v[208:211], v48 offset:2048
    v_mfma_f32_16x16x32_bf16 v[152:155], v[80:83], v[104:107], v[152:155]
    ds_read_b64 v[180:181], v47 offset:3008
    v_mfma_f32_16x16x32_bf16 v[156:159], v[80:83], v[108:111], v[156:159]
    buffer_load_dwordx4 a[100:103], v59, s[20:23], s61 offen offset:0 sc1
    s_waitcnt lgkmcnt(15)
    v_mfma_f32_16x16x32_bf16 v[148:151], v[64:67], v[116:119], v[148:151]
    ds_read_b64 v[182:183], v47 offset:3016
    v_mfma_f32_16x16x32_bf16 v[152:155], v[68:71], v[116:119], v[152:155]
    ds_read_b128 v[212:215], v48 offset:2560
    v_mfma_f32_16x16x32_bf16 v[156:159], v[72:75], v[116:119], v[156:159]
    buffer_load_dwordx4 a[104:107], v3, s[20:23], s61 offen offset:1024 sc1
    v_mfma_f32_16x16x32_bf16 v[148:151], v[84:87], v[96:99], v[148:151]
    ds_read_b64 v[184:185], v47 offset:3520
    v_mfma_f32_16x16x32_bf16 v[152:155], v[84:87], v[100:103], v[152:155]
    ds_read_b64 v[186:187], v47 offset:3528
    v_mfma_f32_16x16x32_bf16 v[156:159], v[84:87], v[104:107], v[156:159]
    buffer_load_dwordx4 a[108:111], v59, s[20:23], s61 offen offset:1024 sc1
    s_add_u32 s61, s26, 16384
    v_mfma_f32_16x16x32_bf16 v[152:155], v[64:67], v[120:123], v[152:155]
    ds_read_b128 v[216:219], v48 offset:3072
    v_mfma_f32_16x16x32_bf16 v[156:159], v[68:71], v[120:123], v[156:159]
    ds_read_b64 v[188:189], v47 offset:4032
    v_mfma_f32_16x16x32_bf16 v[152:155], v[88:91], v[96:99], v[152:155]
    buffer_load_dwordx4 a[136:139], v3, s[20:23], s61 offen offset:1024 sc1
    v_mfma_f32_16x16x32_bf16 v[156:159], v[88:91], v[100:103], v[156:159]
    ds_read_b64 v[190:191], v47 offset:4040
    v_mfma_f32_16x16x32_bf16 v[156:159], v[64:67], v[124:127], v[156:159]
    ds_read_b128 v[220:223], v48 offset:3584
    v_mfma_f32_16x16x32_bf16 v[156:159], v[92:95], v[96:99], v[156:159]
    buffer_load_dwordx4 a[140:143], v59, s[20:23], s61 offen offset:1024 sc1
    s_add_u32 s61, s26, 20480
    s_waitcnt lgkmcnt(15)
    v_mfma_f32_16x16x32_bf16 v[128:131], v[160:163], v[192:195], v[128:131]
    ds_read_b64 v[20:21], v49 offset:0
    v_mfma_f32_16x16x32_bf16 v[132:135], v[160:163], v[196:199], v[132:135]
    ds_read_b64 v[22:23], v49 offset:512
    v_mfma_f32_16x16x32_bf16 v[132:135], v[164:167], v[192:195], v[132:135]
    buffer_load_dwordx4 a[168:171], v3, s[20:23], s61 offen offset:1024 sc1
    v_mfma_f32_16x16x32_bf16 v[136:139], v[164:167], v[196:199], v[136:139]
    ds_read_b64 v[24:25], v49 offset:1024
    v_mfma_f32_16x16x32_bf16 v[136:139], v[160:163], v[200:203], v[136:139]
    ds_read_b64 v[26:27], v49 offset:1536
    v_mfma_f32_16x16x32_bf16 v[140:143], v[164:167], v[200:203], v[140:143]
    buffer_load_dwordx4 a[172:175], v59, s[20:23], s61 offen offset:1024 sc1
    v_mfma_f32_16x16x32_bf16 v[136:139], v[168:171], v[192:195], v[136:139]
    ds_read_b64 v[28:29], v49 offset:2048
    v_mfma_f32_16x16x32_bf16 v[140:143], v[168:171], v[196:199], v[140:143]
    ds_read_b64 v[30:31], v49 offset:2560
    v_mfma_f32_16x16x32_bf16 v[144:147], v[168:171], v[200:203], v[144:147]
    buffer_load_dwordx4 a[176:179], v3, s[20:23], s61 offen offset:2048 sc1
    s_waitcnt lgkmcnt(15)
    v_mfma_f32_16x16x32_bf16 v[140:143], v[160:163], v[204:207], v[140:143]
    ds_read_b64 v[32:33], v49 offset:3072
    v_mfma_f32_16x16x32_bf16 v[144:147], v[164:167], v[204:207], v[144:147]
    ds_read_b64 v[34:35], v49 offset:3584
    v_mfma_f32_16x16x32_bf16 v[148:151], v[168:171], v[204:207], v[148:151]
    buffer_load_dwordx4 a[180:183], v59, s[20:23], s61 offen offset:2048 sc1
    s_add_u32 s61, s26, 24576
    v_mfma_f32_16x16x32_bf16 v[140:143], v[172:175], v[192:195], v[140:143]
    v_mfma_f32_16x16x32_bf16 v[144:147], v[172:175], v[196:199], v[144:147]
    v_mfma_f32_16x16x32_bf16 v[148:151], v[172:175], v[200:203], v[148:151]
    buffer_load_dwordx4 a[208:211], v3, s[20:23], s61 offen offset:2048 sc1
    v_mfma_f32_16x16x32_bf16 v[152:155], v[172:175], v[204:207], v[152:155]
    v_mfma_f32_16x16x32_bf16 v[144:147], v[160:163], v[208:211], v[144:147]
    s_waitcnt lgkmcnt(0)
    v_and_b32 v64, 0xffff0000, v21
    v_lshlrev_b32 v65, 16, v21
    v_mfma_f32_16x16x32_bf16 v[148:151], v[164:167], v[208:211], v[148:151]
    buffer_load_dwordx4 a[212:215], v59, s[20:23], s61 offen offset:2048 sc1
    s_add_u32 s61, s26, 28672
    v_mfma_f32_16x16x32_bf16 v[152:155], v[168:171], v[208:211], v[152:155]
    v_and_b32 v66, 0xffff0000, v20
    v_lshlrev_b32 v67, 16, v20
    v_mfma_f32_16x16x32_bf16 v[156:159], v[172:175], v[208:211], v[156:159]
    v_and_b32 v68, 0xffff0000, v23
    v_lshlrev_b32 v69, 16, v23
    v_mfma_f32_16x16x32_bf16 v[144:147], v[176:179], v[192:195], v[144:147]
    buffer_load_dwordx4 a[240:243], v3, s[20:23], s61 offen offset:2048 sc1
    v_mfma_f32_16x16x32_bf16 v[148:151], v[176:179], v[196:199], v[148:151]
    v_and_b32 v70, 0xffff0000, v22
    v_lshlrev_b32 v71, 16, v22
    v_mfma_f32_16x16x32_bf16 v[152:155], v[176:179], v[200:203], v[152:155]
    v_and_b32 v72, 0xffff0000, v25
    v_lshlrev_b32 v73, 16, v25
    v_mfma_f32_16x16x32_bf16 v[156:159], v[176:179], v[204:207], v[156:159]
    buffer_load_dwordx4 a[244:247], v59, s[20:23], s61 offen offset:2048 sc1
    v_mfma_f32_16x16x32_bf16 v[148:151], v[160:163], v[212:215], v[148:151]
    v_and_b32 v74, 0xffff0000, v24
    v_lshlrev_b32 v75, 16, v24
    v_mfma_f32_16x16x32_bf16 v[152:155], v[164:167], v[212:215], v[152:155]
    v_and_b32 v76, 0xffff0000, v27
    v_lshlrev_b32 v77, 16, v27
    v_mfma_f32_16x16x32_bf16 v[156:159], v[168:171], v[212:215], v[156:159]
    buffer_load_dwordx4 a[248:251], v3, s[20:23], s61 offen offset:3072 sc1
    v_mfma_f32_16x16x32_bf16 v[148:151], v[180:183], v[192:195], v[148:151]
    v_and_b32 v78, 0xffff0000, v26
    v_lshlrev_b32 v79, 16, v26
    v_mfma_f32_16x16x32_bf16 v[152:155], v[180:183], v[196:199], v[152:155]
    v_and_b32 v80, 0xffff0000, v29
    v_lshlrev_b32 v81, 16, v29
    v_mfma_f32_16x16x32_bf16 v[156:159], v[180:183], v[200:203], v[156:159]
    buffer_load_dwordx4 a[252:255], v59, s[20:23], s61 offen offset:3072 sc1
    s_add_u32 s61, s26, 32768
    v_mfma_f32_16x16x32_bf16 v[152:155], v[160:163], v[216:219], v[152:155]
    v_and_b32 v82, 0xffff0000, v28
    v_lshlrev_b32 v83, 16, v28
    v_mfma_f32_16x16x32_bf16 v[156:159], v[164:167], v[216:219], v[156:159]
    v_and_b32 v84, 0xffff0000, v31
    v_lshlrev_b32 v85, 16, v31
    v_mfma_f32_16x16x32_bf16 v[152:155], v[184:187], v[192:195], v[152:155]
    buffer_load_dwordx4 v[248:251], v3, s[20:23], s61 offen offset:3072 sc1
    v_mfma_f32_16x16x32_bf16 v[156:159], v[184:187], v[196:199], v[156:159]
    v_and_b32 v86, 0xffff0000, v30
    v_lshlrev_b32 v87, 16, v30
    v_mfma_f32_16x16x32_bf16 v[156:159], v[160:163], v[220:223], v[156:159]
    v_and_b32 v88, 0xffff0000, v33
    v_lshlrev_b32 v89, 16, v33
    v_mfma_f32_16x16x32_bf16 v[156:159], v[188:191], v[192:195], v[156:159]
    buffer_load_dwordx4 v[252:255], v59, s[20:23], s61 offen offset:3072 sc1
    v_and_b32 v90, 0xffff0000, v32
    v_lshlrev_b32 v91, 16, v32
    v_and_b32 v92, 0xffff0000, v35
    v_lshlrev_b32 v93, 16, v35
    v_and_b32 v94, 0xffff0000, v34
    v_lshlrev_b32 v95, 16, v34
    s_and_b32 s43, s40, 1
    s_lshl_b32 s58, s56, 16
    s_and_b32 s57, s56, 0xffff0000
    s_cmp_eq_u32 s43, 0
    s_cselect_b32 s56, s58, s57
    s_add_u32 s42, s42, 22413312
    s_nop 3
    v_pk_fma_f32 v[128:129], v[64:65], s[56:57], v[128:129] op_sel_hi:[1,0,1]
    v_pk_fma_f32 v[130:131], v[66:67], s[56:57], v[130:131] op_sel_hi:[1,0,1]
    v_cvt_pk_bf16_f32 v128, v128, v129
    v_cvt_pk_bf16_f32 v129, v130, v131
    ds_write_b64 v62, v[128:129] offset:0
    v_pk_fma_f32 v[132:133], v[68:69], s[56:57], v[132:133] op_sel_hi:[1,0,1]
    v_pk_fma_f32 v[134:135], v[70:71], s[56:57], v[134:135] op_sel_hi:[1,0,1]
    v_cvt_pk_bf16_f32 v132, v132, v133
    v_cvt_pk_bf16_f32 v133, v134, v135
    ds_write_b64 v62, v[132:133] offset:512
    v_pk_fma_f32 v[136:137], v[72:73], s[56:57], v[136:137] op_sel_hi:[1,0,1]
    v_pk_fma_f32 v[138:139], v[74:75], s[56:57], v[138:139] op_sel_hi:[1,0,1]
    v_cvt_pk_bf16_f32 v136, v136, v137
    v_cvt_pk_bf16_f32 v137, v138, v139
    ds_write_b64 v62, v[136:137] offset:1024
    v_pk_fma_f32 v[140:141], v[76:77], s[56:57], v[140:141] op_sel_hi:[1,0,1]
    v_pk_fma_f32 v[142:143], v[78:79], s[56:57], v[142:143] op_sel_hi:[1,0,1]
    v_cvt_pk_bf16_f32 v140, v140, v141
    v_cvt_pk_bf16_f32 v141, v142, v143
    ds_write_b64 v62, v[140:141] offset:1536
    v_pk_fma_f32 v[144:145], v[80:81], s[56:57], v[144:145] op_sel_hi:[1,0,1]
    v_pk_fma_f32 v[146:147], v[82:83], s[56:57], v[146:147] op_sel_hi:[1,0,1]
    v_cvt_pk_bf16_f32 v144, v144, v145
    v_cvt_pk_bf16_f32 v145, v146, v147
    ds_write_b64 v62, v[144:145] offset:2048
    v_pk_fma_f32 v[148:149], v[84:85], s[56:57], v[148:149] op_sel_hi:[1,0,1]
    v_pk_fma_f32 v[150:151], v[86:87], s[56:57], v[150:151] op_sel_hi:[1,0,1]
    v_cvt_pk_bf16_f32 v148, v148, v149
    v_cvt_pk_bf16_f32 v149, v150, v151
    ds_write_b64 v62, v[148:149] offset:2560
    v_pk_fma_f32 v[152:153], v[88:89], s[56:57], v[152:153] op_sel_hi:[1,0,1]
    v_pk_fma_f32 v[154:155], v[90:91], s[56:57], v[154:155] op_sel_hi:[1,0,1]
    v_cvt_pk_bf16_f32 v152, v152, v153
    v_cvt_pk_bf16_f32 v153, v154, v155
    ds_write_b64 v62, v[152:153] offset:3072
    v_pk_fma_f32 v[156:157], v[92:93], s[56:57], v[156:157] op_sel_hi:[1,0,1]
    v_pk_fma_f32 v[158:159], v[94:95], s[56:57], v[158:159] op_sel_hi:[1,0,1]
    v_cvt_pk_bf16_f32 v156, v156, v157
    v_cvt_pk_bf16_f32 v157, v158, v159
    ds_write_b64 v62, v[156:157] offset:3584
    s_waitcnt lgkmcnt(0)
    ds_read_b128 v[96:99], v46 offset:0
    ds_read_b128 v[100:103], v46 offset:1024
    ds_read_b128 v[104:107], v46 offset:2048
    ds_read_b128 v[108:111], v46 offset:3072
    s_waitcnt lgkmcnt(3)
    buffer_store_dwordx4 v[96:99], v3, s[20:23], s42 offen offset:0 sc1
    s_waitcnt lgkmcnt(2)
    buffer_store_dwordx4 v[100:103], v3, s[20:23], s42 offen offset:1024 sc1
    s_waitcnt lgkmcnt(1)
    buffer_store_dwordx4 v[104:107], v3, s[20:23], s42 offen offset:2048 sc1
    s_waitcnt lgkmcnt(0)
    buffer_store_dwordx4 v[108:111], v3, s[20:23], s42 offen offset:3072 sc1
    s_waitcnt vmcnt(4)
L_join:
    v_mov_b32 v7, 1
    v_mov_b32 v8, 0
    s_lshr_b32 s39, s40, 3
    s_lshl_b32 s39, s39, 7
    s_and_b32 s38, s40, 7
    s_lshl_b32 s38, s38, 2
    s_add_u32 s39, s39, s38
    s_add_u32 s39, s39, 24838144
    s_cmp_lt_u32 s40, 576
    s_cselect_b32 s39, s39, 2147483632
    v_add_u32 v212, 0, v3
    v_add_u32 v213, 36864, v3
    v_add_u32 v214, 73728, v3
    s_barrier
    ds_read_b128 v[48:51], v212 offset:0
    ds_read_b128 v[52:55], v212 offset:1024
    ds_read_b128 v[56:59], v212 offset:2048
    ds_read_b128 v[60:63], v212 offset:3072
    ds_read_b128 v[64:67], v212 offset:4096
    ds_read_b128 v[68:71], v212 offset:5120
    s_waitcnt lgkmcnt(4)
    v_mfma_f32_16x16x32_bf16 v[16:19], v[48:51], a[0:3], 0
    ds_read_b128 v[72:75], v212 offset:6144
    s_add_u32 s29, s36, 1
    v_mfma_f32_16x16x32_bf16 v[16:19], v[52:55], a[8:11], v[16:19]
    s_and_b32 s29, s29, 3
    s_lshl_b32 s29, s29, 1
    s_add_u32 s29, s29, 1
    v_mfma_f32_16x16x32_bf16 v[20:23], v[48:51], a[4:7], 0
    ds_read_b128 v[76:79], v212 offset:7168
    s_mul_i32 s29, s29, 148480
    v_mfma_f32_16x16x32_bf16 v[20:23], v[52:55], a[12:15], v[20:23]
    s_waitcnt lgkmcnt(4)
    s_add_u32 s29, s29, s27
    s_add_u32 m0, s30, 73728
    v_mfma_f32_16x16x32_bf16 v[16:19], v[56:59], a[16:19], v[16:19]
    ds_read_b128 v[48:51], v212 offset:8192
    s_lshl_b32 s38, s24, 10
    v_mfma_f32_16x16x32_bf16 v[16:19], v[60:63], a[24:27], v[16:19]
    buffer_load_dwordx4 v3, s[20:23], s29 offen offset:0 sc1 lds
    v_add_u32 v6, s38, v3
    v_mfma_f32_16x16x32_bf16 v[20:23], v[56:59], a[20:23], v[20:23]
    ds_read_b128 v[52:55], v212 offset:9216
    s_mul_i32 s31, s34, 152576
    v_mfma_f32_16x16x32_bf16 v[20:23], v[60:63], a[28:31], v[20:23]
    s_waitcnt lgkmcnt(4)
    buffer_load_dwordx4 v3, s[20:23], s29 offen offset:1024 sc1 lds
    v_mfma_f32_16x16x32_bf16 v[16:19], v[64:67], a[32:35], v[16:19]
    ds_read_b128 v[56:59], v212 offset:10240
    s_add_u32 s31, s31, 31457280
    v_mfma_f32_16x16x32_bf16 v[16:19], v[68:71], a[40:43], v[16:19]
    s_lshl_b32 s25, s34, 8
    s_lshl_b32 s38, s24, 4
    s_add_u32 s25, s25, s38
    v_mfma_f32_16x16x32_bf16 v[20:23], v[64:67], a[36:39], v[20:23]
    ds_read_b128 v[60:63], v212 offset:11264
    s_add_u32 s25, s25, 24848384
    v_mfma_f32_16x16x32_bf16 v[20:23], v[68:71], a[44:47], v[20:23]
    s_waitcnt lgkmcnt(4)
    buffer_load_dwordx4 v3, s[20:23], s29 offen offset:2048 sc1 lds
    v_mfma_f32_16x16x32_bf16 v[16:19], v[72:75], a[48:51], v[16:19]
    ds_read_b128 v[64:67], v212 offset:12288
    s_lshl_b32 s47, s36, 6
    v_mfma_f32_16x16x32_bf16 v[16:19], v[76:79], a[56:59], v[16:19]
    s_add_u32 s47, s47, s25
    v_and_b32 v9, 15, v2
    v_lshrrev_b32 v10, 4, v2
    v_mfma_f32_16x16x32_bf16 v[20:23], v[72:75], a[52:55], v[20:23]
    ds_read_b128 v[68:71], v212 offset:13312
    s_mul_i32 s48, s37, 16*1152
    v_mfma_f32_16x16x32_bf16 v[20:23], v[76:79], a[60:63], v[20:23]
    s_waitcnt lgkmcnt(4)
    s_mul_i32 s38, s35, 256
    s_add_u32 s49, s48, s38
    v_mfma_f32_16x16x32_bf16 v[16:19], v[48:51], a[64:67], v[16:19]
    ds_read_b128 v[72:75], v212 offset:14336
    s_lshl_b32 s38, s36, 6
    v_mfma_f32_16x16x32_bf16 v[16:19], v[52:55], a[72:75], v[16:19]
    buffer_load_dwordx4 v3, s[20:23], s29 offen offset:3072 sc1 lds
    s_add_u32 s29, s29, 4096
    v_mfma_f32_16x16x32_bf16 v[20:23], v[48:51], a[68:71], v[20:23]
    ds_read_b128 v[76:79], v212 offset:15360
    s_add_u32 m0, s30, 77824
    v_mfma_f32_16x16x32_bf16 v[20:23], v[52:55], a[76:79], v[20:23]
    s_waitcnt lgkmcnt(4)
    s_add_u32 s49, s49, s38
    s_mul_i32 s38, s35, 32
    v_mfma_f32_16x16x32_bf16 v[16:19], v[56:59], a[80:83], v[16:19]
    ds_read_b128 v[48:51], v212 offset:16384
    s_add_u32 s51, s48, s38
    v_mfma_f32_16x16x32_bf16 v[16:19], v[60:63], a[88:91], v[16:19]
    s_add_u32 s51, s51, 1024
    s_mul_i32 s52, s24, 3072
    s_add_u32 s52, s52, 110592
    v_mfma_f32_16x16x32_bf16 v[20:23], v[56:59], a[84:87], v[20:23]
    ds_read_b128 v[52:55], v212 offset:17408
    v_lshrrev_b32 v14, 2, v2
    v_mfma_f32_16x16x32_bf16 v[20:23], v[60:63], a[92:95], v[20:23]
    s_waitcnt lgkmcnt(4)
    buffer_load_dwordx4 v3, s[20:23], s29 offen offset:0 sc1 lds
    v_mfma_f32_16x16x32_bf16 v[16:19], v[64:67], a[96:99], v[16:19]
    ds_read_b128 v[56:59], v212 offset:18432
    v_and_b32 v15, 3, v2
    v_mfma_f32_16x16x32_bf16 v[16:19], v[68:71], a[104:107], v[16:19]
    v_lshlrev_b32 v40, 6, v14
    v_lshl_add_u32 v40, v15, 3, v40
    v_mfma_f32_16x16x32_bf16 v[20:23], v[64:67], a[100:103], v[20:23]
    ds_read_b128 v[60:63], v212 offset:19456
    v_lshlrev_b32 v14, 12, v14
    v_mfma_f32_16x16x32_bf16 v[20:23], v[68:71], a[108:111], v[20:23]
    s_waitcnt lgkmcnt(4)
    v_lshl_add_u32 v14, v15, 4, v14
    v_add_u32 v40, s52, v40
    v_mfma_f32_16x16x32_bf16 v[16:19], v[72:75], a[112:115], v[16:19]
    ds_read_b128 v[64:67], v212 offset:20480
    v_add_u32 v41, s52, v3
    v_mfma_f32_16x16x32_bf16 v[16:19], v[76:79], a[120:123], v[16:19]
    buffer_load_dwordx4 v3, s[20:23], s29 offen offset:1024 sc1 lds
    s_lshl_b32 s38, s24, 11
    v_mfma_f32_16x16x32_bf16 v[20:23], v[72:75], a[116:119], v[20:23]
    ds_read_b128 v[68:71], v212 offset:21504
    s_add_u32 s38, s38, 153088
    v_mfma_f32_16x16x32_bf16 v[20:23], v[76:79], a[124:127], v[20:23]
    s_waitcnt lgkmcnt(4)
    s_lshl_b32 s62, s24, 8
    s_add_u32 s62, s62, 162304
    v_mfma_f32_16x16x32_bf16 v[16:19], v[48:51], a[128:131], v[16:19]
    ds_read_b128 v[72:75], v212 offset:22528
    v_lshlrev_b32 v15, 3, v10
    v_mfma_f32_16x16x32_bf16 v[16:19], v[52:55], a[136:139], v[16:19]
    buffer_load_dwordx4 v3, s[20:23], s29 offen offset:2048 sc1 lds
    v_lshl_add_u32 v44, v9, 6, v15
    v_mfma_f32_16x16x32_bf16 v[20:23], v[48:51], a[132:135], v[20:23]
    ds_read_b128 v[76:79], v212 offset:23552
    v_lshl_add_u32 v45, v9, 5, v15
    v_mfma_f32_16x16x32_bf16 v[20:23], v[52:55], a[140:143], v[20:23]
    s_waitcnt lgkmcnt(4)
    v_add_u32 v44, s38, v44
    v_add_u32 v45, 161280, v45
    v_mfma_f32_16x16x32_bf16 v[16:19], v[56:59], a[144:147], v[16:19]
    ds_read_b128 v[48:51], v212 offset:24576
    v_lshlrev_b32 v46, 3, v9
    v_mfma_f32_16x16x32_bf16 v[16:19], v[60:63], a[152:155], v[16:19]
    v_add_u32 v46, s62, v46
    s_lshl_b32 s38, s36, 5
    v_mfma_f32_16x16x32_bf16 v[20:23], v[56:59], a[148:151], v[20:23]
    ds_read_b128 v[52:55], v212 offset:25600
    s_mul_i32 s54, s35, 128
    v_mfma_f32_16x16x32_bf16 v[20:23], v[60:63], a[156:159], v[20:23]
    s_waitcnt lgkmcnt(4)
    buffer_load_dwordx4 v3, s[20:23], s29 offen offset:3072 sc1 lds
    v_mfma_f32_16x16x32_bf16 v[16:19], v[64:67], a[160:163], v[16:19]
    ds_read_b128 v[56:59], v212 offset:26624
    s_add_u32 s29, s29, 4096
    v_mfma_f32_16x16x32_bf16 v[16:19], v[68:71], a[168:171], v[16:19]
    s_add_u32 m0, s30, 81920
    s_add_u32 s54, s54, s38
    s_mul_i32 s55, s35, 16
    v_mfma_f32_16x16x32_bf16 v[20:23], v[64:67], a[164:167], v[20:23]
    ds_read_b128 v[60:63], v212 offset:27648
    s_add_u32 s55, s55, 512
    v_mfma_f32_16x16x32_bf16 v[20:23], v[68:71], a[172:175], v[20:23]
    s_waitcnt lgkmcnt(4)
    v_add_u32 v13, s54, v2
    v_add_u32 v15, s55, v9
    v_mfma_f32_16x16x32_bf16 v[16:19], v[72:75], a[176:179], v[16:19]
    ds_read_b128 v[64:67], v212 offset:28672
    v_cmp_gt_u32 vcc, 32, v2
    v_mfma_f32_16x16x32_bf16 v[16:19], v[76:79], a[184:187], v[16:19]
    buffer_load_dwordx4 v3, s[20:23], s29 offen offset:0 sc1 lds
    v_nop
    v_mfma_f32_16x16x32_bf16 v[20:23], v[72:75], a[180:183], v[20:23]
    ds_read_b128 v[68:71], v212 offset:29696
    v_nop
    v_mfma_f32_16x16x32_bf16 v[20:23], v[76:79], a[188:191], v[20:23]
    s_waitcnt lgkmcnt(4)
    v_cndmask_b32 v13, v15, v13, vcc
    v_and_b32 v15, 7, v13
    v_mfma_f32_16x16x32_bf16 v[16:19], v[48:51], a[192:195], v[16:19]
    ds_read_b128 v[72:75], v212 offset:30720
    v_lshrrev_b32 v13, 3, v13
    v_mfma_f32_16x16x32_bf16 v[16:19], v[52:55], a[200:203], v[16:19]
    v_lshlrev_b32 v13, 7, v13
    v_lshl_add_u32 v13, v15, 2, v13
    v_mfma_f32_16x16x32_bf16 v[20:23], v[48:51], a[196:199], v[20:23]
    ds_read_b128 v[76:79], v212 offset:31744
    s_mov_b32 s53, 24838144
    v_mfma_f32_16x16x32_bf16 v[20:23], v[52:55], a[204:207], v[20:23]
    s_waitcnt lgkmcnt(4)
    s_lshl_b32 s38, s37, 5
    s_add_u32 s38, s38, 22413312
    v_mfma_f32_16x16x32_bf16 v[16:19], v[56:59], a[208:211], v[16:19]
    ds_read_b128 v[48:51], v212 offset:32768
    s_lshl_b32 s54, s54, 12
    v_mfma_f32_16x16x32_bf16 v[16:19], v[60:63], a[216:219], v[16:19]
    s_add_u32 s54, s54, s38
    s_lshl_b32 s55, s55, 12
    s_add_u32 s55, s55, s38
    v_mfma_f32_16x16x32_bf16 v[20:23], v[56:59], a[212:215], v[20:23]
    ds_read_b128 v[52:55], v212 offset:33792
    s_sub_u32 s38, s36, 1
    v_mfma_f32_16x16x32_bf16 v[20:23], v[60:63], a[220:223], v[20:23]
    s_waitcnt lgkmcnt(4)
    s_and_b32 s38, s38, 3
    s_lshl_b32 s38, s38, 12
    v_mfma_f32_16x16x32_bf16 v[16:19], v[64:67], a[224:227], v[16:19]
    ds_read_b128 v[56:59], v212 offset:34816
    s_add_u32 s38, s38, s31
    v_mfma_f32_16x16x32_bf16 v[16:19], v[68:71], a[232:235], v[16:19]
    s_lshl_b32 s44, s36, 15
    s_add_u32 s44, s44, s38
    s_add_u32 s45, s44, 16384
    v_mfma_f32_16x16x32_bf16 v[20:23], v[64:67], a[228:231], v[20:23]
    ds_read_b128 v[60:63], v212 offset:35840
    s_add_u32 s46, s38, 131072
    v_mfma_f32_16x16x32_bf16 v[20:23], v[68:71], a[236:239], v[20:23]
    s_waitcnt lgkmcnt(4)
    s_cmp_eq_u32 s24, s36
    s_cselect_b32 s46, s46, 2147483632
    s_sub_u32 s38, s36, 2
    v_mfma_f32_16x16x32_bf16 v[16:19], v[72:75], a[240:243], v[16:19]
    ds_read_b128 v[64:67], v213 offset:0
    s_and_b32 s38, s38, 3
    v_mfma_f32_16x16x32_bf16 v[16:19], v[76:79], a[248:251], v[16:19]
    s_lshl_b32 s38, s38, 12
    s_add_u32 s38, s38, s31
    s_lshl_b32 s57, s36, 15
    v_mfma_f32_16x16x32_bf16 v[20:23], v[72:75], a[244:247], v[20:23]
    s_waitcnt lgkmcnt(0)
    s_barrier
    v_mfma_f32_16x16x32_bf16 v[20:23], v[76:79], a[252:255], v[20:23]
    s_add_u32 s57, s57, s38
    s_add_u32 s58, s57, 16384
    s_add_u32 s59, s38, 131072
    v_mfma_f32_16x16x32_bf16 v[16:19], v[48:51], v[224:227], v[16:19]
    ds_read_b128 v[68:71], v213 offset:1024
    s_cmp_eq_u32 s24, s36
    s_cselect_b32 s59, s59, 2147483632
    v_mfma_f32_16x16x32_bf16 v[16:19], v[52:55], v[232:235], v[16:19]
    s_sub_u32 s38, s36, 3
    s_and_b32 s38, s38, 3
    s_lshl_b32 s38, s38, 12
    v_mfma_f32_16x16x32_bf16 v[20:23], v[48:51], v[228:231], v[20:23]
    ds_read_b128 v[72:75], v213 offset:2048
    s_add_u32 s38, s38, s31
    v_mfma_f32_16x16x32_bf16 v[20:23], v[52:55], v[236:239], v[20:23]
    s_lshl_b32 s98, s36, 15
    s_add_u32 s98, s98, s38
    s_add_u32 s99, s98, 16384
    v_mfma_f32_16x16x32_bf16 v[16:19], v[56:59], v[240:243], v[16:19]
    ds_read_b128 v[76:79], v213 offset:3072
    s_add_u32 s100, s38, 131072
    v_mfma_f32_16x16x32_bf16 v[16:19], v[60:63], v[248:251], v[16:19]
    s_cmp_eq_u32 s24, s36
    s_cselect_b32 s100, s100, 2147483632
    v_and_b32 v42, 1, v10
    v_lshl_add_u32 v42, v42, 4, v9
    v_mfma_f32_16x16x32_bf16 v[20:23], v[56:59], v[244:247], v[20:23]
    ds_read_b128 v[48:51], v213 offset:4096
    v_mul_u32_u24 v42, 1152, v42
    v_mfma_f32_16x16x32_bf16 v[20:23], v[60:63], v[252:255], v[20:23]
    s_waitcnt lgkmcnt(3)
    s_waitcnt vmcnt(9)
    v_lshrrev_b32 v43, 1, v10
    v_mfma_f32_16x16x32_bf16 v[32:35], v[64:67], a[0:3], 0
    ds_read_b128 v[52:55], v213 offset:5120
    s_add_u32 s29, s36, 2
    v_mfma_f32_16x16x32_bf16 v[32:35], v[68:71], a[8:11], v[32:35]
    s_mov_b64 exec, 1
    buffer_store_dword v7, v8, s[20:23], s39 offen sc1
    s_mov_b64 exec, -1
    s_and_b32 s29, s29, 3
    v_mfma_f32_16x16x32_bf16 v[36:39], v[64:67], a[4:7], 0
    ds_read_b128 v[56:59], v213 offset:6144
    s_lshl_b32 s29, s29, 1
    v_mfma_f32_16x16x32_bf16 v[36:39], v[68:71], a[12:15], v[36:39]
    s_waitcnt lgkmcnt(3)
    s_add_u32 s29, s29, 0
    s_mul_i32 s29, s29, 148480
    v_mfma_f32_16x16x32_bf16 v[32:35], v[72:75], a[16:19], v[32:35]
    ds_read_b128 v[60:63], v213 offset:7168
    s_add_u32 s29, s29, s27
    v_mfma_f32_16x16x32_bf16 v[32:35], v[76:79], a[24:27], v[32:35]
    s_add_u32 m0, s30, 0
    s_mov_b32 s28, 8
    s_lshl_b32 s28, s28, 2
    v_mfma_f32_16x16x32_bf16 v[36:39], v[72:75], a[20:23], v[36:39]
    ds_read_b128 v[64:67], v213 offset:8192
    s_add_u32 s28, s28, s36
    v_mfma_f32_16x16x32_bf16 v[36:39], v[76:79], a[28:31], v[36:39]
    s_waitcnt lgkmcnt(3)
    buffer_load_dwordx4 v3, s[20:23], s29 offen offset:0 sc1 lds
    v_mfma_f32_16x16x32_bf16 v[32:35], v[48:51], a[32:35], v[32:35]
    ds_read_b128 v[68:71], v213 offset:9216
    s_lshl_b32 s28, s28, 12
    v_mfma_f32_16x16x32_bf16 v[32:35], v[52:55], a[40:43], v[32:35]
    buffer_load_dwordx4 v3, s[20:23], s29 offen offset:1024 sc1 lds
    s_add_u32 s28, s28, s31
    v_mfma_f32_16x16x32_bf16 v[36:39], v[48:51], a[36:39], v[36:39]
    ds_read_b128 v[72:75], v213 offset:10240
    v_cvt_pk_bf16_f32 v216, v16, v17
    v_mfma_f32_16x16x32_bf16 v[36:39], v[52:55], a[44:47], v[36:39]
    s_waitcnt lgkmcnt(3)
    buffer_load_dwordx4 v3, s[20:23], s29 offen offset:2048 sc1 lds
    v_mfma_f32_16x16x32_bf16 v[32:35], v[56:59], a[48:51], v[32:35]
    ds_read_b128 v[76:79], v213 offset:11264
    v_cvt_pk_bf16_f32 v217, v18, v19
    v_mfma_f32_16x16x32_bf16 v[32:35], v[60:63], a[56:59], v[32:35]
    v_cvt_pk_bf16_f32 v218, v20, v21
    v_cvt_pk_bf16_f32 v219, v22, v23
    v_mfma_f32_16x16x32_bf16 v[36:39], v[56:59], a[52:55], v[36:39]
    ds_read_b128 v[48:51], v213 offset:12288
    v_lshl_add_u32 v42, v43, 4, v42
    v_mfma_f32_16x16x32_bf16 v[36:39], v[60:63], a[60:63], v[36:39]
    s_waitcnt lgkmcnt(3)
    buffer_store_dwordx4 v[216:219], v6, s[20:23], s28 offen sc1
    v_mfma_f32_16x16x32_bf16 v[32:35], v[64:67], a[64:67], v[32:35]
    ds_read_b128 v[52:55], v213 offset:13312
    v_mfma_f32_16x16x32_bf16 v[32:35], v[68:71], a[72:75], v[32:35]
    ds_read_b64 v[80:81], v44 offset:0
    v_mfma_f32_16x16x32_bf16 v[36:39], v[64:67], a[68:71], v[36:39]
    ds_read_b128 v[56:59], v213 offset:14336
    v_mfma_f32_16x16x32_bf16 v[36:39], v[68:71], a[76:79], v[36:39]
    s_waitcnt lgkmcnt(4)
    ds_read_b64 v[82:83], v44 offset:1024
    v_mfma_f32_16x16x32_bf16 v[32:35], v[72:75], a[80:83], v[32:35]
    ds_read_b128 v[60:63], v213 offset:15360
    v_mfma_f32_16x16x32_bf16 v[32:35], v[76:79], a[88:91], v[32:35]
    buffer_load_dwordx4 v3, s[20:23], s29 offen offset:3072 sc1 lds
    s_add_u32 s29, s29, 4096
    v_mfma_f32_16x16x32_bf16 v[36:39], v[72:75], a[84:87], v[36:39]
    ds_read_b128 v[64:67], v213 offset:16384
    s_add_u32 m0, s30, 4096
    v_mfma_f32_16x16x32_bf16 v[36:39], v[76:79], a[92:95], v[36:39]
    s_waitcnt lgkmcnt(5)
    buffer_load_dwordx4 v3, s[20:23], s29 offen offset:0 sc1 lds
    v_mfma_f32_16x16x32_bf16 v[32:35], v[48:51], a[96:99], v[32:35]
    ds_read_b128 v[68:71], v213 offset:17408
    v_mfma_f32_16x16x32_bf16 v[32:35], v[52:55], a[104:107], v[32:35]
    ds_read_b64 v[84:85], v44 offset:32
    v_mfma_f32_16x16x32_bf16 v[36:39], v[48:51], a[100:103], v[36:39]
    ds_read_b128 v[72:75], v213 offset:18432
    v_mfma_f32_16x16x32_bf16 v[36:39], v[52:55], a[108:111], v[36:39]
    s_waitcnt lgkmcnt(4)
    ds_read_b64 v[86:87], v44 offset:1056
    v_mfma_f32_16x16x32_bf16 v[32:35], v[56:59], a[112:115], v[32:35]
    ds_read_b128 v[76:79], v213 offset:19456
    v_mfma_f32_16x16x32_bf16 v[32:35], v[60:63], a[120:123], v[32:35]
    buffer_load_dwordx4 v3, s[20:23], s29 offen offset:1024 sc1 lds
    v_mfma_f32_16x16x32_bf16 v[36:39], v[56:59], a[116:119], v[36:39]
    ds_read_b128 v[48:51], v213 offset:20480
    v_mfma_f32_16x16x32_bf16 v[36:39], v[60:63], a[124:127], v[36:39]
    s_waitcnt lgkmcnt(5)
    ds_read_b64 v[88:89], v45 offset:0
    v_mfma_f32_16x16x32_bf16 v[32:35], v[64:67], a[128:131], v[32:35]
    ds_read_b128 v[52:55], v213 offset:21504
    v_mfma_f32_16x16x32_bf16 v[32:35], v[68:71], a[136:139], v[32:35]
    buffer_load_dwordx4 v3, s[20:23], s29 offen offset:2048 sc1 lds
    v_mfma_f32_16x16x32_bf16 v[36:39], v[64:67], a[132:135], v[36:39]
    ds_read_b128 v[56:59], v213 offset:22528
    v_mfma_f32_16x16x32_bf16 v[36:39], v[68:71], a[140:143], v[36:39]
    s_waitcnt lgkmcnt(4)
    ds_read_b64 v[90:91], v45 offset:512
    v_mfma_f32_16x16x32_bf16 v[32:35], v[72:75], a[144:147], v[32:35]
    ds_read_b128 v[60:63], v213 offset:23552
    v_mfma_f32_16x16x32_bf16 v[32:35], v[76:79], a[152:155], v[32:35]
    ds_read_b64 v[204:205], v46 offset:0
    v_mfma_f32_16x16x32_bf16 v[36:39], v[72:75], a[148:151], v[36:39]
    ds_read_b128 v[64:67], v213 offset:24576
    v_mfma_f32_16x16x32_bf16 v[36:39], v[76:79], a[156:159], v[36:39]
    s_waitcnt lgkmcnt(5)
    buffer_load_dwordx4 v3, s[20:23], s29 offen offset:3072 sc1 lds
    v_mfma_f32_16x16x32_bf16 v[32:35], v[48:51], a[160:163], v[32:35]
    ds_read_b128 v[68:71], v213 offset:25600
    s_add_u32 s29, s29, 4096
    v_mfma_f32_16x16x32_bf16 v[32:35], v[52:55], a[168:171], v[32:35]
    s_add_u32 m0, s30, 8192
    ds_read_b64 v[206:207], v46 offset:128
    v_mfma_f32_16x16x32_bf16 v[36:39], v[48:51], a[164:167], v[36:39]
    ds_read_b128 v[72:75], v213 offset:26624
    v_mfma_f32_16x16x32_bf16 v[36:39], v[52:55], a[172:175], v[36:39]
    s_waitcnt lgkmcnt(5)
    v_mfma_f32_16x16x32_bf16 v[32:35], v[56:59], a[176:179], v[32:35]
    ds_read_b128 v[76:79], v213 offset:27648
    v_mfma_f32_16x16x32_bf16 v[32:35], v[60:63], a[184:187], v[32:35]
    buffer_load_dwordx4 v3, s[20:23], s29 offen offset:0 sc1 lds
    v_mfma_f32_16x16x32_bf16 v[36:39], v[56:59], a[180:183], v[36:39]
    ds_read_b128 v[48:51], v213 offset:28672
    v_mfma_f32_16x16x32_bf16 v[36:39], v[60:63], a[188:191], v[36:39]
    s_waitcnt lgkmcnt(4)
    v_mfma_f32_16x16x32_bf16 v[32:35], v[64:67], a[192:195], v[32:35]
    ds_read_b128 v[52:55], v213 offset:29696
    v_mfma_f32_16x16x32_bf16 v[32:35], v[68:71], a[200:203], v[32:35]
    v_mfma_f32_16x16x32_bf16 v[36:39], v[64:67], a[196:199], v[36:39]
    ds_read_b128 v[56:59], v213 offset:30720
    v_mfma_f32_16x16x32_bf16 v[36:39], v[68:71], a[204:207], v[36:39]
    s_waitcnt lgkmcnt(3)
    v_mfma_f32_16x16x32_bf16 v[32:35], v[72:75], a[208:211], v[32:35]
    ds_read_b128 v[60:63], v213 offset:31744
    v_mfma_f32_16x16x32_bf16 v[32:35], v[76:79], a[216:219], v[32:35]
    v_mfma_f32_16x16x32_bf16 v[36:39], v[72:75], a[212:215], v[36:39]
    ds_read_b128 v[64:67], v213 offset:32768
    v_mfma_f32_16x16x32_bf16 v[36:39], v[76:79], a[220:223], v[36:39]
    s_waitcnt lgkmcnt(3)
    v_mfma_f32_16x16x32_bf16 v[32:35], v[48:51], a[224:227], v[32:35]
    ds_read_b128 v[68:71], v213 offset:33792
    v_mfma_f32_16x16x32_bf16 v[32:35], v[52:55], a[232:235], v[32:35]
    v_mfma_f32_16x16x32_bf16 v[36:39], v[48:51], a[228:231], v[36:39]
    ds_read_b128 v[72:75], v213 offset:34816
    v_mfma_f32_16x16x32_bf16 v[36:39], v[52:55], a[236:239], v[36:39]
    s_waitcnt lgkmcnt(3)
    v_mfma_f32_16x16x32_bf16 v[32:35], v[56:59], a[240:243], v[32:35]
    ds_read_b128 v[76:79], v213 offset:35840
    v_mfma_f32_16x16x32_bf16 v[32:35], v[60:63], a[248:251], v[32:35]
    v_mfma_f32_16x16x32_bf16 v[36:39], v[56:59], a[244:247], v[36:39]
    s_waitcnt lgkmcnt(0)
    s_waitcnt vmcnt(11)
    s_barrier
    v_mfma_f32_16x16x32_bf16 v[36:39], v[60:63], a[252:255], v[36:39]
    ds_read_b128 v[48:51], v214 offset:0
    v_mfma_f32_16x16x32_bf16 v[32:35], v[64:67], v[224:227], v[32:35]
    ds_read_b128 v[52:55], v214 offset:1024
    v_mfma_f32_16x16x32_bf16 v[32:35], v[68:71], v[232:235], v[32:35]
    v_mfma_f32_16x16x32_bf16 v[36:39], v[64:67], v[228:231], v[36:39]
    ds_read_b128 v[56:59], v214 offset:2048
    v_mfma_f32_16x16x32_bf16 v[36:39], v[68:71], v[236:239], v[36:39]
    v_mfma_f32_16x16x32_bf16 v[32:35], v[72:75], v[240:243], v[32:35]
    ds_read_b128 v[60:63], v214 offset:3072
    v_mfma_f32_16x16x32_bf16 v[32:35], v[76:79], v[248:251], v[32:35]
    v_mfma_f32_16x16x32_bf16 v[36:39], v[72:75], v[244:247], v[36:39]
    ds_read_b128 v[64:67], v214 offset:4096
    v_mfma_f32_16x16x32_bf16 v[36:39], v[76:79], v[252:255], v[36:39]
    s_waitcnt lgkmcnt(3)
    v_mfma_f32_16x16x32_bf16 v[24:27], v[48:51], a[0:3], 0
    ds_read_b128 v[68:71], v214 offset:5120
    s_add_u32 s29, s36, 2
    v_mfma_f32_16x16x32_bf16 v[24:27], v[52:55], a[8:11], v[24:27]
    s_and_b32 s29, s29, 3
    s_lshl_b32 s29, s29, 1
    s_add_u32 s29, s29, 1
    v_mfma_f32_16x16x32_bf16 v[28:31], v[48:51], a[4:7], 0
    ds_read_b128 v[72:75], v214 offset:6144
    s_mul_i32 s29, s29, 148480
    v_mfma_f32_16x16x32_bf16 v[28:31], v[52:55], a[12:15], v[28:31]
    s_waitcnt lgkmcnt(3)
    s_add_u32 s29, s29, s27
    s_add_u32 m0, s30, 36864
    v_mfma_f32_16x16x32_bf16 v[24:27], v[56:59], a[16:19], v[24:27]
    ds_read_b128 v[76:79], v214 offset:7168
    s_add_u32 s28, s36, 1
    v_mfma_f32_16x16x32_bf16 v[24:27], v[60:63], a[24:27], v[24:27]
    buffer_load_dwordx4 v3, s[20:23], s29 offen offset:0 sc1 lds
    s_and_b32 s28, s28, 3
    v_mfma_f32_16x16x32_bf16 v[28:31], v[56:59], a[20:23], v[28:31]
    ds_read_b128 v[48:51], v214 offset:8192
    s_lshl_b32 s28, s28, 1
    v_mfma_f32_16x16x32_bf16 v[28:31], v[60:63], a[28:31], v[28:31]
    s_waitcnt lgkmcnt(3)
    buffer_load_dwordx4 v3, s[20:23], s29 offen offset:1024 sc1 lds
    v_mfma_f32_16x16x32_bf16 v[24:27], v[64:67], a[32:35], v[24:27]
    ds_read_b128 v[52:55], v214 offset:9216
    s_add_u32 s28, s28, 0
    v_mfma_f32_16x16x32_bf16 v[24:27], v[68:71], a[40:43], v[24:27]
    s_lshl_b32 s28, s28, 2
    s_add_u32 s28, s28, s36
    s_lshl_b32 s28, s28, 12
    v_mfma_f32_16x16x32_bf16 v[28:31], v[64:67], a[36:39], v[28:31]
    ds_read_b128 v[56:59], v214 offset:10240
    s_add_u32 s28, s28, s31
    v_mfma_f32_16x16x32_bf16 v[28:31], v[68:71], a[44:47], v[28:31]
    s_waitcnt lgkmcnt(3)
    buffer_load_dwordx4 v3, s[20:23], s29 offen offset:2048 sc1 lds
    v_mfma_f32_16x16x32_bf16 v[24:27], v[72:75], a[48:51], v[24:27]
    ds_read_b128 v[60:63], v214 offset:11264
    v_cvt_pk_bf16_f32 v216, v32, v33
    v_mfma_f32_16x16x32_bf16 v[24:27], v[76:79], a[56:59], v[24:27]
    v_cvt_pk_bf16_f32 v217, v34, v35
    v_cvt_pk_bf16_f32 v218, v36, v37
    v_mfma_f32_16x16x32_bf16 v[28:31], v[72:75], a[52:55], v[28:31]
    ds_read_b128 v[64:67], v214 offset:12288
    v_cvt_pk_bf16_f32 v219, v38, v39
    v_mfma_f32_16x16x32_bf16 v[28:31], v[76:79], a[60:63], v[28:31]
    s_waitcnt lgkmcnt(3)
    buffer_store_dwordx4 v[216:219], v6, s[20:23], s28 offen sc1
    v_mfma_f32_16x16x32_bf16 v[24:27], v[48:51], a[64:67], v[24:27]
    ds_read_b128 v[68:71], v214 offset:13312
    v_mfma_f32_16x16x32_bf16 v[24:27], v[52:55], a[72:75], v[24:27]
    v_mfma_f32_16x16x32_bf16 v[28:31], v[48:51], a[68:71], v[28:31]
    ds_read_b128 v[72:75], v214 offset:14336
    v_mfma_f32_16x16x32_bf16 v[28:31], v[52:55], a[76:79], v[28:31]
    s_waitcnt lgkmcnt(3)
    v_mfma_f32_16x16x32_bf16 v[24:27], v[56:59], a[80:83], v[24:27]
    ds_read_b128 v[76:79], v214 offset:15360
    v_mfma_f32_16x16x32_bf16 v[24:27], v[60:63], a[88:91], v[24:27]
    buffer_load_dwordx4 v3, s[20:23], s29 offen offset:3072 sc1 lds
    s_add_u32 s29, s29, 4096
    v_mfma_f32_16x16x32_bf16 v[28:31], v[56:59], a[84:87], v[28:31]
    ds_read_b128 v[48:51], v214 offset:16384
    s_add_u32 m0, s30, 40960
    v_mfma_f32_16x16x32_bf16 v[28:31], v[60:63], a[92:95], v[28:31]
    s_waitcnt lgkmcnt(3)
    buffer_load_dwordx4 v3, s[20:23], s29 offen offset:0 sc1 lds
    v_mfma_f32_16x16x32_bf16 v[24:27], v[64:67], a[96:99], v[24:27]
    ds_read_b128 v[52:55], v214 offset:17408
    v_mfma_f32_16x16x32_bf16 v[24:27], v[68:71], a[104:107], v[24:27]
    v_mfma_f32_16x16x32_bf16 v[28:31], v[64:67], a[100:103], v[28:31]
    ds_read_b128 v[56:59], v214 offset:18432
    v_mfma_f32_16x16x32_bf16 v[28:31], v[68:71], a[108:111], v[28:31]
    s_waitcnt lgkmcnt(3)
    v_mfma_f32_16x16x32_bf16 v[24:27], v[72:75], a[112:115], v[24:27]
    ds_read_b128 v[60:63], v214 offset:19456
    v_mfma_f32_16x16x32_bf16 v[24:27], v[76:79], a[120:123], v[24:27]
    buffer_load_dwordx4 v3, s[20:23], s29 offen offset:1024 sc1 lds
    v_mfma_f32_16x16x32_bf16 v[28:31], v[72:75], a[116:119], v[28:31]
    ds_read_b128 v[64:67], v214 offset:20480
    v_mfma_f32_16x16x32_bf16 v[28:31], v[76:79], a[124:127], v[28:31]
    s_waitcnt lgkmcnt(3)
    v_mfma_f32_16x16x32_bf16 v[24:27], v[48:51], a[128:131], v[24:27]
    ds_read_b128 v[68:71], v214 offset:21504
    v_mfma_f32_16x16x32_bf16 v[24:27], v[52:55], a[136:139], v[24:27]
    buffer_load_dwordx4 v3, s[20:23], s29 offen offset:2048 sc1 lds
    v_mfma_f32_16x16x32_bf16 v[28:31], v[48:51], a[132:135], v[28:31]
    ds_read_b128 v[72:75], v214 offset:22528
    v_mfma_f32_16x16x32_bf16 v[28:31], v[52:55], a[140:143], v[28:31]
    s_waitcnt lgkmcnt(3)
    v_mfma_f32_16x16x32_bf16 v[24:27], v[56:59], a[144:147], v[24:27]
    ds_read_b128 v[76:79], v214 offset:23552
    v_mfma_f32_16x16x32_bf16 v[24:27], v[60:63], a[152:155], v[24:27]
    v_mfma_f32_16x16x32_bf16 v[28:31], v[56:59], a[148:151], v[28:31]
    ds_read_b128 v[48:51], v214 offset:24576
    v_mfma_f32_16x16x32_bf16 v[28:31], v[60:63], a[156:159], v[28:31]
    s_waitcnt lgkmcnt(3)
    buffer_load_dwordx4 v3, s[20:23], s29 offen offset:3072 sc1 lds
    v_mfma_f32_16x16x32_bf16 v[24:27], v[64:67], a[160:163], v[24:27]
    ds_read_b128 v[52:55], v214 offset:25600
    s_add_u32 s29, s29, 4096
    v_mfma_f32_16x16x32_bf16 v[24:27], v[68:71], a[168:171], v[24:27]
    s_add_u32 m0, s30, 45056
    v_mfma_f32_16x16x32_bf16 v[28:31], v[64:67], a[164:167], v[28:31]
    ds_read_b128 v[56:59], v214 offset:26624
    v_mfma_f32_16x16x32_bf16 v[28:31], v[68:71], a[172:175], v[28:31]
    s_waitcnt lgkmcnt(3)
    v_mfma_f32_16x16x32_bf16 v[24:27], v[72:75], a[176:179], v[24:27]
    ds_read_b128 v[60:63], v214 offset:27648
    v_mfma_f32_16x16x32_bf16 v[24:27], v[76:79], a[184:187], v[24:27]
    buffer_load_dwordx4 v3, s[20:23], s29 offen offset:0 sc1 lds
    v_mfma_f32_16x16x32_bf16 v[28:31], v[72:75], a[180:183], v[28:31]
    ds_read_b128 v[64:67], v214 offset:28672
    v_mfma_f32_16x16x32_bf16 v[28:31], v[76:79], a[188:191], v[28:31]
    s_waitcnt lgkmcnt(3)
    v_mfma_f32_16x16x32_bf16 v[24:27], v[48:51], a[192:195], v[24:27]
    ds_read_b128 v[68:71], v214 offset:29696
    v_mfma_f32_16x16x32_bf16 v[24:27], v[52:55], a[200:203], v[24:27]
    v_mfma_f32_16x16x32_bf16 v[28:31], v[48:51], a[196:199], v[28:31]
    ds_read_b128 v[72:75], v214 offset:30720
    v_mfma_f32_16x16x32_bf16 v[28:31], v[52:55], a[204:207], v[28:31]
    s_waitcnt lgkmcnt(3)
    v_mfma_f32_16x16x32_bf16 v[24:27], v[56:59], a[208:211], v[24:27]
    ds_read_b128 v[76:79], v214 offset:31744
    v_mfma_f32_16x16x32_bf16 v[24:27], v[60:63], a[216:219], v[24:27]
    v_mfma_f32_16x16x32_bf16 v[28:31], v[56:59], a[212:215], v[28:31]
    ds_read_b128 v[48:51], v214 offset:32768
    v_mfma_f32_16x16x32_bf16 v[28:31], v[60:63], a[220:223], v[28:31]
    s_waitcnt lgkmcnt(3)
    v_mfma_f32_16x16x32_bf16 v[24:27], v[64:67], a[224:227], v[24:27]
    ds_read_b128 v[52:55], v214 offset:33792
    v_mfma_f32_16x16x32_bf16 v[24:27], v[68:71], a[232:235], v[24:27]
    v_mfma_f32_16x16x32_bf16 v[28:31], v[64:67], a[228:231], v[28:31]
    ds_read_b128 v[56:59], v214 offset:34816
    v_mfma_f32_16x16x32_bf16 v[28:31], v[68:71], a[236:239], v[28:31]
    s_waitcnt lgkmcnt(3)
    v_mfma_f32_16x16x32_bf16 v[24:27], v[72:75], a[240:243], v[24:27]
    ds_read_b128 v[60:63], v214 offset:35840
    v_mfma_f32_16x16x32_bf16 v[24:27], v[76:79], a[248:251], v[24:27]
    v_mfma_f32_16x16x32_bf16 v[28:31], v[72:75], a[244:247], v[28:31]
    s_waitcnt lgkmcnt(0)
    s_waitcnt vmcnt(10)
    s_barrier
    v_mfma_f32_16x16x32_bf16 v[28:31], v[76:79], a[252:255], v[28:31]
    ds_read_b128 v[64:67], v212 offset:0
    v_mfma_f32_16x16x32_bf16 v[24:27], v[48:51], v[224:227], v[24:27]
    ds_read_b128 v[68:71], v212 offset:1024
    v_mfma_f32_16x16x32_bf16 v[24:27], v[52:55], v[232:235], v[24:27]
    v_mfma_f32_16x16x32_bf16 v[28:31], v[48:51], v[228:231], v[28:31]
    ds_read_b128 v[72:75], v212 offset:2048
    v_mfma_f32_16x16x32_bf16 v[28:31], v[52:55], v[236:239], v[28:31]
    v_mfma_f32_16x16x32_bf16 v[24:27], v[56:59], v[240:243], v[24:27]
    ds_read_b128 v[76:79], v212 offset:3072
    v_mfma_f32_16x16x32_bf16 v[24:27], v[60:63], v[248:251], v[24:27]
    v_mfma_f32_16x16x32_bf16 v[28:31], v[56:59], v[244:247], v[28:31]
    ds_read_b128 v[48:51], v212 offset:4096
    v_mfma_f32_16x16x32_bf16 v[28:31], v[60:63], v[252:255], v[28:31]
    s_waitcnt lgkmcnt(3)
    v_mfma_f32_16x16x32_bf16 v[32:35], v[64:67], a[0:3], 0
    ds_read_b128 v[52:55], v212 offset:5120
    s_add_u32 s29, s36, 3
    v_mfma_f32_16x16x32_bf16 v[32:35], v[68:71], a[8:11], v[32:35]
    s_and_b32 s29, s29, 3
    s_lshl_b32 s29, s29, 1
    s_add_u32 s29, s29, 0
    v_mfma_f32_16x16x32_bf16 v[36:39], v[64:67], a[4:7], 0
    ds_read_b128 v[56:59], v212 offset:6144
    s_mul_i32 s29, s29, 148480
    v_mfma_f32_16x16x32_bf16 v[36:39], v[68:71], a[12:15], v[36:39]
    s_waitcnt lgkmcnt(3)
    s_add_u32 s29, s29, s27
    s_add_u32 m0, s30, 73728
    v_mfma_f32_16x16x32_bf16 v[32:35], v[72:75], a[16:19], v[32:35]
    ds_read_b128 v[60:63], v212 offset:7168
    s_add_u32 s28, s36, 1
    v_mfma_f32_16x16x32_bf16 v[32:35], v[76:79], a[24:27], v[32:35]
    buffer_load_dwordx4 v3, s[20:23], s29 offen offset:0 sc1 lds
    s_and_b32 s28, s28, 3
    v_mfma_f32_16x16x32_bf16 v[36:39], v[72:75], a[20:23], v[36:39]
    ds_read_b128 v[64:67], v212 offset:8192
    s_lshl_b32 s28, s28, 1
    v_mfma_f32_16x16x32_bf16 v[36:39], v[76:79], a[28:31], v[36:39]
    s_waitcnt lgkmcnt(3)
    buffer_load_dwordx4 v3, s[20:23], s29 offen offset:1024 sc1 lds
    v_mfma_f32_16x16x32_bf16 v[32:35], v[48:51], a[32:35], v[32:35]
    ds_read_b128 v[68:71], v212 offset:9216
    s_add_u32 s28, s28, 1
    v_mfma_f32_16x16x32_bf16 v[32:35], v[52:55], a[40:43], v[32:35]
    buffer_load_dword v43, v13, s[20:23], s53 offen sc1
    s_lshl_b32 s28, s28, 2
    v_mfma_f32_16x16x32_bf16 v[36:39], v[48:51], a[36:39], v[36:39]
    ds_read_b128 v[72:75], v212 offset:10240
    s_add_u32 s28, s28, s36
    v_mfma_f32_16x16x32_bf16 v[36:39], v[52:55], a[44:47], v[36:39]
    s_waitcnt lgkmcnt(3)
    buffer_load_dwordx4 v3, s[20:23], s29 offen offset:2048 sc1 lds
    v_mfma_f32_16x16x32_bf16 v[32:35], v[56:59], a[48:51], v[32:35]
    ds_read_b128 v[76:79], v212 offset:11264
    s_lshl_b32 s28, s28, 12
    v_mfma_f32_16x16x32_bf16 v[32:35], v[60:63], a[56:59], v[32:35]
    s_add_u32 s28, s28, s31
    v_cvt_pk_bf16_f32 v216, v24, v25
    v_cvt_pk_bf16_f32 v217, v26, v27
    v_mfma_f32_16x16x32_bf16 v[36:39], v[56:59], a[52:55], v[36:39]
    ds_read_b128 v[48:51], v212 offset:12288
    v_cvt_pk_bf16_f32 v218, v28, v29
    v_mfma_f32_16x16x32_bf16 v[36:39], v[60:63], a[60:63], v[36:39]
    s_waitcnt lgkmcnt(3)
    v_cvt_pk_bf16_f32 v219, v30, v31
    v_mfma_f32_16x16x32_bf16 v[32:35], v[64:67], a[64:67], v[32:35]
    ds_read_b128 v[52:55], v212 offset:13312
    v_mfma_f32_16x16x32_bf16 v[32:35], v[68:71], a[72:75], v[32:35]
    buffer_store_dwordx4 v[216:219], v6, s[20:23], s28 offen sc1
    v_mfma_f32_16x16x32_bf16 v[36:39], v[64:67], a[68:71], v[36:39]
    ds_read_b128 v[56:59], v212 offset:14336
    v_mfma_f32_16x16x32_bf16 v[36:39], v[68:71], a[76:79], v[36:39]
    s_waitcnt lgkmcnt(3)
    v_mfma_f32_16x16x32_bf16 v[32:35], v[72:75], a[80:83], v[32:35]
    ds_read_b128 v[60:63], v212 offset:15360
    v_mfma_f32_16x16x32_bf16 v[32:35], v[76:79], a[88:91], v[32:35]
    v_mfma_f32_16x16x32_bf16 v[36:39], v[72:75], a[84:87], v[36:39]
    ds_read_b128 v[64:67], v212 offset:16384
    v_mfma_f32_16x16x32_bf16 v[36:39], v[76:79], a[92:95], v[36:39]
    s_waitcnt lgkmcnt(3)
    buffer_load_dwordx4 v3, s[20:23], s29 offen offset:3072 sc1 lds
    v_mfma_f32_16x16x32_bf16 v[32:35], v[48:51], a[96:99], v[32:35]
    ds_read_b128 v[68:71], v212 offset:17408
    s_add_u32 s29, s29, 4096
    v_mfma_f32_16x16x32_bf16 v[32:35], v[52:55], a[104:107], v[32:35]
    s_add_u32 m0, s30, 77824
    v_mfma_f32_16x16x32_bf16 v[36:39], v[48:51], a[100:103], v[36:39]
    ds_read_b128 v[72:75], v212 offset:18432
    v_mfma_f32_16x16x32_bf16 v[36:39], v[52:55], a[108:111], v[36:39]
    s_waitcnt lgkmcnt(3)
    buffer_load_dwordx4 v3, s[20:23], s29 offen offset:0 sc1 lds
    v_mfma_f32_16x16x32_bf16 v[32:35], v[56:59], a[112:115], v[32:35]
    ds_read_b128 v[76:79], v212 offset:19456
    v_mfma_f32_16x16x32_bf16 v[32:35], v[60:63], a[120:123], v[32:35]
    buffer_load_dwordx4 v3, s[20:23], s29 offen offset:1024 sc1 lds
    v_mfma_f32_16x16x32_bf16 v[36:39], v[56:59], a[116:119], v[36:39]
    ds_read_b128 v[48:51], v212 offset:20480
    v_mfma_f32_16x16x32_bf16 v[36:39], v[60:63], a[124:127], v[36:39]
    s_waitcnt lgkmcnt(3)
    v_mfma_f32_16x16x32_bf16 v[32:35], v[64:67], a[128:131], v[32:35]
    ds_read_b128 v[52:55], v212 offset:21504
    v_mfma_f32_16x16x32_bf16 v[32:35], v[68:71], a[136:139], v[32:35]
    buffer_load_dwordx4 v3, s[20:23], s29 offen offset:2048 sc1 lds
    v_mfma_f32_16x16x32_bf16 v[36:39], v[64:67], a[132:135], v[36:39]
    ds_read_b128 v[56:59], v212 offset:22528
    v_mfma_f32_16x16x32_bf16 v[36:39], v[68:71], a[140:143], v[36:39]
    s_waitcnt lgkmcnt(3)
    v_mfma_f32_16x16x32_bf16 v[32:35], v[72:75], a[144:147], v[32:35]
    ds_read_b128 v[60:63], v212 offset:23552
    v_mfma_f32_16x16x32_bf16 v[32:35], v[76:79], a[152:155], v[32:35]
    v_mfma_f32_16x16x32_bf16 v[36:39], v[72:75], a[148:151], v[36:39]
    ds_read_b128 v[64:67], v212 offset:24576
    v_mfma_f32_16x16x32_bf16 v[36:39], v[76:79], a[156:159], v[36:39]
    s_waitcnt lgkmcnt(3)
    buffer_load_dwordx4 v3, s[20:23], s29 offen offset:3072 sc1 lds
    v_mfma_f32_16x16x32_bf16 v[32:35], v[48:51], a[160:163], v[32:35]
    ds_read_b128 v[68:71], v212 offset:25600
    s_add_u32 s29, s29, 4096
    v_mfma_f32_16x16x32_bf16 v[32:35], v[52:55], a[168:171], v[32:35]
    s_add_u32 m0, s30, 81920
    v_mfma_f32_16x16x32_bf16 v[36:39], v[48:51], a[164:167], v[36:39]
    ds_read_b128 v[72:75], v212 offset:26624
    v_mfma_f32_16x16x32_bf16 v[36:39], v[52:55], a[172:175], v[36:39]
    s_waitcnt lgkmcnt(3)
    v_mfma_f32_16x16x32_bf16 v[32:35], v[56:59], a[176:179], v[32:35]
    ds_read_b128 v[76:79], v212 offset:27648
    v_mfma_f32_16x16x32_bf16 v[32:35], v[60:63], a[184:187], v[32:35]
    buffer_load_dwordx4 v3, s[20:23], s29 offen offset:0 sc1 lds
    v_mfma_f32_16x16x32_bf16 v[36:39], v[56:59], a[180:183], v[36:39]
    ds_read_b128 v[48:51], v212 offset:28672
    v_mfma_f32_16x16x32_bf16 v[36:39], v[60:63], a[188:191], v[36:39]
    s_waitcnt lgkmcnt(3)
    v_mfma_f32_16x16x32_bf16 v[32:35], v[64:67], a[192:195], v[32:35]
    ds_read_b128 v[52:55], v212 offset:29696
    v_mfma_f32_16x16x32_bf16 v[32:35], v[68:71], a[200:203], v[32:35]
    v_mfma_f32_16x16x32_bf16 v[36:39], v[64:67], a[196:199], v[36:39]
    ds_read_b128 v[56:59], v212 offset:30720
    v_mfma_f32_16x16x32_bf16 v[36:39], v[68:71], a[204:207], v[36:39]
    s_waitcnt lgkmcnt(3)
    v_mfma_f32_16x16x32_bf16 v[32:35], v[72:75], a[208:211], v[32:35]
    ds_read_b128 v[60:63], v212 offset:31744
    v_mfma_f32_16x16x32_bf16 v[32:35], v[76:79], a[216:219], v[32:35]
    v_mfma_f32_16x16x32_bf16 v[36:39], v[72:75], a[212:215], v[36:39]
    ds_read_b128 v[64:67], v212 offset:32768
    v_mfma_f32_16x16x32_bf16 v[36:39], v[76:79], a[220:223], v[36:39]
    s_waitcnt lgkmcnt(3)
    v_mfma_f32_16x16x32_bf16 v[32:35], v[48:51], a[224:227], v[32:35]
    ds_read_b128 v[68:71], v212 offset:33792
    v_mfma_f32_16x16x32_bf16 v[32:35], v[52:55], a[232:235], v[32:35]
    v_mfma_f32_16x16x32_bf16 v[36:39], v[48:51], a[228:231], v[36:39]
    ds_read_b128 v[72:75], v212 offset:34816
    v_mfma_f32_16x16x32_bf16 v[36:39], v[52:55], a[236:239], v[36:39]
    s_waitcnt lgkmcnt(3)
    v_mfma_f32_16x16x32_bf16 v[32:35], v[56:59], a[240:243], v[32:35]
    ds_read_b128 v[76:79], v212 offset:35840
    v_mfma_f32_16x16x32_bf16 v[32:35], v[60:63], a[248:251], v[32:35]
    v_mfma_f32_16x16x32_bf16 v[36:39], v[56:59], a[244:247], v[36:39]
    s_waitcnt lgkmcnt(0)
    s_waitcnt vmcnt(11)
    s_barrier
    v_mfma_f32_16x16x32_bf16 v[36:39], v[60:63], a[252:255], v[36:39]
    ds_read_b128 v[48:51], v213 offset:0
    v_mfma_f32_16x16x32_bf16 v[32:35], v[64:67], v[224:227], v[32:35]
    ds_read_b128 v[52:55], v213 offset:1024
    v_mfma_f32_16x16x32_bf16 v[32:35], v[68:71], v[232:235], v[32:35]
    v_mfma_f32_16x16x32_bf16 v[36:39], v[64:67], v[228:231], v[36:39]
    ds_read_b128 v[56:59], v213 offset:2048
    v_mfma_f32_16x16x32_bf16 v[36:39], v[68:71], v[236:239], v[36:39]
    v_mfma_f32_16x16x32_bf16 v[32:35], v[72:75], v[240:243], v[32:35]
    ds_read_b128 v[60:63], v213 offset:3072
    v_mfma_f32_16x16x32_bf16 v[32:35], v[76:79], v[248:251], v[32:35]
    v_mfma_f32_16x16x32_bf16 v[36:39], v[72:75], v[244:247], v[36:39]
    ds_read_b128 v[64:67], v213 offset:4096
    v_mfma_f32_16x16x32_bf16 v[36:39], v[76:79], v[252:255], v[36:39]
    s_waitcnt lgkmcnt(3)
    v_mfma_f32_16x16x32_bf16 v[24:27], v[48:51], a[0:3], 0
    ds_read_b128 v[68:71], v213 offset:5120
    s_add_u32 s29, s36, 3
    v_mfma_f32_16x16x32_bf16 v[24:27], v[52:55], a[8:11], v[24:27]
    s_and_b32 s29, s29, 3
    s_lshl_b32 s29, s29, 1
    s_add_u32 s29, s29, 1
    v_mfma_f32_16x16x32_bf16 v[28:31], v[48:51], a[4:7], 0
    ds_read_b128 v[72:75], v213 offset:6144
    s_mul_i32 s29, s29, 148480
    v_mfma_f32_16x16x32_bf16 v[28:31], v[52:55], a[12:15], v[28:31]
    s_waitcnt lgkmcnt(3)
    s_add_u32 s29, s29, s27
    s_add_u32 m0, s30, 0
    v_mfma_f32_16x16x32_bf16 v[24:27], v[56:59], a[16:19], v[24:27]
    ds_read_b128 v[76:79], v213 offset:7168
    s_add_u32 s28, s36, 2
    v_mfma_f32_16x16x32_bf16 v[24:27], v[60:63], a[24:27], v[24:27]
    buffer_load_dwordx4 v3, s[20:23], s29 offen offset:0 sc1 lds
    s_and_b32 s28, s28, 3
    v_mfma_f32_16x16x32_bf16 v[28:31], v[56:59], a[20:23], v[28:31]
    ds_read_b128 v[48:51], v213 offset:8192
    s_lshl_b32 s28, s28, 1
    v_mfma_f32_16x16x32_bf16 v[28:31], v[60:63], a[28:31], v[28:31]
    s_waitcnt lgkmcnt(3)
    buffer_load_dwordx4 v3, s[20:23], s29 offen offset:1024 sc1 lds
    v_mfma_f32_16x16x32_bf16 v[24:27], v[64:67], a[32:35], v[24:27]
    ds_read_b128 v[52:55], v213 offset:9216
    s_add_u32 s28, s28, 0
    v_mfma_f32_16x16x32_bf16 v[24:27], v[68:71], a[40:43], v[24:27]
    s_lshl_b32 s28, s28, 2
    s_add_u32 s28, s28, s36
    s_lshl_b32 s28, s28, 12
    v_mfma_f32_16x16x32_bf16 v[28:31], v[64:67], a[36:39], v[28:31]
    ds_read_b128 v[56:59], v213 offset:10240
    s_add_u32 s28, s28, s31
    v_mfma_f32_16x16x32_bf16 v[28:31], v[68:71], a[44:47], v[28:31]
    s_waitcnt lgkmcnt(3)
    buffer_load_dwordx4 v3, s[20:23], s29 offen offset:2048 sc1 lds
    v_mfma_f32_16x16x32_bf16 v[24:27], v[72:75], a[48:51], v[24:27]
    ds_read_b128 v[60:63], v213 offset:11264
    v_cvt_pk_bf16_f32 v216, v32, v33
    v_mfma_f32_16x16x32_bf16 v[24:27], v[76:79], a[56:59], v[24:27]
    v_cvt_pk_bf16_f32 v217, v34, v35
    v_cvt_pk_bf16_f32 v218, v36, v37
    v_mfma_f32_16x16x32_bf16 v[28:31], v[72:75], a[52:55], v[28:31]
    ds_read_b128 v[64:67], v213 offset:12288
    v_cvt_pk_bf16_f32 v219, v38, v39
    v_mfma_f32_16x16x32_bf16 v[28:31], v[76:79], a[60:63], v[28:31]
    s_waitcnt lgkmcnt(3)
    buffer_store_dwordx4 v[216:219], v6, s[20:23], s28 offen sc1
    v_mfma_f32_16x16x32_bf16 v[24:27], v[48:51], a[64:67], v[24:27]
    ds_read_b128 v[68:71], v213 offset:13312
    v_mfma_f32_16x16x32_bf16 v[24:27], v[52:55], a[72:75], v[24:27]
    s_waitcnt vmcnt(12)
    v_cmp_ne_u32 vcc, 1, v43
    s_nop 1
    s_cmp_eq_u64 vcc, 0
    s_cbranch_scc0 L_spin_pc
L_back_pc:
    v_mfma_f32_16x16x32_bf16 v[28:31], v[48:51], a[68:71], v[28:31]
    ds_read_b128 v[72:75], v213 offset:14336
    v_mfma_f32_16x16x32_bf16 v[28:31], v[52:55], a[76:79], v[28:31]
    s_waitcnt lgkmcnt(3)
    v_mfma_f32_16x16x32_bf16 v[24:27], v[56:59], a[80:83], v[24:27]
    ds_read_b128 v[76:79], v213 offset:15360
    v_mfma_f32_16x16x32_bf16 v[24:27], v[60:63], a[88:91], v[24:27]
    buffer_load_dwordx4 v[104:107], v14, s[20:23], s54 offen sc1
    s_add_u32 s54, s54, 65536
    v_mfma_f32_16x16x32_bf16 v[28:31], v[56:59], a[84:87], v[28:31]
    ds_read_b128 v[48:51], v213 offset:16384
    v_mfma_f32_16x16x32_bf16 v[28:31], v[60:63], a[92:95], v[28:31]
    s_waitcnt lgkmcnt(3)
    buffer_load_dwordx4 v[108:111], v14, s[20:23], s54 offen sc1
    v_mfma_f32_16x16x32_bf16 v[24:27], v[64:67], a[96:99], v[24:27]
    ds_read_b128 v[52:55], v213 offset:17408
    v_mfma_f32_16x16x32_bf16 v[24:27], v[68:71], a[104:107], v[24:27]
    buffer_load_dwordx4 v[112:115], v14, s[20:23], s55 offen sc1
    v_mfma_f32_16x16x32_bf16 v[28:31], v[64:67], a[100:103], v[28:31]
    ds_read_b128 v[56:59], v213 offset:18432
    v_mfma_f32_16x16x32_bf16 v[28:31], v[68:71], a[108:111], v[28:31]
    s_waitcnt lgkmcnt(3)
    buffer_load_dwordx4 v3, s[20:23], s29 offen offset:3072 sc1 lds
    v_mfma_f32_16x16x32_bf16 v[24:27], v[72:75], a[112:115], v[24:27]
    ds_read_b128 v[60:63], v213 offset:19456
    s_add_u32 s29, s29, 4096
    v_mfma_f32_16x16x32_bf16 v[24:27], v[76:79], a[120:123], v[24:27]
    s_add_u32 m0, s30, 4096
    v_mfma_f32_16x16x32_bf16 v[28:31], v[72:75], a[116:119], v[28:31]
    ds_read_b128 v[64:67], v213 offset:20480
    v_mfma_f32_16x16x32_bf16 v[28:31], v[76:79], a[124:127], v[28:31]
    s_waitcnt lgkmcnt(3)
    buffer_load_dwordx4 v3, s[20:23], s29 offen offset:0 sc1 lds
    v_mfma_f32_16x16x32_bf16 v[24:27], v[48:51], a[128:131], v[24:27]
    ds_read_b128 v[68:71], v213 offset:21504
    v_mfma_f32_16x16x32_bf16 v[24:27], v[52:55], a[136:139], v[24:27]
    buffer_load_dwordx4 v3, s[20:23], s29 offen offset:1024 sc1 lds
    v_mfma_f32_16x16x32_bf16 v[28:31], v[48:51], a[132:135], v[28:31]
    ds_read_b128 v[72:75], v213 offset:22528
    v_mfma_f32_16x16x32_bf16 v[28:31], v[52:55], a[140:143], v[28:31]
    s_waitcnt lgkmcnt(3)
    buffer_load_dwordx4 v3, s[20:23], s29 offen offset:2048 sc1 lds
    v_mfma_f32_16x16x32_bf16 v[24:27], v[56:59], a[144:147], v[24:27]
    ds_read_b128 v[76:79], v213 offset:23552
    v_mfma_f32_16x16x32_bf16 v[24:27], v[60:63], a[152:155], v[24:27]
    v_mfma_f32_16x16x32_bf16 v[28:31], v[56:59], a[148:151], v[28:31]
    ds_read_b128 v[48:51], v213 offset:24576
    v_mfma_f32_16x16x32_bf16 v[28:31], v[60:63], a[156:159], v[28:31]
    s_waitcnt lgkmcnt(3)
    buffer_load_dwordx4 v3, s[20:23], s29 offen offset:3072 sc1 lds
    v_mfma_f32_16x16x32_bf16 v[24:27], v[64:67], a[160:163], v[24:27]
    ds_read_b128 v[52:55], v213 offset:25600
    s_add_u32 s29, s29, 4096
    v_mfma_f32_16x16x32_bf16 v[24:27], v[68:71], a[168:171], v[24:27]
    s_add_u32 m0, s30, 8192
    v_mfma_f32_16x16x32_bf16 v[28:31], v[64:67], a[164:167], v[28:31]
    ds_read_b128 v[56:59], v213 offset:26624
    v_mfma_f32_16x16x32_bf16 v[28:31], v[68:71], a[172:175], v[28:31]
    s_waitcnt lgkmcnt(3)
    v_mfma_f32_16x16x32_bf16 v[24:27], v[72:75], a[176:179], v[24:27]
    ds_read_b128 v[60:63], v213 offset:27648
    v_mfma_f32_16x16x32_bf16 v[24:27], v[76:79], a[184:187], v[24:27]
    buffer_load_dwordx4 v3, s[20:23], s29 offen offset:0 sc1 lds
    v_mfma_f32_16x16x32_bf16 v[28:31], v[72:75], a[180:183], v[28:31]
    ds_read_b128 v[64:67], v213 offset:28672
    v_mfma_f32_16x16x32_bf16 v[28:31], v[76:79], a[188:191], v[28:31]
    s_waitcnt lgkmcnt(3)
    v_mfma_f32_16x16x32_bf16 v[24:27], v[48:51], a[192:195], v[24:27]
    ds_read_b128 v[68:71], v213 offset:29696
    v_mfma_f32_16x16x32_bf16 v[24:27], v[52:55], a[200:203], v[24:27]
    v_mfma_f32_16x16x32_bf16 v[28:31], v[48:51], a[196:199], v[28:31]
    ds_read_b128 v[72:75], v213 offset:30720
    v_mfma_f32_16x16x32_bf16 v[28:31], v[52:55], a[204:207], v[28:31]
    s_waitcnt lgkmcnt(3)
    v_mfma_f32_16x16x32_bf16 v[24:27], v[56:59], a[208:211], v[24:27]
    ds_read_b128 v[76:79], v213 offset:31744
    v_mfma_f32_16x16x32_bf16 v[24:27], v[60:63], a[216:219], v[24:27]
    v_mfma_f32_16x16x32_bf16 v[28:31], v[56:59], a[212:215], v[28:31]
    ds_read_b128 v[48:51], v213 offset:32768
    v_mfma_f32_16x16x32_bf16 v[28:31], v[60:63], a[220:223], v[28:31]
    s_waitcnt lgkmcnt(3)
    v_mfma_f32_16x16x32_bf16 v[24:27], v[64:67], a[224:227], v[24:27]
    ds_read_b128 v[52:55], v213 offset:33792
    v_mfma_f32_16x16x32_bf16 v[24:27], v[68:71], a[232:235], v[24:27]
    v_mfma_f32_16x16x32_bf16 v[28:31], v[64:67], a[228:231], v[28:31]
    ds_read_b128 v[56:59], v213 offset:34816
    v_mfma_f32_16x16x32_bf16 v[28:31], v[68:71], a[236:239], v[28:31]
    s_waitcnt lgkmcnt(3)
    v_mfma_f32_16x16x32_bf16 v[24:27], v[72:75], a[240:243], v[24:27]
    ds_read_b128 v[60:63], v213 offset:35840
    v_mfma_f32_16x16x32_bf16 v[24:27], v[76:79], a[248:251], v[24:27]
    v_mfma_f32_16x16x32_bf16 v[28:31], v[72:75], a[244:247], v[28:31]
    s_waitcnt lgkmcnt(0)
    s_waitcnt vmcnt(13)
    s_barrier
    v_mfma_f32_16x16x32_bf16 v[28:31], v[76:79], a[252:255], v[28:31]
    ds_read_b128 v[64:67], v214 offset:0
    v_mfma_f32_16x16x32_bf16 v[24:27], v[48:51], v[224:227], v[24:27]
    ds_read_b128 v[68:71], v214 offset:1024
    v_mfma_f32_16x16x32_bf16 v[24:27], v[52:55], v[232:235], v[24:27]
    v_mfma_f32_16x16x32_bf16 v[28:31], v[48:51], v[228:231], v[28:31]
    ds_read_b128 v[72:75], v214 offset:2048
    v_mfma_f32_16x16x32_bf16 v[28:31], v[52:55], v[236:239], v[28:31]
    v_mfma_f32_16x16x32_bf16 v[24:27], v[56:59], v[240:243], v[24:27]
    ds_read_b128 v[76:79], v214 offset:3072
    v_mfma_f32_16x16x32_bf16 v[24:27], v[60:63], v[248:251], v[24:27]
    v_mfma_f32_16x16x32_bf16 v[28:31], v[56:59], v[244:247], v[28:31]
    ds_read_b128 v[48:51], v214 offset:4096
    v_mfma_f32_16x16x32_bf16 v[28:31], v[60:63], v[252:255], v[28:31]
    s_waitcnt lgkmcnt(3)
    v_mfma_f32_16x16x32_bf16 v[32:35], v[64:67], a[0:3], 0
    ds_read_b128 v[52:55], v214 offset:5120
    s_add_u32 s29, s36, 4
    v_mfma_f32_16x16x32_bf16 v[32:35], v[68:71], a[8:11], v[32:35]
    s_and_b32 s29, s29, 3
    s_lshl_b32 s29, s29, 1
    s_add_u32 s29, s29, 0
    v_mfma_f32_16x16x32_bf16 v[36:39], v[64:67], a[4:7], 0
    ds_read_b128 v[56:59], v214 offset:6144
    s_mul_i32 s29, s29, 148480
    v_mfma_f32_16x16x32_bf16 v[36:39], v[68:71], a[12:15], v[36:39]
    s_waitcnt lgkmcnt(3)
    s_add_u32 s29, s29, s27
    s_add_u32 m0, s30, 36864
    v_mfma_f32_16x16x32_bf16 v[32:35], v[72:75], a[16:19], v[32:35]
    ds_read_b128 v[60:63], v214 offset:7168
    s_add_u32 s28, s36, 2
    v_mfma_f32_16x16x32_bf16 v[32:35], v[76:79], a[24:27], v[32:35]
    buffer_load_dwordx4 v3, s[20:23], s29 offen offset:0 sc1 lds
    s_and_b32 s28, s28, 3
    v_mfma_f32_16x16x32_bf16 v[36:39], v[72:75], a[20:23], v[36:39]
    ds_read_b128 v[64:67], v214 offset:8192
    s_lshl_b32 s28, s28, 1
    v_mfma_f32_16x16x32_bf16 v[36:39], v[76:79], a[28:31], v[36:39]
    s_waitcnt lgkmcnt(3)
    buffer_load_dwordx4 v3, s[20:23], s29 offen offset:1024 sc1 lds
    v_mfma_f32_16x16x32_bf16 v[32:35], v[48:51], a[32:35], v[32:35]
    ds_read_b128 v[68:71], v214 offset:9216
    s_add_u32 s28, s28, 1
    v_mfma_f32_16x16x32_bf16 v[32:35], v[52:55], a[40:43], v[32:35]
    s_lshl_b32 s28, s28, 2
    s_add_u32 s28, s28, s36
    s_lshl_b32 s28, s28, 12
    v_mfma_f32_16x16x32_bf16 v[36:39], v[48:51], a[36:39], v[36:39]
    ds_read_b128 v[72:75], v214 offset:10240
    s_add_u32 s28, s28, s31
    v_mfma_f32_16x16x32_bf16 v[36:39], v[52:55], a[44:47], v[36:39]
    s_waitcnt lgkmcnt(3)
    buffer_load_dwordx4 v3, s[20:23], s29 offen offset:2048 sc1 lds
    v_mfma_f32_16x16x32_bf16 v[32:35], v[56:59], a[48:51], v[32:35]
    ds_read_b128 v[76:79], v214 offset:11264
    v_cvt_pk_bf16_f32 v216, v24, v25
    v_mfma_f32_16x16x32_bf16 v[32:35], v[60:63], a[56:59], v[32:35]
    v_cvt_pk_bf16_f32 v217, v26, v27
    v_cvt_pk_bf16_f32 v218, v28, v29
    v_mfma_f32_16x16x32_bf16 v[36:39], v[56:59], a[52:55], v[36:39]
    ds_read_b128 v[48:51], v214 offset:12288
    v_cvt_pk_bf16_f32 v219, v30, v31
    v_mfma_f32_16x16x32_bf16 v[36:39], v[60:63], a[60:63], v[36:39]
    s_waitcnt lgkmcnt(3)
    buffer_store_dwordx4 v[216:219], v6, s[20:23], s28 offen sc1
    v_mfma_f32_16x16x32_bf16 v[32:35], v[64:67], a[64:67], v[32:35]
    ds_read_b128 v[52:55], v214 offset:13312
    v_mfma_f32_16x16x32_bf16 v[32:35], v[68:71], a[72:75], v[32:35]
    v_mfma_f32_16x16x32_bf16 v[36:39], v[64:67], a[68:71], v[36:39]
    ds_read_b128 v[56:59], v214 offset:14336
    v_mfma_f32_16x16x32_bf16 v[36:39], v[68:71], a[76:79], v[36:39]
    s_waitcnt lgkmcnt(3)
    v_mfma_f32_16x16x32_bf16 v[32:35], v[72:75], a[80:83], v[32:35]
    ds_read_b128 v[60:63], v214 offset:15360
    v_mfma_f32_16x16x32_bf16 v[32:35], v[76:79], a[88:91], v[32:35]
    buffer_load_dwordx4 v3, s[20:23], s29 offen offset:3072 sc1 lds
    s_add_u32 s29, s29, 4096
    v_mfma_f32_16x16x32_bf16 v[36:39], v[72:75], a[84:87], v[36:39]
    ds_read_b128 v[64:67], v214 offset:16384
    s_add_u32 m0, s30, 40960
    v_mfma_f32_16x16x32_bf16 v[36:39], v[76:79], a[92:95], v[36:39]
    s_waitcnt lgkmcnt(3)
    buffer_load_dwordx4 v3, s[20:23], s29 offen offset:0 sc1 lds
    v_mfma_f32_16x16x32_bf16 v[32:35], v[48:51], a[96:99], v[32:35]
    ds_read_b128 v[68:71], v214 offset:17408
    v_mfma_f32_16x16x32_bf16 v[32:35], v[52:55], a[104:107], v[32:35]
    s_waitcnt vmcnt(12)
    ds_write_b128 v41, v[104:107] offset:0
    v_mfma_f32_16x16x32_bf16 v[36:39], v[48:51], a[100:103], v[36:39]
    ds_read_b128 v[72:75], v214 offset:18432
    v_mfma_f32_16x16x32_bf16 v[36:39], v[52:55], a[108:111], v[36:39]
    s_waitcnt lgkmcnt(4)
    ds_write_b128 v41, v[108:111] offset:1024
    v_mfma_f32_16x16x32_bf16 v[32:35], v[56:59], a[112:115], v[32:35]
    ds_read_b128 v[76:79], v214 offset:19456
    v_mfma_f32_16x16x32_bf16 v[32:35], v[60:63], a[120:123], v[32:35]
    buffer_load_dwordx4 v3, s[20:23], s29 offen offset:1024 sc1 lds
    v_mfma_f32_16x16x32_bf16 v[36:39], v[56:59], a[116:119], v[36:39]
    ds_read_b128 v[48:51], v214 offset:20480
    v_mfma_f32_16x16x32_bf16 v[36:39], v[60:63], a[124:127], v[36:39]
    s_waitcnt lgkmcnt(5)
    ds_write_b128 v41, v[112:115] offset:2048
    v_mfma_f32_16x16x32_bf16 v[32:35], v[64:67], a[128:131], v[32:35]
    ds_read_b128 v[52:55], v214 offset:21504
    v_mfma_f32_16x16x32_bf16 v[32:35], v[68:71], a[136:139], v[32:35]
    buffer_load_dwordx4 v3, s[20:23], s29 offen offset:2048 sc1 lds
    v_mfma_f32_16x16x32_bf16 v[36:39], v[64:67], a[132:135], v[36:39]
    ds_read_b128 v[56:59], v214 offset:22528
    s_waitcnt lgkmcnt(2)
    v_mfma_f32_16x16x32_bf16 v[36:39], v[68:71], a[140:143], v[36:39]
    ds_read_b64_tr_b16 v[92:93], v40 offset:0
    v_mfma_f32_16x16x32_bf16 v[32:35], v[72:75], a[144:147], v[32:35]
    ds_read_b128 v[60:63], v214 offset:23552
    v_mfma_f32_16x16x32_bf16 v[32:35], v[76:79], a[152:155], v[32:35]
    ds_read_b64_tr_b16 v[94:95], v40 offset:32
    v_mfma_f32_16x16x32_bf16 v[36:39], v[72:75], a[148:151], v[36:39]
    ds_read_b128 v[64:67], v214 offset:24576
    v_mfma_f32_16x16x32_bf16 v[36:39], v[76:79], a[156:159], v[36:39]
    s_waitcnt lgkmcnt(5)
    buffer_load_dwordx4 v3, s[20:23], s29 offen offset:3072 sc1 lds
    v_mfma_f32_16x16x32_bf16 v[32:35], v[48:51], a[160:163], v[32:35]
    ds_read_b128 v[68:71], v214 offset:25600
    s_add_u32 s29, s29, 4096
    v_mfma_f32_16x16x32_bf16 v[32:35], v[52:55], a[168:171], v[32:35]
    s_add_u32 m0, s30, 45056
    ds_read_b64_tr_b16 v[96:97], v40 offset:1024
    v_mfma_f32_16x16x32_bf16 v[36:39], v[48:51], a[164:167], v[36:39]
    ds_read_b128 v[72:75], v214 offset:26624
    v_mfma_f32_16x16x32_bf16 v[36:39], v[52:55], a[172:175], v[36:39]
    s_waitcnt lgkmcnt(5)
    ds_read_b64_tr_b16 v[98:99], v40 offset:1056
    v_mfma_f32_16x16x32_bf16 v[32:35], v[56:59], a[176:179], v[32:35]
    ds_read_b128 v[76:79], v214 offset:27648
    v_mfma_f32_16x16x32_bf16 v[32:35], v[60:63], a[184:187], v[32:35]
    buffer_load_dwordx4 v3, s[20:23], s29 offen offset:0 sc1 lds
    v_mfma_f32_16x16x32_bf16 v[36:39], v[56:59], a[180:183], v[36:39]
    ds_read_b128 v[48:51], v214 offset:28672
    v_mfma_f32_16x16x32_bf16 v[36:39], v[60:63], a[188:191], v[36:39]
    s_waitcnt lgkmcnt(5)
    ds_read_b64_tr_b16 v[100:101], v40 offset:2048
    v_mfma_f32_16x16x32_bf16 v[32:35], v[64:67], a[192:195], v[32:35]
    ds_read_b128 v[52:55], v214 offset:29696
    v_mfma_f32_16x16x32_bf16 v[32:35], v[68:71], a[200:203], v[32:35]
    ds_read_b64_tr_b16 v[102:103], v40 offset:2080
    v_mfma_f32_16x16x32_bf16 v[36:39], v[64:67], a[196:199], v[36:39]
    ds_read_b128 v[56:59], v214 offset:30720
    v_mfma_f32_16x16x32_bf16 v[36:39], v[68:71], a[204:207], v[36:39]
    s_waitcnt lgkmcnt(5)
    v_mfma_f32_16x16x32_bf16 v[32:35], v[72:75], a[208:211], v[32:35]
    ds_read_b128 v[60:63], v214 offset:31744
    s_waitcnt lgkmcnt(2)
    v_mfma_f32_16x16x32_bf16 v[32:35], v[76:79], a[216:219], v[32:35]
    v_lshlrev_b32 v104, 16, v92
    v_and_b32 v105, 0xffff0000, v92
    v_mfma_f32_16x16x32_bf16 v[36:39], v[72:75], a[212:215], v[36:39]
    ds_read_b128 v[64:67], v214 offset:32768
    v_lshlrev_b32 v106, 16, v93
    v_mfma_f32_16x16x32_bf16 v[36:39], v[76:79], a[220:223], v[36:39]
    v_and_b32 v107, 0xffff0000, v93
    v_lshlrev_b32 v44, 16, v80
    v_mfma_f32_16x16x32_bf16 v[32:35], v[48:51], a[224:227], v[32:35]
    ds_read_b128 v[68:71], v214 offset:33792
    v_and_b32 v45, 0xffff0000, v80
    v_mfma_f32_16x16x32_bf16 v[32:35], v[52:55], a[232:235], v[32:35]
    v_lshlrev_b32 v46, 16, v81
    v_and_b32 v47, 0xffff0000, v81
    v_mfma_f32_16x16x32_bf16 v[36:39], v[48:51], a[228:231], v[36:39]
    ds_read_b128 v[72:75], v214 offset:34816
    v_mul_f32 v104, v104, v44
    v_mfma_f32_16x16x32_bf16 v[36:39], v[52:55], a[236:239], v[36:39]
    s_waitcnt lgkmcnt(3)
    v_mul_f32 v105, v105, v45
    v_mul_f32 v106, v106, v46
    v_mfma_f32_16x16x32_bf16 v[32:35], v[56:59], a[240:243], v[32:35]
    ds_read_b128 v[76:79], v214 offset:35840
    v_mul_f32 v107, v107, v47
    v_mfma_f32_16x16x32_bf16 v[32:35], v[60:63], a[248:251], v[32:35]
    v_mul_f32 v104, v104, v204
    v_mul_f32 v105, v105, v204
    v_mfma_f32_16x16x32_bf16 v[36:39], v[56:59], a[244:247], v[36:39]
    s_waitcnt lgkmcnt(0)
    s_waitcnt vmcnt(10)
    s_barrier
    v_mfma_f32_16x16x32_bf16 v[36:39], v[60:63], a[252:255], v[36:39]
    ds_read_b128 v[48:51], v212 offset:0
    v_mul_f32 v106, v106, v204
    v_mfma_f32_16x16x32_bf16 v[32:35], v[64:67], v[224:227], v[32:35]
    ds_read_b128 v[52:55], v212 offset:1024
    v_mul_f32 v107, v107, v204
    v_mfma_f32_16x16x32_bf16 v[32:35], v[68:71], v[232:235], v[32:35]
    v_lshlrev_b32 v108, 16, v94
    v_and_b32 v109, 0xffff0000, v94
    v_mfma_f32_16x16x32_bf16 v[36:39], v[64:67], v[228:231], v[36:39]
    ds_read_b128 v[56:59], v212 offset:2048
    v_lshlrev_b32 v110, 16, v95
    v_mfma_f32_16x16x32_bf16 v[36:39], v[68:71], v[236:239], v[36:39]
    v_and_b32 v111, 0xffff0000, v95
    v_lshlrev_b32 v44, 16, v82
    v_mfma_f32_16x16x32_bf16 v[32:35], v[72:75], v[240:243], v[32:35]
    ds_read_b128 v[60:63], v212 offset:3072
    v_and_b32 v45, 0xffff0000, v82
    v_mfma_f32_16x16x32_bf16 v[32:35], v[76:79], v[248:251], v[32:35]
    v_lshlrev_b32 v46, 16, v83
    v_and_b32 v47, 0xffff0000, v83
    v_mfma_f32_16x16x32_bf16 v[36:39], v[72:75], v[244:247], v[36:39]
    ds_read_b128 v[64:67], v212 offset:4096
    v_mul_f32 v108, v108, v44
    v_mfma_f32_16x16x32_bf16 v[36:39], v[76:79], v[252:255], v[36:39]
    s_waitcnt lgkmcnt(3)
    v_mul_f32 v109, v109, v45
    v_mul_f32 v110, v110, v46
    v_mfma_f32_16x16x32_bf16 v[24:27], v[48:51], a[0:3], 0
    ds_read_b128 v[68:71], v212 offset:5120
    s_add_u32 s29, s36, 4
    v_mfma_f32_16x16x32_bf16 v[24:27], v[52:55], a[8:11], v[24:27]
    s_and_b32 s29, s29, 3
    s_lshl_b32 s29, s29, 1
    s_add_u32 s29, s29, 1
    v_mfma_f32_16x16x32_bf16 v[28:31], v[48:51], a[4:7], 0
    ds_read_b128 v[72:75], v212 offset:6144
    s_mul_i32 s29, s29, 148480
    v_mfma_f32_16x16x32_bf16 v[28:31], v[52:55], a[12:15], v[28:31]
    s_waitcnt lgkmcnt(3)
    buffer_load_dwordx4 v[128:131], v6, s[20:23], s44 offen sc1
    v_mfma_f32_16x16x32_bf16 v[24:27], v[56:59], a[16:19], v[24:27]
    ds_read_b128 v[76:79], v212 offset:7168
    s_add_u32 s29, s29, s27
    v_mfma_f32_16x16x32_bf16 v[24:27], v[60:63], a[24:27], v[24:27]
    buffer_load_dwordx4 v[132:135], v6, s[20:23], s45 offen sc1
    s_add_u32 m0, s30, 73728
    v_mfma_f32_16x16x32_bf16 v[28:31], v[56:59], a[20:23], v[28:31]
    ds_read_b128 v[48:51], v212 offset:8192
    s_add_u32 s28, s36, 3
    v_mfma_f32_16x16x32_bf16 v[28:31], v[60:63], a[28:31], v[28:31]
    s_waitcnt lgkmcnt(3)
    buffer_load_dwordx4 v[136:139], v6, s[20:23], s46 offen sc1
    v_mfma_f32_16x16x32_bf16 v[24:27], v[64:67], a[32:35], v[24:27]
    ds_read_b128 v[52:55], v212 offset:9216
    s_and_b32 s28, s28, 3
    v_mfma_f32_16x16x32_bf16 v[24:27], v[68:71], a[40:43], v[24:27]
    buffer_load_dwordx4 v[148:151], v6, s[20:23], s59 offen sc1
    s_lshl_b32 s28, s28, 1
    v_mfma_f32_16x16x32_bf16 v[28:31], v[64:67], a[36:39], v[28:31]
    ds_read_b128 v[56:59], v212 offset:10240
    s_add_u32 s28, s28, 0
    v_mfma_f32_16x16x32_bf16 v[28:31], v[68:71], a[44:47], v[28:31]
    s_waitcnt lgkmcnt(3)
    buffer_load_dwordx4 v[160:163], v6, s[20:23], s100 offen sc1
    v_mfma_f32_16x16x32_bf16 v[24:27], v[72:75], a[48:51], v[24:27]
    ds_read_b128 v[60:63], v212 offset:11264
    s_lshl_b32 s28, s28, 2
    v_mfma_f32_16x16x32_bf16 v[24:27], v[76:79], a[56:59], v[24:27]
    buffer_load_dwordx4 v3, s[20:23], s29 offen offset:0 sc1 lds
    s_add_u32 s28, s28, s36
    v_mfma_f32_16x16x32_bf16 v[28:31], v[72:75], a[52:55], v[28:31]
    ds_read_b128 v[64:67], v212 offset:12288
    s_lshl_b32 s28, s28, 12
    v_mfma_f32_16x16x32_bf16 v[28:31], v[76:79], a[60:63], v[28:31]
    s_waitcnt lgkmcnt(3)
    buffer_load_dwordx4 v3, s[20:23], s29 offen offset:1024 sc1 lds
    v_mfma_f32_16x16x32_bf16 v[24:27], v[48:51], a[64:67], v[24:27]
    ds_read_b128 v[68:71], v212 offset:13312
    s_add_u32 s28, s28, s31
    v_mfma_f32_16x16x32_bf16 v[24:27], v[52:55], a[72:75], v[24:27]
    buffer_load_dwordx4 v3, s[20:23], s29 offen offset:2048 sc1 lds
    v_cvt_pk_bf16_f32 v216, v32, v33
    v_mfma_f32_16x16x32_bf16 v[28:31], v[48:51], a[68:71], v[28:31]
    ds_read_b128 v[72:75], v212 offset:14336
    v_cvt_pk_bf16_f32 v217, v34, v35
    v_mfma_f32_16x16x32_bf16 v[28:31], v[52:55], a[76:79], v[28:31]
    s_waitcnt lgkmcnt(3)
    buffer_load_dwordx4 v3, s[20:23], s29 offen offset:3072 sc1 lds
    v_mfma_f32_16x16x32_bf16 v[24:27], v[56:59], a[80:83], v[24:27]
    ds_read_b128 v[76:79], v212 offset:15360
    s_add_u32 s29, s29, 4096
    v_mfma_f32_16x16x32_bf16 v[24:27], v[60:63], a[88:91], v[24:27]
    s_add_u32 m0, s30, 77824
    v_cvt_pk_bf16_f32 v218, v36, v37
    v_cvt_pk_bf16_f32 v219, v38, v39
    v_mfma_f32_16x16x32_bf16 v[28:31], v[56:59], a[84:87], v[28:31]
    ds_read_b128 v[48:51], v212 offset:16384
    v_mul_f32 v111, v111, v47
    v_mfma_f32_16x16x32_bf16 v[28:31], v[60:63], a[92:95], v[28:31]
    s_waitcnt lgkmcnt(3)
    buffer_store_dwordx4 v[216:219], v6, s[20:23], s28 offen sc1
    v_mfma_f32_16x16x32_bf16 v[24:27], v[64:67], a[96:99], v[24:27]
    ds_read_b128 v[52:55], v212 offset:17408
    v_mul_f32 v108, v108, v206
    v_mfma_f32_16x16x32_bf16 v[24:27], v[68:71], a[104:107], v[24:27]
    v_mul_f32 v109, v109, v206
    v_mul_f32 v110, v110, v206
    v_mfma_f32_16x16x32_bf16 v[28:31], v[64:67], a[100:103], v[28:31]
    ds_read_b128 v[56:59], v212 offset:18432
    v_mul_f32 v111, v111, v206
    v_mfma_f32_16x16x32_bf16 v[28:31], v[68:71], a[108:111], v[28:31]
    s_waitcnt lgkmcnt(3)
    v_lshlrev_b32 v112, 16, v96
    v_and_b32 v113, 0xffff0000, v96
    v_mfma_f32_16x16x32_bf16 v[24:27], v[72:75], a[112:115], v[24:27]
    ds_read_b128 v[60:63], v212 offset:19456
    v_lshlrev_b32 v114, 16, v97
    v_mfma_f32_16x16x32_bf16 v[24:27], v[76:79], a[120:123], v[24:27]
    buffer_load_dwordx4 v3, s[20:23], s29 offen offset:0 sc1 lds
    v_and_b32 v115, 0xffff0000, v97
    v_mfma_f32_16x16x32_bf16 v[28:31], v[72:75], a[116:119], v[28:31]
    ds_read_b128 v[64:67], v212 offset:20480
    v_lshlrev_b32 v44, 16, v84
    v_mfma_f32_16x16x32_bf16 v[28:31], v[76:79], a[124:127], v[28:31]
    s_waitcnt lgkmcnt(3)
    buffer_load_dwordx4 v3, s[20:23], s29 offen offset:1024 sc1 lds
    v_mfma_f32_16x16x32_bf16 v[24:27], v[48:51], a[128:131], v[24:27]
    ds_read_b128 v[68:71], v212 offset:21504
    v_and_b32 v45, 0xffff0000, v84
    v_mfma_f32_16x16x32_bf16 v[24:27], v[52:55], a[136:139], v[24:27]
    buffer_load_dwordx4 v3, s[20:23], s29 offen offset:2048 sc1 lds
    v_lshlrev_b32 v46, 16, v85
    v_mfma_f32_16x16x32_bf16 v[28:31], v[48:51], a[132:135], v[28:31]
    ds_read_b128 v[72:75], v212 offset:22528
    v_and_b32 v47, 0xffff0000, v85
    v_mfma_f32_16x16x32_bf16 v[28:31], v[52:55], a[140:143], v[28:31]
    s_waitcnt lgkmcnt(3)
    v_mul_f32 v112, v112, v44
    v_mul_f32 v113, v113, v45
    v_mfma_f32_16x16x32_bf16 v[24:27], v[56:59], a[144:147], v[24:27]
    ds_read_b128 v[76:79], v212 offset:23552
    v_mul_f32 v114, v114, v46
    v_mfma_f32_16x16x32_bf16 v[24:27], v[60:63], a[152:155], v[24:27]
    v_mul_f32 v115, v115, v47
    v_mul_f32 v112, v112, v204
    v_mfma_f32_16x16x32_bf16 v[28:31], v[56:59], a[148:151], v[28:31]
    ds_read_b128 v[48:51], v212 offset:24576
    v_mul_f32 v113, v113, v204
    v_mfma_f32_16x16x32_bf16 v[28:31], v[60:63], a[156:159], v[28:31]
    s_waitcnt lgkmcnt(3)
    buffer_load_dwordx4 v3, s[20:23], s29 offen offset:3072 sc1 lds
    v_mfma_f32_16x16x32_bf16 v[24:27], v[64:67], a[160:163], v[24:27]
    ds_read_b128 v[52:55], v212 offset:25600
    s_add_u32 s29, s29, 4096
    v_mfma_f32_16x16x32_bf16 v[24:27], v[68:71], a[168:171], v[24:27]
    s_add_u32 m0, s30, 81920
    v_mul_f32 v114, v114, v204
    v_mul_f32 v115, v115, v204
    v_mfma_f32_16x16x32_bf16 v[28:31], v[64:67], a[164:167], v[28:31]
    ds_read_b128 v[56:59], v212 offset:26624
    v_lshlrev_b32 v116, 16, v98
    v_mfma_f32_16x16x32_bf16 v[28:31], v[68:71], a[172:175], v[28:31]
    s_waitcnt lgkmcnt(3)
    v_and_b32 v117, 0xffff0000, v98
    v_lshlrev_b32 v118, 16, v99
    v_mfma_f32_16x16x32_bf16 v[24:27], v[72:75], a[176:179], v[24:27]
    ds_read_b128 v[60:63], v212 offset:27648
    v_and_b32 v119, 0xffff0000, v99
    v_mfma_f32_16x16x32_bf16 v[24:27], v[76:79], a[184:187], v[24:27]
    buffer_load_dwordx4 v3, s[20:23], s29 offen offset:0 sc1 lds
    v_lshlrev_b32 v44, 16, v86
    v_mfma_f32_16x16x32_bf16 v[28:31], v[72:75], a[180:183], v[28:31]
    ds_read_b128 v[64:67], v212 offset:28672
    v_and_b32 v45, 0xffff0000, v86
    v_mfma_f32_16x16x32_bf16 v[28:31], v[76:79], a[188:191], v[28:31]
    s_waitcnt lgkmcnt(3)
    v_lshlrev_b32 v46, 16, v87
    v_and_b32 v47, 0xffff0000, v87
    v_mfma_f32_16x16x32_bf16 v[24:27], v[48:51], a[192:195], v[24:27]
    ds_read_b128 v[68:71], v212 offset:29696
    v_mul_f32 v116, v116, v44
    v_mfma_f32_16x16x32_bf16 v[24:27], v[52:55], a[200:203], v[24:27]
    v_mul_f32 v117, v117, v45
    v_mul_f32 v118, v118, v46
    v_mfma_f32_16x16x32_bf16 v[28:31], v[48:51], a[196:199], v[28:31]
    ds_read_b128 v[72:75], v212 offset:30720
    v_mul_f32 v119, v119, v47
    v_mfma_f32_16x16x32_bf16 v[28:31], v[52:55], a[204:207], v[28:31]
    s_waitcnt lgkmcnt(3)
    v_mul_f32 v116, v116, v206
    v_mul_f32 v117, v117, v206
    v_mfma_f32_16x16x32_bf16 v[24:27], v[56:59], a[208:211], v[24:27]
    ds_read_b128 v[76:79], v212 offset:31744
    v_mul_f32 v118, v118, v206
    v_mfma_f32_16x16x32_bf16 v[24:27], v[60:63], a[216:219], v[24:27]
    v_mul_f32 v119, v119, v206
    v_lshlrev_b32 v120, 16, v100
    v_mfma_f32_16x16x32_bf16 v[28:31], v[56:59], a[212:215], v[28:31]
    ds_read_b128 v[48:51], v212 offset:32768
    v_and_b32 v121, 0xffff0000, v100
    v_mfma_f32_16x16x32_bf16 v[28:31], v[60:63], a[220:223], v[28:31]
    s_waitcnt lgkmcnt(3)
    v_lshlrev_b32 v122, 16, v101
    v_and_b32 v123, 0xffff0000, v101
    v_mfma_f32_16x16x32_bf16 v[24:27], v[64:67], a[224:227], v[24:27]
    ds_read_b128 v[52:55], v212 offset:33792
    v_lshlrev_b32 v44, 16, v88
    v_mfma_f32_16x16x32_bf16 v[24:27], v[68:71], a[232:235], v[24:27]
    v_and_b32 v45, 0xffff0000, v88
    v_lshlrev_b32 v46, 16, v89
    v_mfma_f32_16x16x32_bf16 v[28:31], v[64:67], a[228:231], v[28:31]
    ds_read_b128 v[56:59], v212 offset:34816
    v_and_b32 v47, 0xffff0000, v89
    v_mfma_f32_16x16x32_bf16 v[28:31], v[68:71], a[236:239], v[28:31]
    s_waitcnt lgkmcnt(3)
    v_mul_f32 v120, v120, v44
    v_mul_f32 v121, v121, v45
    v_mfma_f32_16x16x32_bf16 v[24:27], v[72:75], a[240:243], v[24:27]
    ds_read_b128 v[60:63], v212 offset:35840
    v_mul_f32 v122, v122, v46
    v_mfma_f32_16x16x32_bf16 v[24:27], v[76:79], a[248:251], v[24:27]
    v_mul_f32 v123, v123, v47
    v_mul_f32 v120, v120, v204
    v_mfma_f32_16x16x32_bf16 v[28:31], v[72:75], a[244:247], v[28:31]
    s_waitcnt lgkmcnt(0)
    s_waitcnt vmcnt(15)
    s_barrier
    v_mfma_f32_16x16x32_bf16 v[28:31], v[76:79], a[252:255], v[28:31]
    ds_read_b128 v[64:67], v213 offset:0
    v_mul_f32 v121, v121, v204
    v_mfma_f32_16x16x32_bf16 v[24:27], v[48:51], v[224:227], v[24:27]
    ds_read_b128 v[68:71], v213 offset:1024
    v_mul_f32 v122, v122, v204
    v_mfma_f32_16x16x32_bf16 v[24:27], v[52:55], v[232:235], v[24:27]
    v_mul_f32 v123, v123, v204
    v_lshlrev_b32 v124, 16, v102
    v_mfma_f32_16x16x32_bf16 v[28:31], v[48:51], v[228:231], v[28:31]
    ds_read_b128 v[72:75], v213 offset:2048
    v_and_b32 v125, 0xffff0000, v102
    v_mfma_f32_16x16x32_bf16 v[28:31], v[52:55], v[236:239], v[28:31]
    v_lshlrev_b32 v126, 16, v103
    v_and_b32 v127, 0xffff0000, v103
    v_mfma_f32_16x16x32_bf16 v[24:27], v[56:59], v[240:243], v[24:27]
    ds_read_b128 v[76:79], v213 offset:3072
    v_lshlrev_b32 v44, 16, v90
    v_mfma_f32_16x16x32_bf16 v[24:27], v[60:63], v[248:251], v[24:27]
    v_and_b32 v45, 0xffff0000, v90
    v_lshlrev_b32 v46, 16, v91
    v_mfma_f32_16x16x32_bf16 v[28:31], v[56:59], v[244:247], v[28:31]
    ds_read_b128 v[48:51], v213 offset:4096
    v_and_b32 v47, 0xffff0000, v91
    v_mfma_f32_16x16x32_bf16 v[28:31], v[60:63], v[252:255], v[28:31]
    s_waitcnt lgkmcnt(3)
    v_mul_f32 v124, v124, v44
    v_mul_f32 v125, v125, v45
    v_mfma_f32_16x16x32_bf16 v[32:35], v[64:67], a[0:3], 0
    ds_read_b128 v[52:55], v213 offset:5120
    v_mul_f32 v126, v126, v46
    v_mfma_f32_16x16x32_bf16 v[32:35], v[68:71], a[8:11], v[32:35]
    v_mul_f32 v127, v127, v47
    v_mul_f32 v124, v124, v206
    v_mfma_f32_16x16x32_bf16 v[36:39], v[64:67], a[4:7], 0
    ds_read_b128 v[56:59], v213 offset:6144
    s_add_u32 s28, s36, 3
    v_mfma_f32_16x16x32_bf16 v[36:39], v[68:71], a[12:15], v[36:39]
    s_waitcnt lgkmcnt(3)
    s_and_b32 s28, s28, 3
    s_lshl_b32 s28, s28, 1
    v_mfma_f32_16x16x32_bf16 v[32:35], v[72:75], a[16:19], v[32:35]
    ds_read_b128 v[60:63], v213 offset:7168
    s_add_u32 s28, s28, 1
    v_mfma_f32_16x16x32_bf16 v[32:35], v[76:79], a[24:27], v[32:35]
    s_lshl_b32 s28, s28, 2
    s_add_u32 s28, s28, s36
    s_lshl_b32 s28, s28, 12
    v_mfma_f32_16x16x32_bf16 v[36:39], v[72:75], a[20:23], v[36:39]
    ds_read_b128 v[64:67], v213 offset:8192
    s_add_u32 s28, s28, s31
    v_mfma_f32_16x16x32_bf16 v[36:39], v[76:79], a[28:31], v[36:39]
    s_waitcnt lgkmcnt(3)
    v_cvt_pk_bf16_f32 v216, v24, v25
    v_cvt_pk_bf16_f32 v217, v26, v27
    v_mfma_f32_16x16x32_bf16 v[32:35], v[48:51], a[32:35], v[32:35]
    ds_read_b128 v[68:71], v213 offset:9216
    v_cvt_pk_bf16_f32 v218, v28, v29
    v_mfma_f32_16x16x32_bf16 v[32:35], v[52:55], a[40:43], v[32:35]
    v_cvt_pk_bf16_f32 v219, v30, v31
    v_mul_f32 v125, v125, v206
    v_mfma_f32_16x16x32_bf16 v[36:39], v[48:51], a[36:39], v[36:39]
    ds_read_b128 v[72:75], v213 offset:10240
    v_mul_f32 v126, v126, v206
    v_mfma_f32_16x16x32_bf16 v[36:39], v[52:55], a[44:47], v[36:39]
    s_waitcnt lgkmcnt(3)
    buffer_store_dwordx4 v[216:219], v6, s[20:23], s28 offen sc1
    v_mfma_f32_16x16x32_bf16 v[32:35], v[56:59], a[48:51], v[32:35]
    ds_read_b128 v[76:79], v213 offset:11264
    s_waitcnt vmcnt(11)
    v_mfma_f32_16x16x32_bf16 v[32:35], v[60:63], a[56:59], v[32:35]
    v_mul_f32 v127, v127, v206
    v_max_u32 v188, v128, v129
    v_mfma_f32_16x16x32_bf16 v[36:39], v[56:59], a[52:55], v[36:39]
    ds_read_b128 v[48:51], v213 offset:12288
    v_max3_u32 v188, v188, v130, v131
    v_mfma_f32_16x16x32_bf16 v[36:39], v[60:63], a[60:63], v[36:39]
    s_waitcnt lgkmcnt(3)
    v_max3_u32 v188, v188, v132, v133
    v_max3_u32 v188, v188, v134, v135
    v_mfma_f32_16x16x32_bf16 v[32:35], v[64:67], a[64:67], v[32:35]
    ds_read_b128 v[52:55], v213 offset:13312
    v_max3_u32 v188, v188, v136, v137
    v_mfma_f32_16x16x32_bf16 v[32:35], v[68:71], a[72:75], v[32:35]
    v_max3_u32 v188, v188, v138, v139
    v_max3_u32 v188, v188, v160, v161
    v_mfma_f32_16x16x32_bf16 v[36:39], v[64:67], a[68:71], v[36:39]
    ds_read_b128 v[56:59], v213 offset:14336
    v_max3_u32 v188, v188, v162, v163
    v_mfma_f32_16x16x32_bf16 v[36:39], v[68:71], a[76:79], v[36:39]
    s_waitcnt lgkmcnt(3)
    v_lshlrev_b32 v164, 16, v128
    v_and_b32 v165, 0xffff0000, v128
    v_mfma_f32_16x16x32_bf16 v[32:35], v[72:75], a[80:83], v[32:35]
    ds_read_b128 v[60:63], v213 offset:15360
    v_lshlrev_b32 v166, 16, v129
    v_mfma_f32_16x16x32_bf16 v[32:35], v[76:79], a[88:91], v[32:35]
    v_and_b32 v167, 0xffff0000, v129
    v_lshlrev_b32 v168, 16, v130
    v_mfma_f32_16x16x32_bf16 v[36:39], v[72:75], a[84:87], v[36:39]
    ds_read_b128 v[64:67], v213 offset:16384
    v_and_b32 v169, 0xffff0000, v130
    v_mfma_f32_16x16x32_bf16 v[36:39], v[76:79], a[92:95], v[36:39]
    s_waitcnt lgkmcnt(3)
    v_lshlrev_b32 v170, 16, v131
    v_and_b32 v171, 0xffff0000, v131
    v_mfma_f32_16x16x32_bf16 v[32:35], v[48:51], a[96:99], v[32:35]
    ds_read_b128 v[68:71], v213 offset:17408
    v_lshlrev_b32 v172, 16, v132
    v_mfma_f32_16x16x32_bf16 v[32:35], v[52:55], a[104:107], v[32:35]
    v_and_b32 v173, 0xffff0000, v132
    v_lshlrev_b32 v174, 16, v133
    v_mfma_f32_16x16x32_bf16 v[36:39], v[48:51], a[100:103], v[36:39]
    ds_read_b128 v[72:75], v213 offset:18432
    v_and_b32 v175, 0xffff0000, v133
    v_mfma_f32_16x16x32_bf16 v[36:39], v[52:55], a[108:111], v[36:39]
    s_waitcnt lgkmcnt(3)
    v_lshlrev_b32 v176, 16, v134
    v_and_b32 v177, 0xffff0000, v134
    v_mfma_f32_16x16x32_bf16 v[32:35], v[56:59], a[112:115], v[32:35]
    ds_read_b128 v[76:79], v213 offset:19456
    v_lshlrev_b32 v178, 16, v135
    v_mfma_f32_16x16x32_bf16 v[32:35], v[60:63], a[120:123], v[32:35]
    v_and_b32 v179, 0xffff0000, v135
    v_lshlrev_b32 v180, 16, v136
    v_mfma_f32_16x16x32_bf16 v[36:39], v[56:59], a[116:119], v[36:39]
    ds_read_b128 v[48:51], v213 offset:20480
    v_and_b32 v181, 0xffff0000, v136
    v_mfma_f32_16x16x32_bf16 v[36:39], v[60:63], a[124:127], v[36:39]
    s_waitcnt lgkmcnt(3)
    buffer_load_dwordx4 v[140:143], v6, s[20:23], s57 offen sc1
    v_mfma_f32_16x16x32_bf16 v[32:35], v[64:67], a[128:131], v[32:35]
    ds_read_b128 v[52:55], v213 offset:21504
    v_lshlrev_b32 v182, 16, v137
    v_mfma_f32_16x16x32_bf16 v[32:35], v[68:71], a[136:139], v[32:35]
    buffer_load_dwordx4 v[144:147], v6, s[20:23], s58 offen sc1
    v_and_b32 v183, 0xffff0000, v137
    v_mfma_f32_16x16x32_bf16 v[36:39], v[64:67], a[132:135], v[36:39]
    ds_read_b128 v[56:59], v213 offset:22528
    v_lshlrev_b32 v184, 16, v138
    v_mfma_f32_16x16x32_bf16 v[36:39], v[68:71], a[140:143], v[36:39]
    s_waitcnt lgkmcnt(3)
    v_and_b32 v185, 0xffff0000, v138
    v_lshlrev_b32 v186, 16, v139
    v_mfma_f32_16x16x32_bf16 v[32:35], v[72:75], a[144:147], v[32:35]
    ds_read_b128 v[60:63], v213 offset:23552
    v_and_b32 v187, 0xffff0000, v139
    v_mfma_f32_16x16x32_bf16 v[32:35], v[76:79], a[152:155], v[32:35]
    v_fmac_f32 v120, v205, v16
    v_fmac_f32 v121, v205, v17
    v_mfma_f32_16x16x32_bf16 v[36:39], v[72:75], a[148:151], v[36:39]
    ds_read_b128 v[64:67], v213 offset:24576
    v_fmac_f32 v122, v205, v18
    v_mfma_f32_16x16x32_bf16 v[36:39], v[76:79], a[156:159], v[36:39]
    s_waitcnt lgkmcnt(3)
    v_fmac_f32 v123, v205, v19
    v_fmac_f32 v124, v207, v20
    v_mfma_f32_16x16x32_bf16 v[32:35], v[48:51], a[160:163], v[32:35]
    ds_read_b128 v[68:71], v213 offset:25600
    v_fmac_f32 v125, v207, v21
    v_mfma_f32_16x16x32_bf16 v[32:35], v[52:55], a[168:171], v[32:35]
    v_fmac_f32 v126, v207, v22
    v_fmac_f32 v127, v207, v23
    v_mfma_f32_16x16x32_bf16 v[36:39], v[48:51], a[164:167], v[36:39]
    ds_read_b128 v[72:75], v213 offset:26624
    v_mfma_f32_16x16x32_bf16 v[36:39], v[52:55], a[172:175], v[36:39]
    s_waitcnt lgkmcnt(3)
    v_mfma_f32_16x16x32_bf16 v[32:35], v[56:59], a[176:179], v[32:35]
    ds_read_b128 v[76:79], v213 offset:27648
    v_mfma_f32_16x16x32_bf16 v[32:35], v[60:63], a[184:187], v[32:35]
    v_mfma_f32_16x16x32_bf16 v[36:39], v[56:59], a[180:183], v[36:39]
    ds_read_b128 v[48:51], v213 offset:28672
    v_mfma_f32_16x16x32_bf16 v[36:39], v[60:63], a[188:191], v[36:39]
    s_waitcnt lgkmcnt(3)
    v_mfma_f32_16x16x32_bf16 v[32:35], v[64:67], a[192:195], v[32:35]
    ds_read_b128 v[52:55], v213 offset:29696
    v_mfma_f32_16x16x32_bf16 v[32:35], v[68:71], a[200:203], v[32:35]
    v_mfma_f32_16x16x32_bf16 v[36:39], v[64:67], a[196:199], v[36:39]
    ds_read_b128 v[56:59], v213 offset:30720
    v_mfma_f32_16x16x32_bf16 v[36:39], v[68:71], a[204:207], v[36:39]
    s_waitcnt lgkmcnt(3)
    v_mfma_f32_16x16x32_bf16 v[32:35], v[72:75], a[208:211], v[32:35]
    ds_read_b128 v[60:63], v213 offset:31744
    v_mfma_f32_16x16x32_bf16 v[32:35], v[76:79], a[216:219], v[32:35]
    v_mfma_f32_16x16x32_bf16 v[36:39], v[72:75], a[212:215], v[36:39]
    ds_read_b128 v[64:67], v213 offset:32768
    v_mfma_f32_16x16x32_bf16 v[36:39], v[76:79], a[220:223], v[36:39]
    s_waitcnt lgkmcnt(3)
    v_mfma_f32_16x16x32_bf16 v[32:35], v[48:51], a[224:227], v[32:35]
    ds_read_b128 v[68:71], v213 offset:33792
    v_mfma_f32_16x16x32_bf16 v[32:35], v[52:55], a[232:235], v[32:35]
    v_mfma_f32_16x16x32_bf16 v[36:39], v[48:51], a[228:231], v[36:39]
    ds_read_b128 v[72:75], v213 offset:34816
    v_mfma_f32_16x16x32_bf16 v[36:39], v[52:55], a[236:239], v[36:39]
    s_waitcnt lgkmcnt(3)
    v_mfma_f32_16x16x32_bf16 v[32:35], v[56:59], a[240:243], v[32:35]
    ds_read_b128 v[76:79], v213 offset:35840
    v_mfma_f32_16x16x32_bf16 v[32:35], v[60:63], a[248:251], v[32:35]
    v_mfma_f32_16x16x32_bf16 v[36:39], v[56:59], a[244:247], v[36:39]
    s_waitcnt lgkmcnt(0)
    s_waitcnt vmcnt(3)
    s_barrier
    v_mfma_f32_16x16x32_bf16 v[36:39], v[60:63], a[252:255], v[36:39]
    ds_read_b128 v[48:51], v214 offset:0
    v_mfma_f32_16x16x32_bf16 v[32:35], v[64:67], v[224:227], v[32:35]
    ds_read_b128 v[52:55], v214 offset:1024
    v_mfma_f32_16x16x32_bf16 v[32:35], v[68:71], v[232:235], v[32:35]
    v_mfma_f32_16x16x32_bf16 v[36:39], v[64:67], v[228:231], v[36:39]
    ds_read_b128 v[56:59], v214 offset:2048
    v_mfma_f32_16x16x32_bf16 v[36:39], v[68:71], v[236:239], v[36:39]
    v_mfma_f32_16x16x32_bf16 v[32:35], v[72:75], v[240:243], v[32:35]
    ds_read_b128 v[60:63], v214 offset:3072
    v_mfma_f32_16x16x32_bf16 v[32:35], v[76:79], v[248:251], v[32:35]
    v_mfma_f32_16x16x32_bf16 v[36:39], v[72:75], v[244:247], v[36:39]
    ds_read_b128 v[64:67], v214 offset:4096
    v_mfma_f32_16x16x32_bf16 v[36:39], v[76:79], v[252:255], v[36:39]
    s_waitcnt lgkmcnt(3)
    v_mfma_f32_16x16x32_bf16 v[24:27], v[48:51], a[0:3], 0
    ds_read_b128 v[68:71], v214 offset:5120
    v_mfma_f32_16x16x32_bf16 v[24:27], v[52:55], a[8:11], v[24:27]
    v_mfma_f32_16x16x32_bf16 v[28:31], v[48:51], a[4:7], 0
    ds_read_b128 v[72:75], v214 offset:6144
    v_mfma_f32_16x16x32_bf16 v[28:31], v[52:55], a[12:15], v[28:31]
    s_waitcnt lgkmcnt(3)
    v_mfma_f32_16x16x32_bf16 v[24:27], v[56:59], a[16:19], v[24:27]
    ds_read_b128 v[76:79], v214 offset:7168
    v_mfma_f32_16x16x32_bf16 v[24:27], v[60:63], a[24:27], v[24:27]
    v_mfma_f32_16x16x32_bf16 v[28:31], v[56:59], a[20:23], v[28:31]
    ds_read_b128 v[48:51], v214 offset:8192
    v_mfma_f32_16x16x32_bf16 v[28:31], v[60:63], a[28:31], v[28:31]
    s_waitcnt lgkmcnt(3)
    v_mfma_f32_16x16x32_bf16 v[24:27], v[64:67], a[32:35], v[24:27]
    ds_read_b128 v[52:55], v214 offset:9216
    v_fmac_f32 v104, v205, v32
    v_mfma_f32_16x16x32_bf16 v[24:27], v[68:71], a[40:43], v[24:27]
    v_fmac_f32 v105, v205, v33
    v_fmac_f32 v106, v205, v34
    v_mfma_f32_16x16x32_bf16 v[28:31], v[64:67], a[36:39], v[28:31]
    ds_read_b128 v[56:59], v214 offset:10240
    v_fmac_f32 v107, v205, v35
    v_mfma_f32_16x16x32_bf16 v[28:31], v[68:71], a[44:47], v[28:31]
    s_waitcnt lgkmcnt(3)
    v_fmac_f32 v108, v207, v36
    v_fmac_f32 v109, v207, v37
    v_mfma_f32_16x16x32_bf16 v[24:27], v[72:75], a[48:51], v[24:27]
    ds_read_b128 v[60:63], v214 offset:11264
    v_fmac_f32 v110, v207, v38
    v_mfma_f32_16x16x32_bf16 v[24:27], v[76:79], a[56:59], v[24:27]
    v_fmac_f32 v111, v207, v39
    v_mfma_f32_16x16x32_bf16 v[28:31], v[72:75], a[52:55], v[28:31]
    ds_read_b128 v[64:67], v214 offset:12288
    v_mfma_f32_16x16x32_bf16 v[28:31], v[76:79], a[60:63], v[28:31]
    s_waitcnt lgkmcnt(3)
    v_mfma_f32_16x16x32_bf16 v[24:27], v[48:51], a[64:67], v[24:27]
    ds_read_b128 v[68:71], v214 offset:13312
    v_mfma_f32_16x16x32_bf16 v[24:27], v[52:55], a[72:75], v[24:27]
    v_mfma_f32_16x16x32_bf16 v[28:31], v[48:51], a[68:71], v[28:31]
    ds_read_b128 v[72:75], v214 offset:14336
    v_mfma_f32_16x16x32_bf16 v[28:31], v[52:55], a[76:79], v[28:31]
    s_waitcnt lgkmcnt(3)
    v_mfma_f32_16x16x32_bf16 v[24:27], v[56:59], a[80:83], v[24:27]
    ds_read_b128 v[76:79], v214 offset:15360
    v_mfma_f32_16x16x32_bf16 v[24:27], v[60:63], a[88:91], v[24:27]
    s_waitcnt vmcnt(0)
    v_max3_u32 v188, v188, v140, v141
    v_max3_u32 v188, v188, v142, v143
    v_mfma_f32_16x16x32_bf16 v[28:31], v[56:59], a[84:87], v[28:31]
    ds_read_b128 v[48:51], v214 offset:16384
    v_max3_u32 v188, v188, v144, v145
    v_mfma_f32_16x16x32_bf16 v[28:31], v[60:63], a[92:95], v[28:31]
    s_waitcnt lgkmcnt(3)
    buffer_load_dwordx4 v[152:155], v6, s[20:23], s98 offen sc1
    v_mfma_f32_16x16x32_bf16 v[24:27], v[64:67], a[96:99], v[24:27]
    ds_read_b128 v[52:55], v214 offset:17408
    v_max3_u32 v188, v188, v146, v147
    v_mfma_f32_16x16x32_bf16 v[24:27], v[68:71], a[104:107], v[24:27]
    buffer_load_dwordx4 v[156:159], v6, s[20:23], s99 offen sc1
    v_max3_u32 v188, v188, v148, v149
    v_mfma_f32_16x16x32_bf16 v[28:31], v[64:67], a[100:103], v[28:31]
    ds_read_b128 v[56:59], v214 offset:18432
    v_max3_u32 v188, v188, v150, v151
    v_mfma_f32_16x16x32_bf16 v[28:31], v[68:71], a[108:111], v[28:31]
    s_waitcnt lgkmcnt(3)
    v_lshlrev_b32 v190, 16, v140
    v_and_b32 v191, 0xffff0000, v140
    v_mfma_f32_16x16x32_bf16 v[24:27], v[72:75], a[112:115], v[24:27]
    ds_read_b128 v[60:63], v214 offset:19456
    v_add_f32 v164, v164, v190
    v_mfma_f32_16x16x32_bf16 v[24:27], v[76:79], a[120:123], v[24:27]
    v_add_f32 v165, v165, v191
    v_lshlrev_b32 v190, 16, v141
    v_mfma_f32_16x16x32_bf16 v[28:31], v[72:75], a[116:119], v[28:31]
    ds_read_b128 v[64:67], v214 offset:20480
    v_and_b32 v191, 0xffff0000, v141
    v_mfma_f32_16x16x32_bf16 v[28:31], v[76:79], a[124:127], v[28:31]
    s_waitcnt lgkmcnt(3)
    v_add_f32 v166, v166, v190
    v_add_f32 v167, v167, v191
    v_mfma_f32_16x16x32_bf16 v[24:27], v[48:51], a[128:131], v[24:27]
    ds_read_b128 v[68:71], v214 offset:21504
    v_lshlrev_b32 v190, 16, v142
    v_mfma_f32_16x16x32_bf16 v[24:27], v[52:55], a[136:139], v[24:27]
    v_and_b32 v191, 0xffff0000, v142
    v_add_f32 v168, v168, v190
    v_mfma_f32_16x16x32_bf16 v[28:31], v[48:51], a[132:135], v[28:31]
    ds_read_b128 v[72:75], v214 offset:22528
    v_add_f32 v169, v169, v191
    v_mfma_f32_16x16x32_bf16 v[28:31], v[52:55], a[140:143], v[28:31]
    s_waitcnt lgkmcnt(3)
    v_lshlrev_b32 v190, 16, v143
    v_and_b32 v191, 0xffff0000, v143
    v_mfma_f32_16x16x32_bf16 v[24:27], v[56:59], a[144:147], v[24:27]
    ds_read_b128 v[76:79], v214 offset:23552
    v_add_f32 v170, v170, v190
    v_mfma_f32_16x16x32_bf16 v[24:27], v[60:63], a[152:155], v[24:27]
    v_add_f32 v171, v171, v191
    v_lshlrev_b32 v190, 16, v144
    v_mfma_f32_16x16x32_bf16 v[28:31], v[56:59], a[148:151], v[28:31]
    ds_read_b128 v[48:51], v214 offset:24576
    v_and_b32 v191, 0xffff0000, v144
    v_mfma_f32_16x16x32_bf16 v[28:31], v[60:63], a[156:159], v[28:31]
    s_waitcnt lgkmcnt(3)
    v_add_f32 v172, v172, v190
    v_add_f32 v173, v173, v191
    v_mfma_f32_16x16x32_bf16 v[24:27], v[64:67], a[160:163], v[24:27]
    ds_read_b128 v[52:55], v214 offset:25600
    v_lshlrev_b32 v190, 16, v145
    v_mfma_f32_16x16x32_bf16 v[24:27], v[68:71], a[168:171], v[24:27]
    v_and_b32 v191, 0xffff0000, v145
    v_add_f32 v174, v174, v190
    v_mfma_f32_16x16x32_bf16 v[28:31], v[64:67], a[164:167], v[28:31]
    ds_read_b128 v[56:59], v214 offset:26624
    v_add_f32 v175, v175, v191
    v_mfma_f32_16x16x32_bf16 v[28:31], v[68:71], a[172:175], v[28:31]
    s_waitcnt lgkmcnt(3)
    v_lshlrev_b32 v190, 16, v146
    v_and_b32 v191, 0xffff0000, v146
    v_mfma_f32_16x16x32_bf16 v[24:27], v[72:75], a[176:179], v[24:27]
    ds_read_b128 v[60:63], v214 offset:27648
    v_add_f32 v176, v176, v190
    v_mfma_f32_16x16x32_bf16 v[24:27], v[76:79], a[184:187], v[24:27]
    v_add_f32 v177, v177, v191
    v_lshlrev_b32 v190, 16, v147
    v_mfma_f32_16x16x32_bf16 v[28:31], v[72:75], a[180:183], v[28:31]
    ds_read_b128 v[64:67], v214 offset:28672
    v_and_b32 v191, 0xffff0000, v147
    v_mfma_f32_16x16x32_bf16 v[28:31], v[76:79], a[188:191], v[28:31]
    s_waitcnt lgkmcnt(3)
    v_add_f32 v178, v178, v190
    v_add_f32 v179, v179, v191
    v_mfma_f32_16x16x32_bf16 v[24:27], v[48:51], a[192:195], v[24:27]
    ds_read_b128 v[68:71], v214 offset:29696
    v_lshlrev_b32 v190, 16, v148
    v_mfma_f32_16x16x32_bf16 v[24:27], v[52:55], a[200:203], v[24:27]
    v_and_b32 v191, 0xffff0000, v148
    v_add_f32 v180, v180, v190
    v_mfma_f32_16x16x32_bf16 v[28:31], v[48:51], a[196:199], v[28:31]
    ds_read_b128 v[72:75], v214 offset:30720
    v_add_f32 v181, v181, v191
    v_mfma_f32_16x16x32_bf16 v[28:31], v[52:55], a[204:207], v[28:31]
    s_waitcnt lgkmcnt(3)
    v_lshlrev_b32 v190, 16, v149
    v_and_b32 v191, 0xffff0000, v149
    v_mfma_f32_16x16x32_bf16 v[24:27], v[56:59], a[208:211], v[24:27]
    ds_read_b128 v[76:79], v214 offset:31744
    v_add_f32 v182, v182, v190
    v_mfma_f32_16x16x32_bf16 v[24:27], v[60:63], a[216:219], v[24:27]
    v_add_f32 v183, v183, v191
    v_lshlrev_b32 v190, 16, v150
    v_mfma_f32_16x16x32_bf16 v[28:31], v[56:59], a[212:215], v[28:31]
    ds_read_b128 v[48:51], v214 offset:32768
    v_and_b32 v191, 0xffff0000, v150
    v_mfma_f32_16x16x32_bf16 v[28:31], v[60:63], a[220:223], v[28:31]
    s_waitcnt lgkmcnt(3)
    v_add_f32 v184, v184, v190
    v_add_f32 v185, v185, v191
    v_mfma_f32_16x16x32_bf16 v[24:27], v[64:67], a[224:227], v[24:27]
    ds_read_b128 v[52:55], v214 offset:33792
    v_lshlrev_b32 v190, 16, v151
    v_mfma_f32_16x16x32_bf16 v[24:27], v[68:71], a[232:235], v[24:27]
    v_and_b32 v191, 0xffff0000, v151
    v_add_f32 v186, v186, v190
    v_mfma_f32_16x16x32_bf16 v[28:31], v[64:67], a[228:231], v[28:31]
    ds_read_b128 v[56:59], v214 offset:34816
    v_add_f32 v187, v187, v191
    v_mfma_f32_16x16x32_bf16 v[28:31], v[68:71], a[236:239], v[28:31]
    s_waitcnt lgkmcnt(3)
    v_mfma_f32_16x16x32_bf16 v[24:27], v[72:75], a[240:243], v[24:27]
    ds_read_b128 v[60:63], v214 offset:35840
    v_mfma_f32_16x16x32_bf16 v[24:27], v[76:79], a[248:251], v[24:27]
    v_mfma_f32_16x16x32_bf16 v[28:31], v[72:75], a[244:247], v[28:31]
    v_mfma_f32_16x16x32_bf16 v[28:31], v[76:79], a[252:255], v[28:31]
    s_waitcnt lgkmcnt(2)
    v_mfma_f32_16x16x32_bf16 v[24:27], v[48:51], v[224:227], v[24:27]
    v_mfma_f32_16x16x32_bf16 v[24:27], v[52:55], v[232:235], v[24:27]
    v_mfma_f32_16x16x32_bf16 v[28:31], v[48:51], v[228:231], v[28:31]
    v_mfma_f32_16x16x32_bf16 v[28:31], v[52:55], v[236:239], v[28:31]
    s_waitcnt lgkmcnt(0)
    v_mfma_f32_16x16x32_bf16 v[24:27], v[56:59], v[240:243], v[24:27]
    v_mfma_f32_16x16x32_bf16 v[24:27], v[60:63], v[248:251], v[24:27]
    v_mfma_f32_16x16x32_bf16 v[28:31], v[56:59], v[244:247], v[28:31]
    v_mfma_f32_16x16x32_bf16 v[28:31], v[60:63], v[252:255], v[28:31]
    s_mov_b32 s16, s14
    s_mov_b32 s17, s15
    s_mov_b32 s18, 0x240000
    s_mov_b32 s19, 0x20000
    s_cmp_eq_u32 s24, s36
    s_cselect_b32 s51, s51, 2147483632
    s_nop 3
    v_fmac_f32 v112, v205, v24
    v_fmac_f32 v113, v205, v25
    v_fmac_f32 v114, v205, v26
    v_fmac_f32 v115, v205, v27
    v_fmac_f32 v116, v207, v28
    v_fmac_f32 v117, v207, v29
    v_fmac_f32 v118, v207, v30
    v_fmac_f32 v119, v207, v31
    v_cmp_eq_u32 vcc, -1, v188
    s_nop 1
    s_cmp_eq_u64 vcc, 0
    s_cbranch_scc0 L_spin_r12
L_back_r12:
    s_waitcnt vmcnt(0)
    v_max3_u32 v188, v152, v153, v154
    v_max3_u32 v189, v155, v156, v157
    v_max3_u32 v188, v188, v158, v159
    v_max_u32 v188, v188, v189
    v_cmp_eq_u32 vcc, -1, v188
    s_nop 1
    s_cmp_eq_u64 vcc, 0
    s_cbranch_scc0 L_spin_r3
L_back_r3:
    v_lshlrev_b32 v190, 16, v152
    v_and_b32 v191, 0xffff0000, v152
    v_add_f32 v164, v164, v190
    v_add_f32 v165, v165, v191
    v_lshlrev_b32 v190, 16, v153
    v_and_b32 v191, 0xffff0000, v153
    v_add_f32 v166, v166, v190
    v_add_f32 v167, v167, v191
    v_lshlrev_b32 v190, 16, v154
    v_and_b32 v191, 0xffff0000, v154
    v_add_f32 v168, v168, v190
    v_add_f32 v169, v169, v191
    v_lshlrev_b32 v190, 16, v155
    v_and_b32 v191, 0xffff0000, v155
    v_add_f32 v170, v170, v190
    v_add_f32 v171, v171, v191
    v_lshlrev_b32 v190, 16, v156
    v_and_b32 v191, 0xffff0000, v156
    v_add_f32 v172, v172, v190
    v_add_f32 v173, v173, v191
    v_lshlrev_b32 v190, 16, v157
    v_and_b32 v191, 0xffff0000, v157
    v_add_f32 v174, v174, v190
    v_add_f32 v175, v175, v191
    v_lshlrev_b32 v190, 16, v158
    v_and_b32 v191, 0xffff0000, v158
    v_add_f32 v176, v176, v190
    v_add_f32 v177, v177, v191
    v_lshlrev_b32 v190, 16, v159
    v_and_b32 v191, 0xffff0000, v159
    v_add_f32 v178, v178, v190
    v_add_f32 v179, v179, v191
    v_lshlrev_b32 v190, 16, v160
    v_and_b32 v191, 0xffff0000, v160
    v_add_f32 v180, v180, v190
    v_add_f32 v181, v181, v191
    v_lshlrev_b32 v190, 16, v161
    v_and_b32 v191, 0xffff0000, v161
    v_add_f32 v182, v182, v190
    v_add_f32 v183, v183, v191
    v_lshlrev_b32 v190, 16, v162
    v_and_b32 v191, 0xffff0000, v162
    v_add_f32 v184, v184, v190
    v_add_f32 v185, v185, v191
    v_lshlrev_b32 v190, 16, v163
    v_and_b32 v191, 0xffff0000, v163
    v_add_f32 v186, v186, v190
    v_add_f32 v187, v187, v191
    v_fmac_f32 v104, v205, v164
    v_fmac_f32 v105, v205, v165
    v_fmac_f32 v106, v205, v166
    v_fmac_f32 v107, v205, v167
    v_fmac_f32 v108, v207, v168
    v_fmac_f32 v109, v207, v169
    v_fmac_f32 v110, v207, v170
    v_fmac_f32 v111, v207, v171
    v_cvt_pk_bf16_f32 v104, v104, v105
    v_cvt_pk_bf16_f32 v105, v106, v107
    v_cvt_pk_bf16_f32 v106, v108, v109
    v_cvt_pk_bf16_f32 v107, v110, v111
    s_nop 1
    v_permlane16_swap_b32 v104, v106
    v_permlane16_swap_b32 v105, v107
    buffer_store_dwordx4 v[104:107], v42, s[16:19], s49 offen offset:0
    v_fmac_f32 v112, v205, v172
    v_fmac_f32 v113, v205, v173
    v_fmac_f32 v114, v205, v174
    v_fmac_f32 v115, v205, v175
    v_fmac_f32 v116, v207, v176
    v_fmac_f32 v117, v207, v177
    v_fmac_f32 v118, v207, v178
    v_fmac_f32 v119, v207, v179
    v_cvt_pk_bf16_f32 v112, v112, v113
    v_cvt_pk_bf16_f32 v113, v114, v115
    v_cvt_pk_bf16_f32 v114, v116, v117
    v_cvt_pk_bf16_f32 v115, v118, v119
    s_nop 1
    v_permlane16_swap_b32 v112, v114
    v_permlane16_swap_b32 v113, v115
    buffer_store_dwordx4 v[112:115], v42, s[16:19], s49 offen offset:32
    v_fmac_f32 v120, v205, v180
    v_fmac_f32 v121, v205, v181
    v_fmac_f32 v122, v205, v182
    v_fmac_f32 v123, v205, v183
    v_fmac_f32 v124, v207, v184
    v_fmac_f32 v125, v207, v185
    v_fmac_f32 v126, v207, v186
    v_fmac_f32 v127, v207, v187
    v_cvt_pk_bf16_f32 v120, v120, v121
    v_cvt_pk_bf16_f32 v121, v122, v123
    v_cvt_pk_bf16_f32 v122, v124, v125
    v_cvt_pk_bf16_f32 v123, v126, v127
    s_nop 1
    v_permlane16_swap_b32 v120, v122
    v_permlane16_swap_b32 v121, v123
    buffer_store_dwordx4 v[120:123], v42, s[16:19], s51 offen offset:0
L_exit:
    s_endpgm
L_spin_zc:
    s_mov_b32 s101, 0x40000
L_spin2_zc:
    s_sleep 2
    buffer_load_dword v63, v12, s[8:11], 0 offen sc1
    s_waitcnt vmcnt(0)
    v_readfirstlane_b32 s98, v63
    s_nop 0
    s_cmp_ge_u32 s98, s35
    s_cbranch_scc1 L_back_zc
    s_sub_u32 s101, s101, 1
    s_cmp_lg_u32 s101, 0
    s_cbranch_scc1 L_spin2_zc
    s_branch L_back_zc
L_spin_sf:
    s_mov_b32 s101, 0x40000
L_spin2_sf:
    s_sleep 2
    buffer_load_dwordx4 v[36:39], v50, s[20:23], s42 offen offset:0 sc1
    s_waitcnt vmcnt(0)
    v_and_b32 v36, v36, v37
    v_and_b32 v38, v38, v39
    v_and_b32 v36, v36, v38
    v_cmp_ne_u32 vcc, s36, v36
    s_nop 1
    s_cmp_eq_u64 vcc, 0
    s_cbranch_scc1 L_back_sf
    s_sub_u32 s101, s101, 1
    s_cmp_lg_u32 s101, 0
    s_cbranch_scc1 L_spin2_sf
    s_branch L_back_sf
L_spin_n1:
    s_mov_b32 s101, 0x40000
L_spin2_n1:
    s_sleep 2
    buffer_load_dword v5, v51, s[20:23], s63 offen sc1
    s_waitcnt vmcnt(0)
    v_cmp_ne_u32 vcc, 1, v5
    s_nop 1
    s_cmp_eq_u64 vcc, 0
    s_cbranch_scc1 L_back_n1
    s_sub_u32 s101, s101, 1
    s_cmp_lg_u32 s101, 0
    s_cbranch_scc1 L_spin2_n1
    s_branch L_back_n1
L_spin_n2:
    s_mov_b32 s101, 0x40000
L_spin2_n2:
    s_sleep 2
    buffer_load_dword v5, v51, s[20:23], s60 offen sc1
    s_waitcnt vmcnt(0)
    v_cmp_ne_u32 vcc, 1, v5
    s_nop 1
    s_cmp_eq_u64 vcc, 0
    s_cbranch_scc1 L_back_n2
    s_sub_u32 s101, s101, 1
    s_cmp_lg_u32 s101, 0
    s_cbranch_scc1 L_spin2_n2
    s_branch L_back_n2
L_spin_n3:
    s_mov_b32 s101, 0x40000
L_spin2_n3:
    s_sleep 2
    buffer_load_dword v5, v51, s[20:23], s59 offen sc1
    s_waitcnt vmcnt(0)
    v_cmp_ne_u32 vcc, 1, v5
    s_nop 1
    s_cmp_eq_u64 vcc, 0
    s_cbranch_scc1 L_back_n3
    s_sub_u32 s101, s101, 1
    s_cmp_lg_u32 s101, 0
    s_cbranch_scc1 L_spin2_n3
    s_branch L_back_n3
L_spin_rd:
    s_mov_b32 s101, 0x40000
L_spin2_rd:
    buffer_load_dwordx4 v[4:7], v44, s[20:23], s58 offen sc1
    s_waitcnt vmcnt(0)
    v_and_b32 v4, v4, v5
    v_and_b32 v6, v6, v7
    v_and_b32 v4, v4, v6
    s_nop 0
    v_readfirstlane_b32 s57, v4
    s_nop 0
    s_cmp_eq_u32 s57, 1
    s_cbranch_scc1 L_back_rd
    s_sub_u32 s101, s101, 1
    s_cmp_lg_u32 s101, 0
    s_cbranch_scc1 L_spin2_rd
    s_branch L_back_rd
L_spin_c1:
    s_mov_b32 s101, 0x40000
L_spin2_c1:
    s_sleep 2
    buffer_load_dword v5, v51, s[20:23], s63 offen sc1
    s_waitcnt vmcnt(0)
    v_cmp_ne_u32 vcc, 1, v5
    s_nop 1
    s_cmp_eq_u64 vcc, 0
    s_cbranch_scc1 L_back_c1
    s_sub_u32 s101, s101, 1
    s_cmp_lg_u32 s101, 0
    s_cbranch_scc1 L_spin2_c1
    s_branch L_back_c1
L_spin_c2:
    s_mov_b32 s101, 0x40000
L_spin2_c2:
    s_sleep 2
    buffer_load_dword v5, v51, s[20:23], s60 offen sc1
    s_waitcnt vmcnt(0)
    v_cmp_ne_u32 vcc, 1, v5
    s_nop 1
    s_cmp_eq_u64 vcc, 0
    s_cbranch_scc1 L_back_c2
    s_sub_u32 s101, s101, 1
    s_cmp_lg_u32 s101, 0
    s_cbranch_scc1 L_spin2_c2
    s_branch L_back_c2
L_spin_c3:
    s_mov_b32 s101, 0x40000
L_spin2_c3:
    s_sleep 2
    buffer_load_dword v5, v51, s[20:23], s59 offen sc1
    s_waitcnt vmcnt(0)
    v_cmp_ne_u32 vcc, 1, v5
    s_nop 1
    s_cmp_eq_u64 vcc, 0
    s_cbranch_scc1 L_back_c3
    s_sub_u32 s101, s101, 1
    s_cmp_lg_u32 s101, 0
    s_cbranch_scc1 L_spin2_c3
    s_branch L_back_c3
L_spin_pc:
    s_mov_b32 s101, 0x40000
L_spin2_pc:
    s_sleep 2
    buffer_load_dword v43, v13, s[20:23], s53 offen sc1
    s_waitcnt vmcnt(0)
    v_cmp_ne_u32 vcc, 1, v43
    s_nop 1
    s_cmp_eq_u64 vcc, 0
    s_cbranch_scc1 L_back_pc
    s_sub_u32 s101, s101, 1
    s_cmp_lg_u32 s101, 0
    s_cbranch_scc1 L_spin2_pc
    s_branch L_back_pc
L_spin_r12:
    s_mov_b32 s101, 0x40000
L_spin2_r12:
    buffer_load_dwordx4 v[128:131], v6, s[20:23], s44 offen sc1
    buffer_load_dwordx4 v[132:135], v6, s[20:23], s45 offen sc1
    buffer_load_dwordx4 v[136:139], v6, s[20:23], s46 offen sc1
    buffer_load_dwordx4 v[140:143], v6, s[20:23], s57 offen sc1
    buffer_load_dwordx4 v[144:147], v6, s[20:23], s58 offen sc1
    buffer_load_dwordx4 v[148:151], v6, s[20:23], s59 offen sc1
    buffer_load_dwordx4 v[160:163], v6, s[20:23], s100 offen sc1
    s_waitcnt vmcnt(0)
    v_max_u32 v188, v128, v129
    v_max3_u32 v188, v188, v130, v131
    v_max3_u32 v188, v188, v132, v133
    v_max3_u32 v188, v188, v134, v135
    v_max3_u32 v188, v188, v136, v137
    v_max3_u32 v188, v188, v138, v139
    v_max3_u32 v188, v188, v160, v161
    v_max3_u32 v188, v188, v162, v163
    v_lshlrev_b32 v164, 16, v128
    v_and_b32 v165, 0xffff0000, v128
    v_lshlrev_b32 v166, 16, v129
    v_and_b32 v167, 0xffff0000, v129
    v_lshlrev_b32 v168, 16, v130
    v_and_b32 v169, 0xffff0000, v130
    v_lshlrev_b32 v170, 16, v131
    v_and_b32 v171, 0xffff0000, v131
    v_lshlrev_b32 v172, 16, v132
    v_and_b32 v173, 0xffff0000, v132
    v_lshlrev_b32 v174, 16, v133
    v_and_b32 v175, 0xffff0000, v133
    v_lshlrev_b32 v176, 16, v134
    v_and_b32 v177, 0xffff0000, v134
    v_lshlrev_b32 v178, 16, v135
    v_and_b32 v179, 0xffff0000, v135
    v_lshlrev_b32 v180, 16, v136
    v_and_b32 v181, 0xffff0000, v136
    v_lshlrev_b32 v182, 16, v137
    v_and_b32 v183, 0xffff0000, v137
    v_lshlrev_b32 v184, 16, v138
    v_and_b32 v185, 0xffff0000, v138
    v_lshlrev_b32 v186, 16, v139
    v_and_b32 v187, 0xffff0000, v139
    v_max3_u32 v188, v188, v140, v141
    v_max3_u32 v188, v188, v142, v143
    v_max3_u32 v188, v188, v144, v145
    v_max3_u32 v188, v188, v146, v147
    v_max3_u32 v188, v188, v148, v149
    v_max3_u32 v188, v188, v150, v151
    v_lshlrev_b32 v190, 16, v140
    v_and_b32 v191, 0xffff0000, v140
    v_add_f32 v164, v164, v190
    v_add_f32 v165, v165, v191
    v_lshlrev_b32 v190, 16, v141
    v_and_b32 v191, 0xffff0000, v141
    v_add_f32 v166, v166, v190
    v_add_f32 v167, v167, v191
    v_lshlrev_b32 v190, 16, v142
    v_and_b32 v191, 0xffff0000, v142
    v_add_f32 v168, v168, v190
    v_add_f32 v169, v169, v191
    v_lshlrev_b32 v190, 16, v143
    v_and_b32 v191, 0xffff0000, v143
    v_add_f32 v170, v170, v190
    v_add_f32 v171, v171, v191
    v_lshlrev_b32 v190, 16, v144
    v_and_b32 v191, 0xffff0000, v144
    v_add_f32 v172, v172, v190
    v_add_f32 v173, v173, v191
    v_lshlrev_b32 v190, 16, v145
    v_and_b32 v191, 0xffff0000, v145
    v_add_f32 v174, v174, v190
    v_add_f32 v175, v175, v191
    v_lshlrev_b32 v190, 16, v146
    v_and_b32 v191, 0xffff0000, v146
    v_add_f32 v176, v176, v190
    v_add_f32 v177, v177, v191
    v_lshlrev_b32 v190, 16, v147
    v_and_b32 v191, 0xffff0000, v147
    v_add_f32 v178, v178, v190
    v_add_f32 v179, v179, v191
    v_lshlrev_b32 v190, 16, v148
    v_and_b32 v191, 0xffff0000, v148
    v_add_f32 v180, v180, v190
    v_add_f32 v181, v181, v191
    v_lshlrev_b32 v190, 16, v149
    v_and_b32 v191, 0xffff0000, v149
    v_add_f32 v182, v182, v190
    v_add_f32 v183, v183, v191
    v_lshlrev_b32 v190, 16, v150
    v_and_b32 v191, 0xffff0000, v150
    v_add_f32 v184, v184, v190
    v_add_f32 v185, v185, v191
    v_lshlrev_b32 v190, 16, v151
    v_and_b32 v191, 0xffff0000, v151
    v_add_f32 v186, v186, v190
    v_add_f32 v187, v187, v191
    v_cmp_eq_u32 vcc, -1, v188
    s_nop 1
    s_cmp_eq_u64 vcc, 0
    s_cbranch_scc1 L_back_r12
    s_sub_u32 s101, s101, 1
    s_cmp_lg_u32 s101, 0
    s_cbranch_scc1 L_spin2_r12
    s_branch L_back_r12
L_spin_r3:
    s_mov_b32 s101, 0x40000
L_spin2_r3:
    buffer_load_dwordx4 v[152:155], v6, s[20:23], s98 offen sc1
    buffer_load_dwordx4 v[156:159], v6, s[20:23], s99 offen sc1
    s_waitcnt vmcnt(0)
    v_max3_u32 v188, v152, v153, v154
    v_max3_u32 v189, v155, v156, v157
    v_max3_u32 v188, v188, v158, v159
    v_max_u32 v188, v188, v189
    v_cmp_eq_u32 vcc, -1, v188
    s_nop 1
    s_cmp_eq_u64 vcc, 0
    s_cbranch_scc1 L_back_r3
    s_sub_u32 s101, s101, 1
    s_cmp_lg_u32 s101, 0
    s_cbranch_scc1 L_spin2_r3
    s_branch L_back_r3
L_code_end:
.section .rodata,"a"
.p2align 6
.amdhsa_kernel gated_mix__ssm_conv_h3__glu_gated_glu__prompt_kernel
  .amdhsa_next_free_vgpr 512
  .amdhsa_next_free_sgpr 102
  .amdhsa_accum_offset 256
  .amdhsa_group_segment_fixed_size 0
  .amdhsa_kernarg_size 112
  .amdhsa_user_sgpr_count 2
  .amdhsa_user_sgpr_kernarg_segment_ptr 1
  .amdhsa_system_sgpr_workgroup_id_x 1
.end_amdhsa_kernel
```
